```python
import torch

def _softmax(x, axis=-1):
    return torch.softmax(x, dim=axis)
def _gelu(x):
    return torch.nn.functional.gelu(x, approximate="tanh")
def _silu(x):
    return torch.nn.functional.silu(x)
def _sigmoid(x):
    return torch.sigmoid(x)
def _layernorm(x, axis=-1, eps=1e-5):
    m = x.mean(dim=axis, keepdim=True)
    v = x.var(dim=axis, keepdim=True, unbiased=False)
    return (x - m) / torch.sqrt(v + eps)
def _scatter_add(tgt, idx, src, axis=0):
    return tgt.clone().index_add_(axis, idx, src)
def _segment_sum(src, seg, n):
    out = torch.zeros((n,) + src.shape[1:], dtype=src.dtype)
    return out.index_add_(0, seg, src)
def _pad(x, pw):
    flat = tuple(v for pair in reversed(pw) for v in pair)
    return torch.nn.functional.pad(x, flat)

kernel_name = 'standalone__geglu_ffn__prompt'

def setup_inputs():

    _w = (lambda a: (lambda t: t.to(torch.bfloat16) if t.is_floating_point() else t)(torch.as_tensor(a)))
    B, S, D, F = 1, 2048, 1024, 3584
    return {
        "x": _w((lambda *s: torch.randn(*s, dtype=torch.bfloat16) * 0.05)(B, S, D)),
        "w_gate": _w((lambda *s: torch.randn(*s, dtype=torch.bfloat16) * 0.05)(D, F)),
        "w_up": _w((lambda *s: torch.randn(*s, dtype=torch.bfloat16) * 0.05)(D, F)),
        "w_down": _w((lambda *s: torch.randn(*s, dtype=torch.bfloat16) * 0.05)(F, D)),
    }

def reference(x, w_gate, w_up, w_down):
    return (_gelu(x @ w_gate) * (x @ w_up)) @ w_down
```

```asm
; @launch kernel=gemm1_kernel grid=(256,1,1) block=(512,1,1) lds=155648
; @launch kernel=gemm2_kernel grid=(256,1,1) block=(512,1,1) lds=131072
.amdgcn_target "amdgcn-amd-amdhsa--gfx950"
.text
.globl gemm1_kernel
.p2align 8
.type gemm1_kernel,@function
gemm1_kernel:
  s_cmp_ge_u32 s2, 256
  s_cbranch_scc1 G1_EXIT
  s_load_dwordx4 s[4:7], s[0:1], 0
  s_load_dwordx4 s[8:11], s[0:1], 16
  s_load_dwordx2 s[48:49], s[0:1], 48
  v_lshrrev_b32 v12, 6, v0
  v_and_b32 v1, 63, v0
  s_and_b32 s40, s2, 7
  v_readfirstlane_b32 s26, v12
  s_lshr_b32 s41, s2, 3
  s_and_b32 s42, s40, 1
  s_lshl_b32 s42, s42, 2
  s_and_b32 s43, s41, 3
  s_add_u32 s24, s42, s43
  s_lshr_b32 s42, s40, 1
  s_lshl_b32 s42, s42, 3
  s_lshr_b32 s43, s41, 2
  s_add_u32 s25, s42, s43
  s_and_b32 s27, s26, 3
  s_lshr_b32 s28, s26, 2
  v_mul_u32_u24 v12, 37, v1
  v_lshrrev_b32 v12, 9, v12
  v_mul_u32_u24 v13, 14, v12
  v_sub_u32 v13, v1, v13
  v_mul_u32_u24 v12, 7168, v12
  v_lshl_add_u32 v6, v13, 4, v12
  v_lshrrev_b32 v12, 3, v1
  v_lshrrev_b32 v13, 4, v1
  v_and_b32 v14, 7, v1
  v_xor_b32 v13, v13, v14
  v_lshlrev_b32 v13, 4, v13
  v_lshl_add_u32 v2, v12, 11, v13
  v_xor_b32 v12, 64, v2
  v_add_u32 v3, 16384, v12
  v_add_u32 v4, 32768, v2
  v_add_u32 v5, 49152, v12
  s_lshl_b32 s40, s24, 19
  s_lshl_b32 s41, s26, 16
  s_add_u32 s29, s40, s41
  s_and_b32 s40, s27, 1
  s_lshl_b32 s40, s40, 4
  s_lshr_b32 s41, s27, 1
  s_lshl_b32 s41, s41, 2
  s_add_u32 s40, s40, s41
  s_mul_i32 s40, s40, 7168
  s_mul_i32 s41, s25, 224
  s_add_u32 s31, s40, s41
  s_lshl_b32 s44, s26, 12
  s_add_u32 s44, s44, 57344
  s_mul_i32 s45, s28, 7168
  s_mul_i32 s40, s27, 1792
  s_add_u32 s45, s45, s40
  s_mov_b32 s36, -1
  s_mov_b32 s37, 0x00ffffff
  s_mov_b32 s14, 4194304
  s_mov_b32 s15, 0x00020000
  s_mov_b32 s18, 7340032
  s_mov_b32 s19, 0x00020000
  s_cmp_eq_u32 s28, 0
  s_waitcnt lgkmcnt(0)
  s_cselect_b32 s16, s6, s8
  s_cselect_b32 s17, s7, s9
  s_and_b32 s17, s17, 0xffff
  s_mov_b32 s12, s4
  s_and_b32 s13, s5, 0xffff
  s_mov_b64 exec, s[36:37]
  s_add_u32 m0, s45, 0
  s_add_u32 s40, s31, 0
  buffer_load_dwordx4 v6, s[16:19], s40 offen lds
  s_add_u32 m0, s45, 896
  s_add_u32 s40, s31, 57344
  buffer_load_dwordx4 v6, s[16:19], s40 offen lds
  s_mov_b64 exec, -1
  s_add_u32 m0, s44, 0
  s_nop 0
  buffer_load_dwordx4 v2, s[12:15], s29 offen offset:0 lds
  s_add_u32 m0, s44, 1024
  s_nop 0
  buffer_load_dwordx4 v3, s[12:15], s29 offen offset:0 lds
  s_add_u32 m0, s44, 2048
  s_nop 0
  buffer_load_dwordx4 v4, s[12:15], s29 offen offset:0 lds
  s_add_u32 m0, s44, 3072
  s_nop 0
  buffer_load_dwordx4 v5, s[12:15], s29 offen offset:0 lds
  s_mov_b64 exec, s[36:37]
  s_add_u32 m0, s45, 14336
  s_add_u32 s40, s31, 229376
  buffer_load_dwordx4 v6, s[16:19], s40 offen lds
  s_add_u32 m0, s45, 15232
  s_add_u32 s40, s31, 286720
  buffer_load_dwordx4 v6, s[16:19], s40 offen lds
  s_mov_b64 exec, -1
  s_mov_b64 exec, s[36:37]
  s_add_u32 m0, s45, 28672
  s_add_u32 s40, s31, 458752
  buffer_load_dwordx4 v6, s[16:19], s40 offen lds
  s_add_u32 m0, s45, 29568
  s_add_u32 s40, s31, 516096
  buffer_load_dwordx4 v6, s[16:19], s40 offen lds
  s_mov_b64 exec, -1
  s_add_u32 m0, s44, 32640
  s_nop 0
  buffer_load_dwordx4 v2, s[12:15], s29 offen offset:128 lds
  s_add_u32 m0, s44, 33664
  s_nop 0
  buffer_load_dwordx4 v3, s[12:15], s29 offen offset:128 lds
  s_add_u32 m0, s44, 34688
  s_nop 0
  buffer_load_dwordx4 v4, s[12:15], s29 offen offset:128 lds
  s_add_u32 m0, s44, 35712
  s_nop 0
  buffer_load_dwordx4 v5, s[12:15], s29 offen offset:128 lds
  s_mov_b64 exec, s[36:37]
  s_add_u32 m0, s45, 43008
  s_add_u32 s40, s31, 688128
  buffer_load_dwordx4 v6, s[16:19], s40 offen lds
  s_add_u32 m0, s45, 43904
  s_add_u32 s40, s31, 745472
  buffer_load_dwordx4 v6, s[16:19], s40 offen lds
  s_mov_b64 exec, -1
  s_add_u32 m0, s44, 65280
  s_nop 0
  buffer_load_dwordx4 v2, s[12:15], s29 offen offset:256 lds
  s_add_u32 m0, s44, 66304
  s_nop 0
  buffer_load_dwordx4 v3, s[12:15], s29 offen offset:256 lds
  v_and_b32 v12, 15, v1
  v_lshrrev_b32 v13, 1, v12
  v_lshrrev_b32 v14, 4, v1
  v_xor_b32 v13, v13, v14
  v_lshlrev_b32 v13, 4, v13
  v_lshl_add_u32 v7, v12, 7, v13
  s_lshl_b32 s40, s27, 13
  s_add_u32 s40, s40, 57344
  v_add_u32 v7, s40, v7
  v_xor_b32 v8, 64, v7
  v_add_u32 v9, 0x10000, v7
  v_add_u32 v10, 0x10000, v8
  v_lshrrev_b32 v12, 2, v1
  v_mul_u32_u24 v12, 224, v12
  v_and_b32 v13, 3, v1
  v_lshl_add_u32 v11, v13, 3, v12
  s_mov_b32 s20, s48
  s_and_b32 s21, s49, 0xffff
  s_mov_b32 s22, 14680064
  s_mov_b32 s23, 0x00020000
  v_lshlrev_b32 v15, 4, v1
  s_mul_i32 s62, s2, 28672
  s_lshl_b32 s40, s26, 12
  s_add_u32 s62, s62, s40
  s_mov_b32 s48, s10
  s_and_b32 s49, s11, 0xffff
  s_mov_b32 s50, 7340032
  s_mov_b32 s51, 0x00020000
  v_mov_b32 v16, 0
  v_mov_b32 v17, 0
  v_mov_b32 v18, 0
  v_mov_b32 v19, 0
  v_mov_b32 v20, 0
  v_mov_b32 v21, 0
  v_mov_b32 v22, 0
  v_mov_b32 v23, 0
  v_mov_b32 v24, 0
  v_mov_b32 v25, 0
  v_mov_b32 v26, 0
  v_mov_b32 v27, 0
  v_mov_b32 v28, 0
  v_mov_b32 v29, 0
  v_mov_b32 v30, 0
  v_mov_b32 v31, 0
  v_mov_b32 v32, 0
  v_mov_b32 v33, 0
  v_mov_b32 v34, 0
  v_mov_b32 v35, 0
  v_mov_b32 v36, 0
  v_mov_b32 v37, 0
  v_mov_b32 v38, 0
  v_mov_b32 v39, 0
  v_mov_b32 v40, 0
  v_mov_b32 v41, 0
  v_mov_b32 v42, 0
  v_mov_b32 v43, 0
  v_mov_b32 v44, 0
  v_mov_b32 v45, 0
  v_mov_b32 v46, 0
  v_mov_b32 v47, 0
  v_mov_b32 v48, 0
  v_mov_b32 v49, 0
  v_mov_b32 v50, 0
  v_mov_b32 v51, 0
  v_mov_b32 v52, 0
  v_mov_b32 v53, 0
  v_mov_b32 v54, 0
  v_mov_b32 v55, 0
  v_mov_b32 v56, 0
  v_mov_b32 v57, 0
  v_mov_b32 v58, 0
  v_mov_b32 v59, 0
  v_mov_b32 v60, 0
  v_mov_b32 v61, 0
  v_mov_b32 v62, 0
  v_mov_b32 v63, 0
  v_mov_b32 v64, 0
  v_mov_b32 v65, 0
  v_mov_b32 v66, 0
  v_mov_b32 v67, 0
  v_mov_b32 v68, 0
  v_mov_b32 v69, 0
  v_mov_b32 v70, 0
  v_mov_b32 v71, 0
  v_mov_b32 v72, 0
  v_mov_b32 v73, 0
  v_mov_b32 v74, 0
  v_mov_b32 v75, 0
  v_mov_b32 v76, 0
  v_mov_b32 v77, 0
  v_mov_b32 v78, 0
  v_mov_b32 v79, 0
  v_mov_b32 v80, 0
  v_mov_b32 v81, 0
  v_mov_b32 v82, 0
  v_mov_b32 v83, 0
  v_mov_b32 v84, 0
  v_mov_b32 v85, 0
  v_mov_b32 v86, 0
  v_mov_b32 v87, 0
  v_mov_b32 v88, 0
  v_mov_b32 v89, 0
  v_mov_b32 v90, 0
  v_mov_b32 v91, 0
  v_mov_b32 v92, 0
  v_mov_b32 v93, 0
  v_mov_b32 v94, 0
  v_mov_b32 v95, 0
  v_mov_b32 v96, 0
  v_mov_b32 v97, 0
  v_mov_b32 v98, 0
  v_mov_b32 v99, 0
  v_mov_b32 v100, 0
  v_mov_b32 v101, 0
  v_mov_b32 v102, 0
  v_mov_b32 v103, 0
  v_mov_b32 v104, 0
  v_mov_b32 v105, 0
  v_mov_b32 v106, 0
  v_mov_b32 v107, 0
  v_mov_b32 v108, 0
  v_mov_b32 v109, 0
  v_mov_b32 v110, 0
  v_mov_b32 v111, 0
  v_mov_b32 v112, 0
  v_mov_b32 v113, 0
  v_mov_b32 v114, 0
  v_mov_b32 v115, 0
  v_mov_b32 v116, 0
  v_mov_b32 v117, 0
  v_mov_b32 v118, 0
  v_mov_b32 v119, 0
  v_mov_b32 v120, 0
  v_mov_b32 v121, 0
  v_mov_b32 v122, 0
  v_mov_b32 v123, 0
  v_mov_b32 v124, 0
  v_mov_b32 v125, 0
  v_mov_b32 v126, 0
  v_mov_b32 v127, 0
  v_mov_b32 v128, 0
  v_mov_b32 v129, 0
  v_mov_b32 v130, 0
  v_mov_b32 v131, 0
  v_mov_b32 v132, 0
  v_mov_b32 v133, 0
  v_mov_b32 v134, 0
  v_mov_b32 v135, 0
  v_mov_b32 v136, 0
  v_mov_b32 v137, 0
  v_mov_b32 v138, 0
  v_mov_b32 v139, 0
  v_mov_b32 v140, 0
  v_mov_b32 v141, 0
  v_mov_b32 v142, 0
  v_mov_b32 v143, 0
  s_waitcnt vmcnt(12)
  s_barrier
  s_cmp_eq_u32 s28, 0
  s_cbranch_scc0 G1_VAR1
  ds_read_b128 a[0:3], v7 offset:0
  ds_read_b128 a[4:7], v7 offset:2048
  ds_read_b128 a[8:11], v7 offset:4096
  ds_read_b128 a[12:15], v7 offset:6144
  ds_read_b64_tr_b16 a[16:17], v11 offset:0
  ds_read_b64_tr_b16 a[18:19], v11 offset:3584
  ds_read_b64_tr_b16 a[32:33], v11 offset:7168
  ds_read_b64_tr_b16 a[34:35], v11 offset:10752
  ds_read_b64_tr_b16 a[20:21], v11 offset:32
  ds_read_b64_tr_b16 a[22:23], v11 offset:3616
  ds_read_b64_tr_b16 a[36:37], v11 offset:7200
  ds_read_b64_tr_b16 a[38:39], v11 offset:10784
  ds_read_b64_tr_b16 a[24:25], v11 offset:64
  ds_read_b64_tr_b16 a[26:27], v11 offset:3648
  ds_read_b64_tr_b16 a[40:41], v11 offset:7232
  ds_read_b64_tr_b16 a[42:43], v11 offset:10816
  ds_read_b64_tr_b16 a[28:29], v11 offset:96
  ds_read_b64_tr_b16 a[30:31], v11 offset:3680
  ds_read_b64_tr_b16 a[44:45], v11 offset:7264
  ds_read_b64_tr_b16 a[46:47], v11 offset:10848
  s_waitcnt vmcnt(10) lgkmcnt(0)
  s_barrier
  v_mfma_f32_16x16x32_bf16 v[16:19], a[16:19], a[0:3], v[16:19]
  ds_read_b128 a[48:51], v8 offset:0
  v_mfma_f32_16x16x32_bf16 v[48:51], a[16:19], a[4:7], v[48:51]
  ds_read_b128 a[52:55], v8 offset:2048
  v_mfma_f32_16x16x32_bf16 v[80:83], a[16:19], a[8:11], v[80:83]
  ds_read_b128 a[56:59], v8 offset:4096
  v_mfma_f32_16x16x32_bf16 v[112:115], a[16:19], a[12:15], v[112:115]
  ds_read_b128 a[60:63], v8 offset:6144
  s_mov_b64 exec, s[36:37]
  s_add_u32 m0, s45, 0
  s_add_u32 s40, s31, 917504
  buffer_load_dwordx4 v6, s[16:19], s40 offen lds
  s_add_u32 m0, s45, 896
  s_add_u32 s40, s31, 974848
  buffer_load_dwordx4 v6, s[16:19], s40 offen lds
  s_mov_b64 exec, -1
  v_mfma_f32_16x16x32_bf16 v[32:35], a[32:35], a[0:3], v[32:35]
  ds_read_b64_tr_b16 a[64:65], v11 offset:14336
  v_mfma_f32_16x16x32_bf16 v[64:67], a[32:35], a[4:7], v[64:67]
  ds_read_b64_tr_b16 a[66:67], v11 offset:17920
  v_mfma_f32_16x16x32_bf16 v[96:99], a[32:35], a[8:11], v[96:99]
  ds_read_b64_tr_b16 a[80:81], v11 offset:21504
  v_mfma_f32_16x16x32_bf16 v[128:131], a[32:35], a[12:15], v[128:131]
  ds_read_b64_tr_b16 a[82:83], v11 offset:25088
  v_mfma_f32_16x16x32_bf16 v[20:23], a[20:23], a[0:3], v[20:23]
  ds_read_b64_tr_b16 a[68:69], v11 offset:14368
  v_mfma_f32_16x16x32_bf16 v[52:55], a[20:23], a[4:7], v[52:55]
  ds_read_b64_tr_b16 a[70:71], v11 offset:17952
  v_mfma_f32_16x16x32_bf16 v[84:87], a[20:23], a[8:11], v[84:87]
  ds_read_b64_tr_b16 a[84:85], v11 offset:21536
  v_mfma_f32_16x16x32_bf16 v[116:119], a[20:23], a[12:15], v[116:119]
  ds_read_b64_tr_b16 a[86:87], v11 offset:25120
  v_mfma_f32_16x16x32_bf16 v[36:39], a[36:39], a[0:3], v[36:39]
  ds_read_b64_tr_b16 a[72:73], v11 offset:14400
  s_add_u32 m0, s44, 67328
  s_nop 0
  buffer_load_dwordx4 v4, s[12:15], s29 offen offset:256 lds
  v_mfma_f32_16x16x32_bf16 v[68:71], a[36:39], a[4:7], v[68:71]
  ds_read_b64_tr_b16 a[74:75], v11 offset:17984
  v_mfma_f32_16x16x32_bf16 v[100:103], a[36:39], a[8:11], v[100:103]
  ds_read_b64_tr_b16 a[88:89], v11 offset:21568
  v_mfma_f32_16x16x32_bf16 v[132:135], a[36:39], a[12:15], v[132:135]
  ds_read_b64_tr_b16 a[90:91], v11 offset:25152
  v_mfma_f32_16x16x32_bf16 v[24:27], a[24:27], a[0:3], v[24:27]
  ds_read_b64_tr_b16 a[76:77], v11 offset:14432
  v_mfma_f32_16x16x32_bf16 v[56:59], a[24:27], a[4:7], v[56:59]
  ds_read_b64_tr_b16 a[78:79], v11 offset:18016
  v_mfma_f32_16x16x32_bf16 v[88:91], a[24:27], a[8:11], v[88:91]
  ds_read_b64_tr_b16 a[92:93], v11 offset:21600
  v_mfma_f32_16x16x32_bf16 v[120:123], a[24:27], a[12:15], v[120:123]
  ds_read_b64_tr_b16 a[94:95], v11 offset:25184
  v_mfma_f32_16x16x32_bf16 v[40:43], a[40:43], a[0:3], v[40:43]
  s_add_u32 m0, s44, 68352
  s_nop 0
  buffer_load_dwordx4 v5, s[12:15], s29 offen offset:256 lds
  v_mfma_f32_16x16x32_bf16 v[72:75], a[40:43], a[4:7], v[72:75]
  v_mfma_f32_16x16x32_bf16 v[104:107], a[40:43], a[8:11], v[104:107]
  v_mfma_f32_16x16x32_bf16 v[136:139], a[40:43], a[12:15], v[136:139]
  v_mfma_f32_16x16x32_bf16 v[28:31], a[28:31], a[0:3], v[28:31]
  v_mfma_f32_16x16x32_bf16 v[60:63], a[28:31], a[4:7], v[60:63]
  v_mfma_f32_16x16x32_bf16 v[92:95], a[28:31], a[8:11], v[92:95]
  v_mfma_f32_16x16x32_bf16 v[124:127], a[28:31], a[12:15], v[124:127]
  v_mfma_f32_16x16x32_bf16 v[44:47], a[44:47], a[0:3], v[44:47]
  v_mfma_f32_16x16x32_bf16 v[76:79], a[44:47], a[4:7], v[76:79]
  v_mfma_f32_16x16x32_bf16 v[108:111], a[44:47], a[8:11], v[108:111]
  v_mfma_f32_16x16x32_bf16 v[140:143], a[44:47], a[12:15], v[140:143]
  s_waitcnt vmcnt(8) lgkmcnt(0)
  s_barrier
  v_mfma_f32_16x16x32_bf16 v[16:19], a[64:67], a[48:51], v[16:19]
  ds_read_b128 a[0:3], v7 offset:32768
  v_mfma_f32_16x16x32_bf16 v[48:51], a[64:67], a[52:55], v[48:51]
  ds_read_b128 a[4:7], v7 offset:34816
  v_mfma_f32_16x16x32_bf16 v[80:83], a[64:67], a[56:59], v[80:83]
  ds_read_b128 a[8:11], v7 offset:36864
  v_mfma_f32_16x16x32_bf16 v[112:115], a[64:67], a[60:63], v[112:115]
  ds_read_b128 a[12:15], v7 offset:38912
  s_mov_b64 exec, s[36:37]
  s_add_u32 m0, s45, 14336
  s_add_u32 s40, s31, 1146880
  buffer_load_dwordx4 v6, s[16:19], s40 offen lds
  s_add_u32 m0, s45, 15232
  s_add_u32 s40, s31, 1204224
  buffer_load_dwordx4 v6, s[16:19], s40 offen lds
  s_mov_b64 exec, -1
  v_mfma_f32_16x16x32_bf16 v[32:35], a[80:83], a[48:51], v[32:35]
  ds_read_b64_tr_b16 a[16:17], v11 offset:28672
  v_mfma_f32_16x16x32_bf16 v[64:67], a[80:83], a[52:55], v[64:67]
  ds_read_b64_tr_b16 a[18:19], v11 offset:32256
  v_mfma_f32_16x16x32_bf16 v[96:99], a[80:83], a[56:59], v[96:99]
  ds_read_b64_tr_b16 a[32:33], v11 offset:35840
  v_mfma_f32_16x16x32_bf16 v[128:131], a[80:83], a[60:63], v[128:131]
  ds_read_b64_tr_b16 a[34:35], v11 offset:39424
  v_mfma_f32_16x16x32_bf16 v[20:23], a[68:71], a[48:51], v[20:23]
  ds_read_b64_tr_b16 a[20:21], v11 offset:28704
  v_mfma_f32_16x16x32_bf16 v[52:55], a[68:71], a[52:55], v[52:55]
  ds_read_b64_tr_b16 a[22:23], v11 offset:32288
  v_mfma_f32_16x16x32_bf16 v[84:87], a[68:71], a[56:59], v[84:87]
  ds_read_b64_tr_b16 a[36:37], v11 offset:35872
  v_mfma_f32_16x16x32_bf16 v[116:119], a[68:71], a[60:63], v[116:119]
  ds_read_b64_tr_b16 a[38:39], v11 offset:39456
  v_mfma_f32_16x16x32_bf16 v[36:39], a[84:87], a[48:51], v[36:39]
  ds_read_b64_tr_b16 a[24:25], v11 offset:28736
  s_add_u32 m0, s44, 4294966912
  s_nop 0
  buffer_load_dwordx4 v2, s[12:15], s29 offen offset:384 lds
  v_mfma_f32_16x16x32_bf16 v[68:71], a[84:87], a[52:55], v[68:71]
  ds_read_b64_tr_b16 a[26:27], v11 offset:32320
  v_mfma_f32_16x16x32_bf16 v[100:103], a[84:87], a[56:59], v[100:103]
  ds_read_b64_tr_b16 a[40:41], v11 offset:35904
  v_mfma_f32_16x16x32_bf16 v[132:135], a[84:87], a[60:63], v[132:135]
  ds_read_b64_tr_b16 a[42:43], v11 offset:39488
  v_mfma_f32_16x16x32_bf16 v[24:27], a[72:75], a[48:51], v[24:27]
  ds_read_b64_tr_b16 a[28:29], v11 offset:28768
  v_mfma_f32_16x16x32_bf16 v[56:59], a[72:75], a[52:55], v[56:59]
  ds_read_b64_tr_b16 a[30:31], v11 offset:32352
  v_mfma_f32_16x16x32_bf16 v[88:91], a[72:75], a[56:59], v[88:91]
  ds_read_b64_tr_b16 a[44:45], v11 offset:35936
  v_mfma_f32_16x16x32_bf16 v[120:123], a[72:75], a[60:63], v[120:123]
  ds_read_b64_tr_b16 a[46:47], v11 offset:39520
  v_mfma_f32_16x16x32_bf16 v[40:43], a[88:91], a[48:51], v[40:43]
  s_add_u32 m0, s44, 640
  s_nop 0
  buffer_load_dwordx4 v3, s[12:15], s29 offen offset:384 lds
  v_mfma_f32_16x16x32_bf16 v[72:75], a[88:91], a[52:55], v[72:75]
  v_mfma_f32_16x16x32_bf16 v[104:107], a[88:91], a[56:59], v[104:107]
  v_mfma_f32_16x16x32_bf16 v[136:139], a[88:91], a[60:63], v[136:139]
  v_mfma_f32_16x16x32_bf16 v[28:31], a[76:79], a[48:51], v[28:31]
  v_mfma_f32_16x16x32_bf16 v[60:63], a[76:79], a[52:55], v[60:63]
  v_mfma_f32_16x16x32_bf16 v[92:95], a[76:79], a[56:59], v[92:95]
  v_mfma_f32_16x16x32_bf16 v[124:127], a[76:79], a[60:63], v[124:127]
  v_mfma_f32_16x16x32_bf16 v[44:47], a[92:95], a[48:51], v[44:47]
  v_mfma_f32_16x16x32_bf16 v[76:79], a[92:95], a[52:55], v[76:79]
  v_mfma_f32_16x16x32_bf16 v[108:111], a[92:95], a[56:59], v[108:111]
  v_mfma_f32_16x16x32_bf16 v[140:143], a[92:95], a[60:63], v[140:143]
  s_waitcnt vmcnt(10) lgkmcnt(0)
  s_barrier
  v_mfma_f32_16x16x32_bf16 v[16:19], a[16:19], a[0:3], v[16:19]
  ds_read_b128 a[48:51], v8 offset:32768
  v_mfma_f32_16x16x32_bf16 v[48:51], a[16:19], a[4:7], v[48:51]
  ds_read_b128 a[52:55], v8 offset:34816
  v_mfma_f32_16x16x32_bf16 v[80:83], a[16:19], a[8:11], v[80:83]
  ds_read_b128 a[56:59], v8 offset:36864
  v_mfma_f32_16x16x32_bf16 v[112:115], a[16:19], a[12:15], v[112:115]
  ds_read_b128 a[60:63], v8 offset:38912
  s_mov_b64 exec, s[36:37]
  s_add_u32 m0, s45, 28672
  s_add_u32 s40, s31, 1376256
  buffer_load_dwordx4 v6, s[16:19], s40 offen lds
  s_add_u32 m0, s45, 29568
  s_add_u32 s40, s31, 1433600
  buffer_load_dwordx4 v6, s[16:19], s40 offen lds
  s_mov_b64 exec, -1
  v_mfma_f32_16x16x32_bf16 v[32:35], a[32:35], a[0:3], v[32:35]
  ds_read_b64_tr_b16 a[64:65], v11 offset:43008
  v_mfma_f32_16x16x32_bf16 v[64:67], a[32:35], a[4:7], v[64:67]
  ds_read_b64_tr_b16 a[66:67], v11 offset:46592
  v_mfma_f32_16x16x32_bf16 v[96:99], a[32:35], a[8:11], v[96:99]
  ds_read_b64_tr_b16 a[80:81], v11 offset:50176
  v_mfma_f32_16x16x32_bf16 v[128:131], a[32:35], a[12:15], v[128:131]
  ds_read_b64_tr_b16 a[82:83], v11 offset:53760
  v_mfma_f32_16x16x32_bf16 v[20:23], a[20:23], a[0:3], v[20:23]
  ds_read_b64_tr_b16 a[68:69], v11 offset:43040
  v_mfma_f32_16x16x32_bf16 v[52:55], a[20:23], a[4:7], v[52:55]
  ds_read_b64_tr_b16 a[70:71], v11 offset:46624
  v_mfma_f32_16x16x32_bf16 v[84:87], a[20:23], a[8:11], v[84:87]
  ds_read_b64_tr_b16 a[84:85], v11 offset:50208
  v_mfma_f32_16x16x32_bf16 v[116:119], a[20:23], a[12:15], v[116:119]
  ds_read_b64_tr_b16 a[86:87], v11 offset:53792
  v_mfma_f32_16x16x32_bf16 v[36:39], a[36:39], a[0:3], v[36:39]
  ds_read_b64_tr_b16 a[72:73], v11 offset:43072
  s_add_u32 m0, s44, 1664
  s_nop 0
  buffer_load_dwordx4 v4, s[12:15], s29 offen offset:384 lds
  v_mfma_f32_16x16x32_bf16 v[68:71], a[36:39], a[4:7], v[68:71]
  ds_read_b64_tr_b16 a[74:75], v11 offset:46656
  v_mfma_f32_16x16x32_bf16 v[100:103], a[36:39], a[8:11], v[100:103]
  ds_read_b64_tr_b16 a[88:89], v11 offset:50240
  v_mfma_f32_16x16x32_bf16 v[132:135], a[36:39], a[12:15], v[132:135]
  ds_read_b64_tr_b16 a[90:91], v11 offset:53824
  v_mfma_f32_16x16x32_bf16 v[24:27], a[24:27], a[0:3], v[24:27]
  ds_read_b64_tr_b16 a[76:77], v11 offset:43104
  v_mfma_f32_16x16x32_bf16 v[56:59], a[24:27], a[4:7], v[56:59]
  ds_read_b64_tr_b16 a[78:79], v11 offset:46688
  v_mfma_f32_16x16x32_bf16 v[88:91], a[24:27], a[8:11], v[88:91]
  ds_read_b64_tr_b16 a[92:93], v11 offset:50272
  v_mfma_f32_16x16x32_bf16 v[120:123], a[24:27], a[12:15], v[120:123]
  ds_read_b64_tr_b16 a[94:95], v11 offset:53856
  v_mfma_f32_16x16x32_bf16 v[40:43], a[40:43], a[0:3], v[40:43]
  s_add_u32 m0, s44, 2688
  s_nop 0
  buffer_load_dwordx4 v5, s[12:15], s29 offen offset:384 lds
  v_mfma_f32_16x16x32_bf16 v[72:75], a[40:43], a[4:7], v[72:75]
  v_mfma_f32_16x16x32_bf16 v[104:107], a[40:43], a[8:11], v[104:107]
  v_mfma_f32_16x16x32_bf16 v[136:139], a[40:43], a[12:15], v[136:139]
  v_mfma_f32_16x16x32_bf16 v[28:31], a[28:31], a[0:3], v[28:31]
  v_mfma_f32_16x16x32_bf16 v[60:63], a[28:31], a[4:7], v[60:63]
  v_mfma_f32_16x16x32_bf16 v[92:95], a[28:31], a[8:11], v[92:95]
  v_mfma_f32_16x16x32_bf16 v[124:127], a[28:31], a[12:15], v[124:127]
  v_mfma_f32_16x16x32_bf16 v[44:47], a[44:47], a[0:3], v[44:47]
  v_mfma_f32_16x16x32_bf16 v[76:79], a[44:47], a[4:7], v[76:79]
  v_mfma_f32_16x16x32_bf16 v[108:111], a[44:47], a[8:11], v[108:111]
  v_mfma_f32_16x16x32_bf16 v[140:143], a[44:47], a[12:15], v[140:143]
  s_waitcnt vmcnt(8) lgkmcnt(0)
  s_barrier
  v_mfma_f32_16x16x32_bf16 v[16:19], a[64:67], a[48:51], v[16:19]
  ds_read_b128 a[0:3], v9 offset:0
  v_mfma_f32_16x16x32_bf16 v[48:51], a[64:67], a[52:55], v[48:51]
  ds_read_b128 a[4:7], v9 offset:2048
  v_mfma_f32_16x16x32_bf16 v[80:83], a[64:67], a[56:59], v[80:83]
  ds_read_b128 a[8:11], v9 offset:4096
  v_mfma_f32_16x16x32_bf16 v[112:115], a[64:67], a[60:63], v[112:115]
  ds_read_b128 a[12:15], v9 offset:6144
  s_mov_b64 exec, s[36:37]
  s_add_u32 m0, s45, 43008
  s_add_u32 s40, s31, 1605632
  buffer_load_dwordx4 v6, s[16:19], s40 offen lds
  s_add_u32 m0, s45, 43904
  s_add_u32 s40, s31, 1662976
  buffer_load_dwordx4 v6, s[16:19], s40 offen lds
  s_mov_b64 exec, -1
  v_mfma_f32_16x16x32_bf16 v[32:35], a[80:83], a[48:51], v[32:35]
  ds_read_b64_tr_b16 a[16:17], v11 offset:0
  v_mfma_f32_16x16x32_bf16 v[64:67], a[80:83], a[52:55], v[64:67]
  ds_read_b64_tr_b16 a[18:19], v11 offset:3584
  v_mfma_f32_16x16x32_bf16 v[96:99], a[80:83], a[56:59], v[96:99]
  ds_read_b64_tr_b16 a[32:33], v11 offset:7168
  v_mfma_f32_16x16x32_bf16 v[128:131], a[80:83], a[60:63], v[128:131]
  ds_read_b64_tr_b16 a[34:35], v11 offset:10752
  v_mfma_f32_16x16x32_bf16 v[20:23], a[68:71], a[48:51], v[20:23]
  ds_read_b64_tr_b16 a[20:21], v11 offset:32
  v_mfma_f32_16x16x32_bf16 v[52:55], a[68:71], a[52:55], v[52:55]
  ds_read_b64_tr_b16 a[22:23], v11 offset:3616
  v_mfma_f32_16x16x32_bf16 v[84:87], a[68:71], a[56:59], v[84:87]
  ds_read_b64_tr_b16 a[36:37], v11 offset:7200
  v_mfma_f32_16x16x32_bf16 v[116:119], a[68:71], a[60:63], v[116:119]
  ds_read_b64_tr_b16 a[38:39], v11 offset:10784
  v_mfma_f32_16x16x32_bf16 v[36:39], a[84:87], a[48:51], v[36:39]
  ds_read_b64_tr_b16 a[24:25], v11 offset:64
  s_add_u32 m0, s44, 32256
  s_nop 0
  buffer_load_dwordx4 v2, s[12:15], s29 offen offset:512 lds
  v_mfma_f32_16x16x32_bf16 v[68:71], a[84:87], a[52:55], v[68:71]
  ds_read_b64_tr_b16 a[26:27], v11 offset:3648
  v_mfma_f32_16x16x32_bf16 v[100:103], a[84:87], a[56:59], v[100:103]
  ds_read_b64_tr_b16 a[40:41], v11 offset:7232
  v_mfma_f32_16x16x32_bf16 v[132:135], a[84:87], a[60:63], v[132:135]
  ds_read_b64_tr_b16 a[42:43], v11 offset:10816
  v_mfma_f32_16x16x32_bf16 v[24:27], a[72:75], a[48:51], v[24:27]
  ds_read_b64_tr_b16 a[28:29], v11 offset:96
  v_mfma_f32_16x16x32_bf16 v[56:59], a[72:75], a[52:55], v[56:59]
  ds_read_b64_tr_b16 a[30:31], v11 offset:3680
  v_mfma_f32_16x16x32_bf16 v[88:91], a[72:75], a[56:59], v[88:91]
  ds_read_b64_tr_b16 a[44:45], v11 offset:7264
  v_mfma_f32_16x16x32_bf16 v[120:123], a[72:75], a[60:63], v[120:123]
  ds_read_b64_tr_b16 a[46:47], v11 offset:10848
  v_mfma_f32_16x16x32_bf16 v[40:43], a[88:91], a[48:51], v[40:43]
  s_add_u32 m0, s44, 33280
  s_nop 0
  buffer_load_dwordx4 v3, s[12:15], s29 offen offset:512 lds
  v_mfma_f32_16x16x32_bf16 v[72:75], a[88:91], a[52:55], v[72:75]
  v_mfma_f32_16x16x32_bf16 v[104:107], a[88:91], a[56:59], v[104:107]
  v_mfma_f32_16x16x32_bf16 v[136:139], a[88:91], a[60:63], v[136:139]
  v_mfma_f32_16x16x32_bf16 v[28:31], a[76:79], a[48:51], v[28:31]
  v_mfma_f32_16x16x32_bf16 v[60:63], a[76:79], a[52:55], v[60:63]
  v_mfma_f32_16x16x32_bf16 v[92:95], a[76:79], a[56:59], v[92:95]
  v_mfma_f32_16x16x32_bf16 v[124:127], a[76:79], a[60:63], v[124:127]
  v_mfma_f32_16x16x32_bf16 v[44:47], a[92:95], a[48:51], v[44:47]
  v_mfma_f32_16x16x32_bf16 v[76:79], a[92:95], a[52:55], v[76:79]
  v_mfma_f32_16x16x32_bf16 v[108:111], a[92:95], a[56:59], v[108:111]
  v_mfma_f32_16x16x32_bf16 v[140:143], a[92:95], a[60:63], v[140:143]
  s_waitcnt vmcnt(10) lgkmcnt(0)
  s_barrier
  v_mfma_f32_16x16x32_bf16 v[16:19], a[16:19], a[0:3], v[16:19]
  ds_read_b128 a[48:51], v10 offset:0
  v_mfma_f32_16x16x32_bf16 v[48:51], a[16:19], a[4:7], v[48:51]
  ds_read_b128 a[52:55], v10 offset:2048
  v_mfma_f32_16x16x32_bf16 v[80:83], a[16:19], a[8:11], v[80:83]
  ds_read_b128 a[56:59], v10 offset:4096
  v_mfma_f32_16x16x32_bf16 v[112:115], a[16:19], a[12:15], v[112:115]
  ds_read_b128 a[60:63], v10 offset:6144
  s_mov_b64 exec, s[36:37]
  s_add_u32 m0, s45, 0
  s_add_u32 s40, s31, 1835008
  buffer_load_dwordx4 v6, s[16:19], s40 offen lds
  s_add_u32 m0, s45, 896
  s_add_u32 s40, s31, 1892352
  buffer_load_dwordx4 v6, s[16:19], s40 offen lds
  s_mov_b64 exec, -1
  v_mfma_f32_16x16x32_bf16 v[32:35], a[32:35], a[0:3], v[32:35]
  ds_read_b64_tr_b16 a[64:65], v11 offset:14336
  v_mfma_f32_16x16x32_bf16 v[64:67], a[32:35], a[4:7], v[64:67]
  ds_read_b64_tr_b16 a[66:67], v11 offset:17920
  v_mfma_f32_16x16x32_bf16 v[96:99], a[32:35], a[8:11], v[96:99]
  ds_read_b64_tr_b16 a[80:81], v11 offset:21504
  v_mfma_f32_16x16x32_bf16 v[128:131], a[32:35], a[12:15], v[128:131]
  ds_read_b64_tr_b16 a[82:83], v11 offset:25088
  v_mfma_f32_16x16x32_bf16 v[20:23], a[20:23], a[0:3], v[20:23]
  ds_read_b64_tr_b16 a[68:69], v11 offset:14368
  v_mfma_f32_16x16x32_bf16 v[52:55], a[20:23], a[4:7], v[52:55]
  ds_read_b64_tr_b16 a[70:71], v11 offset:17952
  v_mfma_f32_16x16x32_bf16 v[84:87], a[20:23], a[8:11], v[84:87]
  ds_read_b64_tr_b16 a[84:85], v11 offset:21536
  v_mfma_f32_16x16x32_bf16 v[116:119], a[20:23], a[12:15], v[116:119]
  ds_read_b64_tr_b16 a[86:87], v11 offset:25120
  v_mfma_f32_16x16x32_bf16 v[36:39], a[36:39], a[0:3], v[36:39]
  ds_read_b64_tr_b16 a[72:73], v11 offset:14400
  s_add_u32 m0, s44, 34304
  s_nop 0
  buffer_load_dwordx4 v4, s[12:15], s29 offen offset:512 lds
  v_mfma_f32_16x16x32_bf16 v[68:71], a[36:39], a[4:7], v[68:71]
  ds_read_b64_tr_b16 a[74:75], v11 offset:17984
  v_mfma_f32_16x16x32_bf16 v[100:103], a[36:39], a[8:11], v[100:103]
  ds_read_b64_tr_b16 a[88:89], v11 offset:21568
  v_mfma_f32_16x16x32_bf16 v[132:135], a[36:39], a[12:15], v[132:135]
  ds_read_b64_tr_b16 a[90:91], v11 offset:25152
  v_mfma_f32_16x16x32_bf16 v[24:27], a[24:27], a[0:3], v[24:27]
  ds_read_b64_tr_b16 a[76:77], v11 offset:14432
  v_mfma_f32_16x16x32_bf16 v[56:59], a[24:27], a[4:7], v[56:59]
  ds_read_b64_tr_b16 a[78:79], v11 offset:18016
  v_mfma_f32_16x16x32_bf16 v[88:91], a[24:27], a[8:11], v[88:91]
  ds_read_b64_tr_b16 a[92:93], v11 offset:21600
  v_mfma_f32_16x16x32_bf16 v[120:123], a[24:27], a[12:15], v[120:123]
  ds_read_b64_tr_b16 a[94:95], v11 offset:25184
  v_mfma_f32_16x16x32_bf16 v[40:43], a[40:43], a[0:3], v[40:43]
  s_add_u32 m0, s44, 35328
  s_nop 0
  buffer_load_dwordx4 v5, s[12:15], s29 offen offset:512 lds
  v_mfma_f32_16x16x32_bf16 v[72:75], a[40:43], a[4:7], v[72:75]
  v_mfma_f32_16x16x32_bf16 v[104:107], a[40:43], a[8:11], v[104:107]
  v_mfma_f32_16x16x32_bf16 v[136:139], a[40:43], a[12:15], v[136:139]
  v_mfma_f32_16x16x32_bf16 v[28:31], a[28:31], a[0:3], v[28:31]
  v_mfma_f32_16x16x32_bf16 v[60:63], a[28:31], a[4:7], v[60:63]
  v_mfma_f32_16x16x32_bf16 v[92:95], a[28:31], a[8:11], v[92:95]
  v_mfma_f32_16x16x32_bf16 v[124:127], a[28:31], a[12:15], v[124:127]
  v_mfma_f32_16x16x32_bf16 v[44:47], a[44:47], a[0:3], v[44:47]
  v_mfma_f32_16x16x32_bf16 v[76:79], a[44:47], a[4:7], v[76:79]
  v_mfma_f32_16x16x32_bf16 v[108:111], a[44:47], a[8:11], v[108:111]
  v_mfma_f32_16x16x32_bf16 v[140:143], a[44:47], a[12:15], v[140:143]
  s_waitcnt vmcnt(8) lgkmcnt(0)
  s_barrier
  v_mfma_f32_16x16x32_bf16 v[16:19], a[64:67], a[48:51], v[16:19]
  ds_read_b128 a[0:3], v7 offset:0
  v_mfma_f32_16x16x32_bf16 v[48:51], a[64:67], a[52:55], v[48:51]
  ds_read_b128 a[4:7], v7 offset:2048
  v_mfma_f32_16x16x32_bf16 v[80:83], a[64:67], a[56:59], v[80:83]
  ds_read_b128 a[8:11], v7 offset:4096
  v_mfma_f32_16x16x32_bf16 v[112:115], a[64:67], a[60:63], v[112:115]
  ds_read_b128 a[12:15], v7 offset:6144
  s_mov_b64 exec, s[36:37]
  s_add_u32 m0, s45, 14336
  s_add_u32 s40, s31, 2064384
  buffer_load_dwordx4 v6, s[16:19], s40 offen lds
  s_add_u32 m0, s45, 15232
  s_add_u32 s40, s31, 2121728
  buffer_load_dwordx4 v6, s[16:19], s40 offen lds
  s_mov_b64 exec, -1
  v_mfma_f32_16x16x32_bf16 v[32:35], a[80:83], a[48:51], v[32:35]
  ds_read_b64_tr_b16 a[16:17], v11 offset:28672
  v_mfma_f32_16x16x32_bf16 v[64:67], a[80:83], a[52:55], v[64:67]
  ds_read_b64_tr_b16 a[18:19], v11 offset:32256
  v_mfma_f32_16x16x32_bf16 v[96:99], a[80:83], a[56:59], v[96:99]
  ds_read_b64_tr_b16 a[32:33], v11 offset:35840
  v_mfma_f32_16x16x32_bf16 v[128:131], a[80:83], a[60:63], v[128:131]
  ds_read_b64_tr_b16 a[34:35], v11 offset:39424
  v_mfma_f32_16x16x32_bf16 v[20:23], a[68:71], a[48:51], v[20:23]
  ds_read_b64_tr_b16 a[20:21], v11 offset:28704
  v_mfma_f32_16x16x32_bf16 v[52:55], a[68:71], a[52:55], v[52:55]
  ds_read_b64_tr_b16 a[22:23], v11 offset:32288
  v_mfma_f32_16x16x32_bf16 v[84:87], a[68:71], a[56:59], v[84:87]
  ds_read_b64_tr_b16 a[36:37], v11 offset:35872
  v_mfma_f32_16x16x32_bf16 v[116:119], a[68:71], a[60:63], v[116:119]
  ds_read_b64_tr_b16 a[38:39], v11 offset:39456
  v_mfma_f32_16x16x32_bf16 v[36:39], a[84:87], a[48:51], v[36:39]
  ds_read_b64_tr_b16 a[24:25], v11 offset:28736
  s_add_u32 m0, s44, 64896
  s_nop 0
  buffer_load_dwordx4 v2, s[12:15], s29 offen offset:640 lds
  v_mfma_f32_16x16x32_bf16 v[68:71], a[84:87], a[52:55], v[68:71]
  ds_read_b64_tr_b16 a[26:27], v11 offset:32320
  v_mfma_f32_16x16x32_bf16 v[100:103], a[84:87], a[56:59], v[100:103]
  ds_read_b64_tr_b16 a[40:41], v11 offset:35904
  v_mfma_f32_16x16x32_bf16 v[132:135], a[84:87], a[60:63], v[132:135]
  ds_read_b64_tr_b16 a[42:43], v11 offset:39488
  v_mfma_f32_16x16x32_bf16 v[24:27], a[72:75], a[48:51], v[24:27]
  ds_read_b64_tr_b16 a[28:29], v11 offset:28768
  v_mfma_f32_16x16x32_bf16 v[56:59], a[72:75], a[52:55], v[56:59]
  ds_read_b64_tr_b16 a[30:31], v11 offset:32352
  v_mfma_f32_16x16x32_bf16 v[88:91], a[72:75], a[56:59], v[88:91]
  ds_read_b64_tr_b16 a[44:45], v11 offset:35936
  v_mfma_f32_16x16x32_bf16 v[120:123], a[72:75], a[60:63], v[120:123]
  ds_read_b64_tr_b16 a[46:47], v11 offset:39520
  v_mfma_f32_16x16x32_bf16 v[40:43], a[88:91], a[48:51], v[40:43]
  s_add_u32 m0, s44, 65920
  s_nop 0
  buffer_load_dwordx4 v3, s[12:15], s29 offen offset:640 lds
  v_mfma_f32_16x16x32_bf16 v[72:75], a[88:91], a[52:55], v[72:75]
  v_mfma_f32_16x16x32_bf16 v[104:107], a[88:91], a[56:59], v[104:107]
  v_mfma_f32_16x16x32_bf16 v[136:139], a[88:91], a[60:63], v[136:139]
  v_mfma_f32_16x16x32_bf16 v[28:31], a[76:79], a[48:51], v[28:31]
  v_mfma_f32_16x16x32_bf16 v[60:63], a[76:79], a[52:55], v[60:63]
  v_mfma_f32_16x16x32_bf16 v[92:95], a[76:79], a[56:59], v[92:95]
  v_mfma_f32_16x16x32_bf16 v[124:127], a[76:79], a[60:63], v[124:127]
  v_mfma_f32_16x16x32_bf16 v[44:47], a[92:95], a[48:51], v[44:47]
  v_mfma_f32_16x16x32_bf16 v[76:79], a[92:95], a[52:55], v[76:79]
  v_mfma_f32_16x16x32_bf16 v[108:111], a[92:95], a[56:59], v[108:111]
  v_mfma_f32_16x16x32_bf16 v[140:143], a[92:95], a[60:63], v[140:143]
  s_waitcnt vmcnt(10) lgkmcnt(0)
  s_barrier
  v_mfma_f32_16x16x32_bf16 v[16:19], a[16:19], a[0:3], v[16:19]
  ds_read_b128 a[48:51], v8 offset:0
  v_mfma_f32_16x16x32_bf16 v[48:51], a[16:19], a[4:7], v[48:51]
  ds_read_b128 a[52:55], v8 offset:2048
  v_mfma_f32_16x16x32_bf16 v[80:83], a[16:19], a[8:11], v[80:83]
  ds_read_b128 a[56:59], v8 offset:4096
  v_mfma_f32_16x16x32_bf16 v[112:115], a[16:19], a[12:15], v[112:115]
  ds_read_b128 a[60:63], v8 offset:6144
  s_mov_b64 exec, s[36:37]
  s_add_u32 m0, s45, 28672
  s_add_u32 s40, s31, 2293760
  buffer_load_dwordx4 v6, s[16:19], s40 offen lds
  s_add_u32 m0, s45, 29568
  s_add_u32 s40, s31, 2351104
  buffer_load_dwordx4 v6, s[16:19], s40 offen lds
  s_mov_b64 exec, -1
  v_mfma_f32_16x16x32_bf16 v[32:35], a[32:35], a[0:3], v[32:35]
  ds_read_b64_tr_b16 a[64:65], v11 offset:43008
  v_mfma_f32_16x16x32_bf16 v[64:67], a[32:35], a[4:7], v[64:67]
  ds_read_b64_tr_b16 a[66:67], v11 offset:46592
  v_mfma_f32_16x16x32_bf16 v[96:99], a[32:35], a[8:11], v[96:99]
  ds_read_b64_tr_b16 a[80:81], v11 offset:50176
  v_mfma_f32_16x16x32_bf16 v[128:131], a[32:35], a[12:15], v[128:131]
  ds_read_b64_tr_b16 a[82:83], v11 offset:53760
  v_mfma_f32_16x16x32_bf16 v[20:23], a[20:23], a[0:3], v[20:23]
  ds_read_b64_tr_b16 a[68:69], v11 offset:43040
  v_mfma_f32_16x16x32_bf16 v[52:55], a[20:23], a[4:7], v[52:55]
  ds_read_b64_tr_b16 a[70:71], v11 offset:46624
  v_mfma_f32_16x16x32_bf16 v[84:87], a[20:23], a[8:11], v[84:87]
  ds_read_b64_tr_b16 a[84:85], v11 offset:50208
  v_mfma_f32_16x16x32_bf16 v[116:119], a[20:23], a[12:15], v[116:119]
  ds_read_b64_tr_b16 a[86:87], v11 offset:53792
  v_mfma_f32_16x16x32_bf16 v[36:39], a[36:39], a[0:3], v[36:39]
  ds_read_b64_tr_b16 a[72:73], v11 offset:43072
  s_add_u32 m0, s44, 66944
  s_nop 0
  buffer_load_dwordx4 v4, s[12:15], s29 offen offset:640 lds
  v_mfma_f32_16x16x32_bf16 v[68:71], a[36:39], a[4:7], v[68:71]
  ds_read_b64_tr_b16 a[74:75], v11 offset:46656
  v_mfma_f32_16x16x32_bf16 v[100:103], a[36:39], a[8:11], v[100:103]
  ds_read_b64_tr_b16 a[88:89], v11 offset:50240
  v_mfma_f32_16x16x32_bf16 v[132:135], a[36:39], a[12:15], v[132:135]
  ds_read_b64_tr_b16 a[90:91], v11 offset:53824
  v_mfma_f32_16x16x32_bf16 v[24:27], a[24:27], a[0:3], v[24:27]
  ds_read_b64_tr_b16 a[76:77], v11 offset:43104
  v_mfma_f32_16x16x32_bf16 v[56:59], a[24:27], a[4:7], v[56:59]
  ds_read_b64_tr_b16 a[78:79], v11 offset:46688
  v_mfma_f32_16x16x32_bf16 v[88:91], a[24:27], a[8:11], v[88:91]
  ds_read_b64_tr_b16 a[92:93], v11 offset:50272
  v_mfma_f32_16x16x32_bf16 v[120:123], a[24:27], a[12:15], v[120:123]
  ds_read_b64_tr_b16 a[94:95], v11 offset:53856
  v_mfma_f32_16x16x32_bf16 v[40:43], a[40:43], a[0:3], v[40:43]
  s_add_u32 m0, s44, 67968
  s_nop 0
  buffer_load_dwordx4 v5, s[12:15], s29 offen offset:640 lds
  v_mfma_f32_16x16x32_bf16 v[72:75], a[40:43], a[4:7], v[72:75]
  v_mfma_f32_16x16x32_bf16 v[104:107], a[40:43], a[8:11], v[104:107]
  v_mfma_f32_16x16x32_bf16 v[136:139], a[40:43], a[12:15], v[136:139]
  v_mfma_f32_16x16x32_bf16 v[28:31], a[28:31], a[0:3], v[28:31]
  v_mfma_f32_16x16x32_bf16 v[60:63], a[28:31], a[4:7], v[60:63]
  v_mfma_f32_16x16x32_bf16 v[92:95], a[28:31], a[8:11], v[92:95]
  v_mfma_f32_16x16x32_bf16 v[124:127], a[28:31], a[12:15], v[124:127]
  v_mfma_f32_16x16x32_bf16 v[44:47], a[44:47], a[0:3], v[44:47]
  v_mfma_f32_16x16x32_bf16 v[76:79], a[44:47], a[4:7], v[76:79]
  v_mfma_f32_16x16x32_bf16 v[108:111], a[44:47], a[8:11], v[108:111]
  v_mfma_f32_16x16x32_bf16 v[140:143], a[44:47], a[12:15], v[140:143]
  s_waitcnt vmcnt(8) lgkmcnt(0)
  s_barrier
  v_mfma_f32_16x16x32_bf16 v[16:19], a[64:67], a[48:51], v[16:19]
  ds_read_b128 a[0:3], v7 offset:32768
  v_mfma_f32_16x16x32_bf16 v[48:51], a[64:67], a[52:55], v[48:51]
  ds_read_b128 a[4:7], v7 offset:34816
  v_mfma_f32_16x16x32_bf16 v[80:83], a[64:67], a[56:59], v[80:83]
  ds_read_b128 a[8:11], v7 offset:36864
  v_mfma_f32_16x16x32_bf16 v[112:115], a[64:67], a[60:63], v[112:115]
  ds_read_b128 a[12:15], v7 offset:38912
  s_mov_b64 exec, s[36:37]
  s_add_u32 m0, s45, 43008
  s_add_u32 s40, s31, 2523136
  buffer_load_dwordx4 v6, s[16:19], s40 offen lds
  s_add_u32 m0, s45, 43904
  s_add_u32 s40, s31, 2580480
  buffer_load_dwordx4 v6, s[16:19], s40 offen lds
  s_mov_b64 exec, -1
  v_mfma_f32_16x16x32_bf16 v[32:35], a[80:83], a[48:51], v[32:35]
  ds_read_b64_tr_b16 a[16:17], v11 offset:0
  v_mfma_f32_16x16x32_bf16 v[64:67], a[80:83], a[52:55], v[64:67]
  ds_read_b64_tr_b16 a[18:19], v11 offset:3584
  v_mfma_f32_16x16x32_bf16 v[96:99], a[80:83], a[56:59], v[96:99]
  ds_read_b64_tr_b16 a[32:33], v11 offset:7168
  v_mfma_f32_16x16x32_bf16 v[128:131], a[80:83], a[60:63], v[128:131]
  ds_read_b64_tr_b16 a[34:35], v11 offset:10752
  v_mfma_f32_16x16x32_bf16 v[20:23], a[68:71], a[48:51], v[20:23]
  ds_read_b64_tr_b16 a[20:21], v11 offset:32
  v_mfma_f32_16x16x32_bf16 v[52:55], a[68:71], a[52:55], v[52:55]
  ds_read_b64_tr_b16 a[22:23], v11 offset:3616
  v_mfma_f32_16x16x32_bf16 v[84:87], a[68:71], a[56:59], v[84:87]
  ds_read_b64_tr_b16 a[36:37], v11 offset:7200
  v_mfma_f32_16x16x32_bf16 v[116:119], a[68:71], a[60:63], v[116:119]
  ds_read_b64_tr_b16 a[38:39], v11 offset:10784
  v_mfma_f32_16x16x32_bf16 v[36:39], a[84:87], a[48:51], v[36:39]
  ds_read_b64_tr_b16 a[24:25], v11 offset:64
  s_add_u32 m0, s44, 4294966528
  s_nop 0
  buffer_load_dwordx4 v2, s[12:15], s29 offen offset:768 lds
  v_mfma_f32_16x16x32_bf16 v[68:71], a[84:87], a[52:55], v[68:71]
  ds_read_b64_tr_b16 a[26:27], v11 offset:3648
  v_mfma_f32_16x16x32_bf16 v[100:103], a[84:87], a[56:59], v[100:103]
  ds_read_b64_tr_b16 a[40:41], v11 offset:7232
  v_mfma_f32_16x16x32_bf16 v[132:135], a[84:87], a[60:63], v[132:135]
  ds_read_b64_tr_b16 a[42:43], v11 offset:10816
  v_mfma_f32_16x16x32_bf16 v[24:27], a[72:75], a[48:51], v[24:27]
  ds_read_b64_tr_b16 a[28:29], v11 offset:96
  v_mfma_f32_16x16x32_bf16 v[56:59], a[72:75], a[52:55], v[56:59]
  ds_read_b64_tr_b16 a[30:31], v11 offset:3680
  v_mfma_f32_16x16x32_bf16 v[88:91], a[72:75], a[56:59], v[88:91]
  ds_read_b64_tr_b16 a[44:45], v11 offset:7264
  v_mfma_f32_16x16x32_bf16 v[120:123], a[72:75], a[60:63], v[120:123]
  ds_read_b64_tr_b16 a[46:47], v11 offset:10848
  v_mfma_f32_16x16x32_bf16 v[40:43], a[88:91], a[48:51], v[40:43]
  s_add_u32 m0, s44, 256
  s_nop 0
  buffer_load_dwordx4 v3, s[12:15], s29 offen offset:768 lds
  v_mfma_f32_16x16x32_bf16 v[72:75], a[88:91], a[52:55], v[72:75]
  v_mfma_f32_16x16x32_bf16 v[104:107], a[88:91], a[56:59], v[104:107]
  v_mfma_f32_16x16x32_bf16 v[136:139], a[88:91], a[60:63], v[136:139]
  v_mfma_f32_16x16x32_bf16 v[28:31], a[76:79], a[48:51], v[28:31]
  v_mfma_f32_16x16x32_bf16 v[60:63], a[76:79], a[52:55], v[60:63]
  v_mfma_f32_16x16x32_bf16 v[92:95], a[76:79], a[56:59], v[92:95]
  v_mfma_f32_16x16x32_bf16 v[124:127], a[76:79], a[60:63], v[124:127]
  v_mfma_f32_16x16x32_bf16 v[44:47], a[92:95], a[48:51], v[44:47]
  v_mfma_f32_16x16x32_bf16 v[76:79], a[92:95], a[52:55], v[76:79]
  v_mfma_f32_16x16x32_bf16 v[108:111], a[92:95], a[56:59], v[108:111]
  v_mfma_f32_16x16x32_bf16 v[140:143], a[92:95], a[60:63], v[140:143]
  s_waitcnt vmcnt(10) lgkmcnt(0)
  s_barrier
  v_mfma_f32_16x16x32_bf16 v[16:19], a[16:19], a[0:3], v[16:19]
  ds_read_b128 a[48:51], v8 offset:32768
  v_mfma_f32_16x16x32_bf16 v[48:51], a[16:19], a[4:7], v[48:51]
  ds_read_b128 a[52:55], v8 offset:34816
  v_mfma_f32_16x16x32_bf16 v[80:83], a[16:19], a[8:11], v[80:83]
  ds_read_b128 a[56:59], v8 offset:36864
  v_mfma_f32_16x16x32_bf16 v[112:115], a[16:19], a[12:15], v[112:115]
  ds_read_b128 a[60:63], v8 offset:38912
  s_mov_b64 exec, s[36:37]
  s_add_u32 m0, s45, 0
  s_add_u32 s40, s31, 2752512
  buffer_load_dwordx4 v6, s[16:19], s40 offen lds
  s_add_u32 m0, s45, 896
  s_add_u32 s40, s31, 2809856
  buffer_load_dwordx4 v6, s[16:19], s40 offen lds
  s_mov_b64 exec, -1
  v_mfma_f32_16x16x32_bf16 v[32:35], a[32:35], a[0:3], v[32:35]
  ds_read_b64_tr_b16 a[64:65], v11 offset:14336
  v_mfma_f32_16x16x32_bf16 v[64:67], a[32:35], a[4:7], v[64:67]
  ds_read_b64_tr_b16 a[66:67], v11 offset:17920
  v_mfma_f32_16x16x32_bf16 v[96:99], a[32:35], a[8:11], v[96:99]
  ds_read_b64_tr_b16 a[80:81], v11 offset:21504
  v_mfma_f32_16x16x32_bf16 v[128:131], a[32:35], a[12:15], v[128:131]
  ds_read_b64_tr_b16 a[82:83], v11 offset:25088
  v_mfma_f32_16x16x32_bf16 v[20:23], a[20:23], a[0:3], v[20:23]
  ds_read_b64_tr_b16 a[68:69], v11 offset:14368
  v_mfma_f32_16x16x32_bf16 v[52:55], a[20:23], a[4:7], v[52:55]
  ds_read_b64_tr_b16 a[70:71], v11 offset:17952
  v_mfma_f32_16x16x32_bf16 v[84:87], a[20:23], a[8:11], v[84:87]
  ds_read_b64_tr_b16 a[84:85], v11 offset:21536
  v_mfma_f32_16x16x32_bf16 v[116:119], a[20:23], a[12:15], v[116:119]
  ds_read_b64_tr_b16 a[86:87], v11 offset:25120
  v_mfma_f32_16x16x32_bf16 v[36:39], a[36:39], a[0:3], v[36:39]
  ds_read_b64_tr_b16 a[72:73], v11 offset:14400
  s_add_u32 m0, s44, 1280
  s_nop 0
  buffer_load_dwordx4 v4, s[12:15], s29 offen offset:768 lds
  v_mfma_f32_16x16x32_bf16 v[68:71], a[36:39], a[4:7], v[68:71]
  ds_read_b64_tr_b16 a[74:75], v11 offset:17984
  v_mfma_f32_16x16x32_bf16 v[100:103], a[36:39], a[8:11], v[100:103]
  ds_read_b64_tr_b16 a[88:89], v11 offset:21568
  v_mfma_f32_16x16x32_bf16 v[132:135], a[36:39], a[12:15], v[132:135]
  ds_read_b64_tr_b16 a[90:91], v11 offset:25152
  v_mfma_f32_16x16x32_bf16 v[24:27], a[24:27], a[0:3], v[24:27]
  ds_read_b64_tr_b16 a[76:77], v11 offset:14432
  v_mfma_f32_16x16x32_bf16 v[56:59], a[24:27], a[4:7], v[56:59]
  ds_read_b64_tr_b16 a[78:79], v11 offset:18016
  v_mfma_f32_16x16x32_bf16 v[88:91], a[24:27], a[8:11], v[88:91]
  ds_read_b64_tr_b16 a[92:93], v11 offset:21600
  v_mfma_f32_16x16x32_bf16 v[120:123], a[24:27], a[12:15], v[120:123]
  ds_read_b64_tr_b16 a[94:95], v11 offset:25184
  v_mfma_f32_16x16x32_bf16 v[40:43], a[40:43], a[0:3], v[40:43]
  s_add_u32 m0, s44, 2304
  s_nop 0
  buffer_load_dwordx4 v5, s[12:15], s29 offen offset:768 lds
  v_mfma_f32_16x16x32_bf16 v[72:75], a[40:43], a[4:7], v[72:75]
  v_mfma_f32_16x16x32_bf16 v[104:107], a[40:43], a[8:11], v[104:107]
  v_mfma_f32_16x16x32_bf16 v[136:139], a[40:43], a[12:15], v[136:139]
  v_mfma_f32_16x16x32_bf16 v[28:31], a[28:31], a[0:3], v[28:31]
  v_mfma_f32_16x16x32_bf16 v[60:63], a[28:31], a[4:7], v[60:63]
  v_mfma_f32_16x16x32_bf16 v[92:95], a[28:31], a[8:11], v[92:95]
  v_mfma_f32_16x16x32_bf16 v[124:127], a[28:31], a[12:15], v[124:127]
  v_mfma_f32_16x16x32_bf16 v[44:47], a[44:47], a[0:3], v[44:47]
  v_mfma_f32_16x16x32_bf16 v[76:79], a[44:47], a[4:7], v[76:79]
  v_mfma_f32_16x16x32_bf16 v[108:111], a[44:47], a[8:11], v[108:111]
  v_mfma_f32_16x16x32_bf16 v[140:143], a[44:47], a[12:15], v[140:143]
  s_waitcnt vmcnt(8) lgkmcnt(0)
  s_barrier
  v_mfma_f32_16x16x32_bf16 v[16:19], a[64:67], a[48:51], v[16:19]
  ds_read_b128 a[0:3], v9 offset:0
  v_mfma_f32_16x16x32_bf16 v[48:51], a[64:67], a[52:55], v[48:51]
  ds_read_b128 a[4:7], v9 offset:2048
  v_mfma_f32_16x16x32_bf16 v[80:83], a[64:67], a[56:59], v[80:83]
  ds_read_b128 a[8:11], v9 offset:4096
  v_mfma_f32_16x16x32_bf16 v[112:115], a[64:67], a[60:63], v[112:115]
  ds_read_b128 a[12:15], v9 offset:6144
  s_mov_b64 exec, s[36:37]
  s_add_u32 m0, s45, 14336
  s_add_u32 s40, s31, 2981888
  buffer_load_dwordx4 v6, s[16:19], s40 offen lds
  s_add_u32 m0, s45, 15232
  s_add_u32 s40, s31, 3039232
  buffer_load_dwordx4 v6, s[16:19], s40 offen lds
  s_mov_b64 exec, -1
  v_mfma_f32_16x16x32_bf16 v[32:35], a[80:83], a[48:51], v[32:35]
  ds_read_b64_tr_b16 a[16:17], v11 offset:28672
  v_mfma_f32_16x16x32_bf16 v[64:67], a[80:83], a[52:55], v[64:67]
  ds_read_b64_tr_b16 a[18:19], v11 offset:32256
  v_mfma_f32_16x16x32_bf16 v[96:99], a[80:83], a[56:59], v[96:99]
  ds_read_b64_tr_b16 a[32:33], v11 offset:35840
  v_mfma_f32_16x16x32_bf16 v[128:131], a[80:83], a[60:63], v[128:131]
  ds_read_b64_tr_b16 a[34:35], v11 offset:39424
  v_mfma_f32_16x16x32_bf16 v[20:23], a[68:71], a[48:51], v[20:23]
  ds_read_b64_tr_b16 a[20:21], v11 offset:28704
  v_mfma_f32_16x16x32_bf16 v[52:55], a[68:71], a[52:55], v[52:55]
  ds_read_b64_tr_b16 a[22:23], v11 offset:32288
  v_mfma_f32_16x16x32_bf16 v[84:87], a[68:71], a[56:59], v[84:87]
  ds_read_b64_tr_b16 a[36:37], v11 offset:35872
  v_mfma_f32_16x16x32_bf16 v[116:119], a[68:71], a[60:63], v[116:119]
  ds_read_b64_tr_b16 a[38:39], v11 offset:39456
  v_mfma_f32_16x16x32_bf16 v[36:39], a[84:87], a[48:51], v[36:39]
  ds_read_b64_tr_b16 a[24:25], v11 offset:28736
  s_add_u32 m0, s44, 31872
  s_nop 0
  buffer_load_dwordx4 v2, s[12:15], s29 offen offset:896 lds
  v_mfma_f32_16x16x32_bf16 v[68:71], a[84:87], a[52:55], v[68:71]
  ds_read_b64_tr_b16 a[26:27], v11 offset:32320
  v_mfma_f32_16x16x32_bf16 v[100:103], a[84:87], a[56:59], v[100:103]
  ds_read_b64_tr_b16 a[40:41], v11 offset:35904
  v_mfma_f32_16x16x32_bf16 v[132:135], a[84:87], a[60:63], v[132:135]
  ds_read_b64_tr_b16 a[42:43], v11 offset:39488
  v_mfma_f32_16x16x32_bf16 v[24:27], a[72:75], a[48:51], v[24:27]
  ds_read_b64_tr_b16 a[28:29], v11 offset:28768
  v_mfma_f32_16x16x32_bf16 v[56:59], a[72:75], a[52:55], v[56:59]
  ds_read_b64_tr_b16 a[30:31], v11 offset:32352
  v_mfma_f32_16x16x32_bf16 v[88:91], a[72:75], a[56:59], v[88:91]
  ds_read_b64_tr_b16 a[44:45], v11 offset:35936
  v_mfma_f32_16x16x32_bf16 v[120:123], a[72:75], a[60:63], v[120:123]
  ds_read_b64_tr_b16 a[46:47], v11 offset:39520
  v_mfma_f32_16x16x32_bf16 v[40:43], a[88:91], a[48:51], v[40:43]
  s_add_u32 m0, s44, 32896
  s_nop 0
  buffer_load_dwordx4 v3, s[12:15], s29 offen offset:896 lds
  v_mfma_f32_16x16x32_bf16 v[72:75], a[88:91], a[52:55], v[72:75]
  v_mfma_f32_16x16x32_bf16 v[104:107], a[88:91], a[56:59], v[104:107]
  v_mfma_f32_16x16x32_bf16 v[136:139], a[88:91], a[60:63], v[136:139]
  v_mfma_f32_16x16x32_bf16 v[28:31], a[76:79], a[48:51], v[28:31]
  v_mfma_f32_16x16x32_bf16 v[60:63], a[76:79], a[52:55], v[60:63]
  v_mfma_f32_16x16x32_bf16 v[92:95], a[76:79], a[56:59], v[92:95]
  v_mfma_f32_16x16x32_bf16 v[124:127], a[76:79], a[60:63], v[124:127]
  v_mfma_f32_16x16x32_bf16 v[44:47], a[92:95], a[48:51], v[44:47]
  v_mfma_f32_16x16x32_bf16 v[76:79], a[92:95], a[52:55], v[76:79]
  v_mfma_f32_16x16x32_bf16 v[108:111], a[92:95], a[56:59], v[108:111]
  v_mfma_f32_16x16x32_bf16 v[140:143], a[92:95], a[60:63], v[140:143]
  s_waitcnt vmcnt(10) lgkmcnt(0)
  s_barrier
  v_mfma_f32_16x16x32_bf16 v[16:19], a[16:19], a[0:3], v[16:19]
  ds_read_b128 a[48:51], v10 offset:0
  v_mfma_f32_16x16x32_bf16 v[48:51], a[16:19], a[4:7], v[48:51]
  ds_read_b128 a[52:55], v10 offset:2048
  v_mfma_f32_16x16x32_bf16 v[80:83], a[16:19], a[8:11], v[80:83]
  ds_read_b128 a[56:59], v10 offset:4096
  v_mfma_f32_16x16x32_bf16 v[112:115], a[16:19], a[12:15], v[112:115]
  ds_read_b128 a[60:63], v10 offset:6144
  s_mov_b64 exec, s[36:37]
  s_add_u32 m0, s45, 28672
  s_add_u32 s40, s31, 3211264
  buffer_load_dwordx4 v6, s[16:19], s40 offen lds
  s_add_u32 m0, s45, 29568
  s_add_u32 s40, s31, 3268608
  buffer_load_dwordx4 v6, s[16:19], s40 offen lds
  s_mov_b64 exec, -1
  v_mfma_f32_16x16x32_bf16 v[32:35], a[32:35], a[0:3], v[32:35]
  ds_read_b64_tr_b16 a[64:65], v11 offset:43008
  v_mfma_f32_16x16x32_bf16 v[64:67], a[32:35], a[4:7], v[64:67]
  ds_read_b64_tr_b16 a[66:67], v11 offset:46592
  v_mfma_f32_16x16x32_bf16 v[96:99], a[32:35], a[8:11], v[96:99]
  ds_read_b64_tr_b16 a[80:81], v11 offset:50176
  v_mfma_f32_16x16x32_bf16 v[128:131], a[32:35], a[12:15], v[128:131]
  ds_read_b64_tr_b16 a[82:83], v11 offset:53760
  v_mfma_f32_16x16x32_bf16 v[20:23], a[20:23], a[0:3], v[20:23]
  ds_read_b64_tr_b16 a[68:69], v11 offset:43040
  v_mfma_f32_16x16x32_bf16 v[52:55], a[20:23], a[4:7], v[52:55]
  ds_read_b64_tr_b16 a[70:71], v11 offset:46624
  v_mfma_f32_16x16x32_bf16 v[84:87], a[20:23], a[8:11], v[84:87]
  ds_read_b64_tr_b16 a[84:85], v11 offset:50208
  v_mfma_f32_16x16x32_bf16 v[116:119], a[20:23], a[12:15], v[116:119]
  ds_read_b64_tr_b16 a[86:87], v11 offset:53792
  v_mfma_f32_16x16x32_bf16 v[36:39], a[36:39], a[0:3], v[36:39]
  ds_read_b64_tr_b16 a[72:73], v11 offset:43072
  s_add_u32 m0, s44, 33920
  s_nop 0
  buffer_load_dwordx4 v4, s[12:15], s29 offen offset:896 lds
  v_mfma_f32_16x16x32_bf16 v[68:71], a[36:39], a[4:7], v[68:71]
  ds_read_b64_tr_b16 a[74:75], v11 offset:46656
  v_mfma_f32_16x16x32_bf16 v[100:103], a[36:39], a[8:11], v[100:103]
  ds_read_b64_tr_b16 a[88:89], v11 offset:50240
  v_mfma_f32_16x16x32_bf16 v[132:135], a[36:39], a[12:15], v[132:135]
  ds_read_b64_tr_b16 a[90:91], v11 offset:53824
  v_mfma_f32_16x16x32_bf16 v[24:27], a[24:27], a[0:3], v[24:27]
  ds_read_b64_tr_b16 a[76:77], v11 offset:43104
  v_mfma_f32_16x16x32_bf16 v[56:59], a[24:27], a[4:7], v[56:59]
  ds_read_b64_tr_b16 a[78:79], v11 offset:46688
  v_mfma_f32_16x16x32_bf16 v[88:91], a[24:27], a[8:11], v[88:91]
  ds_read_b64_tr_b16 a[92:93], v11 offset:50272
  v_mfma_f32_16x16x32_bf16 v[120:123], a[24:27], a[12:15], v[120:123]
  ds_read_b64_tr_b16 a[94:95], v11 offset:53856
  v_mfma_f32_16x16x32_bf16 v[40:43], a[40:43], a[0:3], v[40:43]
  s_add_u32 m0, s44, 34944
  s_nop 0
  buffer_load_dwordx4 v5, s[12:15], s29 offen offset:896 lds
  v_mfma_f32_16x16x32_bf16 v[72:75], a[40:43], a[4:7], v[72:75]
  v_mfma_f32_16x16x32_bf16 v[104:107], a[40:43], a[8:11], v[104:107]
  v_mfma_f32_16x16x32_bf16 v[136:139], a[40:43], a[12:15], v[136:139]
  v_mfma_f32_16x16x32_bf16 v[28:31], a[28:31], a[0:3], v[28:31]
  v_mfma_f32_16x16x32_bf16 v[60:63], a[28:31], a[4:7], v[60:63]
  v_mfma_f32_16x16x32_bf16 v[92:95], a[28:31], a[8:11], v[92:95]
  v_mfma_f32_16x16x32_bf16 v[124:127], a[28:31], a[12:15], v[124:127]
  v_mfma_f32_16x16x32_bf16 v[44:47], a[44:47], a[0:3], v[44:47]
  v_mfma_f32_16x16x32_bf16 v[76:79], a[44:47], a[4:7], v[76:79]
  v_mfma_f32_16x16x32_bf16 v[108:111], a[44:47], a[8:11], v[108:111]
  v_mfma_f32_16x16x32_bf16 v[140:143], a[44:47], a[12:15], v[140:143]
  s_waitcnt vmcnt(8) lgkmcnt(0)
  s_barrier
  v_mfma_f32_16x16x32_bf16 v[16:19], a[64:67], a[48:51], v[16:19]
  ds_read_b128 a[0:3], v7 offset:0
  v_mfma_f32_16x16x32_bf16 v[48:51], a[64:67], a[52:55], v[48:51]
  ds_read_b128 a[4:7], v7 offset:2048
  v_mfma_f32_16x16x32_bf16 v[80:83], a[64:67], a[56:59], v[80:83]
  ds_read_b128 a[8:11], v7 offset:4096
  v_mfma_f32_16x16x32_bf16 v[112:115], a[64:67], a[60:63], v[112:115]
  ds_read_b128 a[12:15], v7 offset:6144
  s_mov_b64 exec, s[36:37]
  s_add_u32 m0, s45, 43008
  s_add_u32 s40, s31, 3440640
  buffer_load_dwordx4 v6, s[16:19], s40 offen lds
  s_add_u32 m0, s45, 43904
  s_add_u32 s40, s31, 3497984
  buffer_load_dwordx4 v6, s[16:19], s40 offen lds
  s_mov_b64 exec, -1
  v_mfma_f32_16x16x32_bf16 v[32:35], a[80:83], a[48:51], v[32:35]
  ds_read_b64_tr_b16 a[16:17], v11 offset:0
  v_mfma_f32_16x16x32_bf16 v[64:67], a[80:83], a[52:55], v[64:67]
  ds_read_b64_tr_b16 a[18:19], v11 offset:3584
  v_mfma_f32_16x16x32_bf16 v[96:99], a[80:83], a[56:59], v[96:99]
  ds_read_b64_tr_b16 a[32:33], v11 offset:7168
  v_mfma_f32_16x16x32_bf16 v[128:131], a[80:83], a[60:63], v[128:131]
  ds_read_b64_tr_b16 a[34:35], v11 offset:10752
  v_mfma_f32_16x16x32_bf16 v[20:23], a[68:71], a[48:51], v[20:23]
  ds_read_b64_tr_b16 a[20:21], v11 offset:32
  v_mfma_f32_16x16x32_bf16 v[52:55], a[68:71], a[52:55], v[52:55]
  ds_read_b64_tr_b16 a[22:23], v11 offset:3616
  v_mfma_f32_16x16x32_bf16 v[84:87], a[68:71], a[56:59], v[84:87]
  ds_read_b64_tr_b16 a[36:37], v11 offset:7200
  v_mfma_f32_16x16x32_bf16 v[116:119], a[68:71], a[60:63], v[116:119]
  ds_read_b64_tr_b16 a[38:39], v11 offset:10784
  v_mfma_f32_16x16x32_bf16 v[36:39], a[84:87], a[48:51], v[36:39]
  ds_read_b64_tr_b16 a[24:25], v11 offset:64
  s_add_u32 m0, s44, 64512
  s_nop 0
  buffer_load_dwordx4 v2, s[12:15], s29 offen offset:1024 lds
  v_mfma_f32_16x16x32_bf16 v[68:71], a[84:87], a[52:55], v[68:71]
  ds_read_b64_tr_b16 a[26:27], v11 offset:3648
  v_mfma_f32_16x16x32_bf16 v[100:103], a[84:87], a[56:59], v[100:103]
  ds_read_b64_tr_b16 a[40:41], v11 offset:7232
  v_mfma_f32_16x16x32_bf16 v[132:135], a[84:87], a[60:63], v[132:135]
  ds_read_b64_tr_b16 a[42:43], v11 offset:10816
  v_mfma_f32_16x16x32_bf16 v[24:27], a[72:75], a[48:51], v[24:27]
  ds_read_b64_tr_b16 a[28:29], v11 offset:96
  v_mfma_f32_16x16x32_bf16 v[56:59], a[72:75], a[52:55], v[56:59]
  ds_read_b64_tr_b16 a[30:31], v11 offset:3680
  v_mfma_f32_16x16x32_bf16 v[88:91], a[72:75], a[56:59], v[88:91]
  ds_read_b64_tr_b16 a[44:45], v11 offset:7264
  v_mfma_f32_16x16x32_bf16 v[120:123], a[72:75], a[60:63], v[120:123]
  ds_read_b64_tr_b16 a[46:47], v11 offset:10848
  v_mfma_f32_16x16x32_bf16 v[40:43], a[88:91], a[48:51], v[40:43]
  s_add_u32 m0, s44, 65536
  s_nop 0
  buffer_load_dwordx4 v3, s[12:15], s29 offen offset:1024 lds
  v_mfma_f32_16x16x32_bf16 v[72:75], a[88:91], a[52:55], v[72:75]
  v_mfma_f32_16x16x32_bf16 v[104:107], a[88:91], a[56:59], v[104:107]
  v_mfma_f32_16x16x32_bf16 v[136:139], a[88:91], a[60:63], v[136:139]
  v_mfma_f32_16x16x32_bf16 v[28:31], a[76:79], a[48:51], v[28:31]
  v_mfma_f32_16x16x32_bf16 v[60:63], a[76:79], a[52:55], v[60:63]
  v_mfma_f32_16x16x32_bf16 v[92:95], a[76:79], a[56:59], v[92:95]
  v_mfma_f32_16x16x32_bf16 v[124:127], a[76:79], a[60:63], v[124:127]
  v_mfma_f32_16x16x32_bf16 v[44:47], a[92:95], a[48:51], v[44:47]
  v_mfma_f32_16x16x32_bf16 v[76:79], a[92:95], a[52:55], v[76:79]
  v_mfma_f32_16x16x32_bf16 v[108:111], a[92:95], a[56:59], v[108:111]
  v_mfma_f32_16x16x32_bf16 v[140:143], a[92:95], a[60:63], v[140:143]
  s_waitcnt vmcnt(10) lgkmcnt(0)
  s_barrier
  v_mfma_f32_16x16x32_bf16 v[16:19], a[16:19], a[0:3], v[16:19]
  ds_read_b128 a[48:51], v8 offset:0
  v_mfma_f32_16x16x32_bf16 v[48:51], a[16:19], a[4:7], v[48:51]
  ds_read_b128 a[52:55], v8 offset:2048
  v_mfma_f32_16x16x32_bf16 v[80:83], a[16:19], a[8:11], v[80:83]
  ds_read_b128 a[56:59], v8 offset:4096
  v_mfma_f32_16x16x32_bf16 v[112:115], a[16:19], a[12:15], v[112:115]
  ds_read_b128 a[60:63], v8 offset:6144
  s_mov_b64 exec, s[36:37]
  s_add_u32 m0, s45, 0
  s_add_u32 s40, s31, 3670016
  buffer_load_dwordx4 v6, s[16:19], s40 offen lds
  s_add_u32 m0, s45, 896
  s_add_u32 s40, s31, 3727360
  buffer_load_dwordx4 v6, s[16:19], s40 offen lds
  s_mov_b64 exec, -1
  v_mfma_f32_16x16x32_bf16 v[32:35], a[32:35], a[0:3], v[32:35]
  ds_read_b64_tr_b16 a[64:65], v11 offset:14336
  v_mfma_f32_16x16x32_bf16 v[64:67], a[32:35], a[4:7], v[64:67]
  ds_read_b64_tr_b16 a[66:67], v11 offset:17920
  v_mfma_f32_16x16x32_bf16 v[96:99], a[32:35], a[8:11], v[96:99]
  ds_read_b64_tr_b16 a[80:81], v11 offset:21504
  v_mfma_f32_16x16x32_bf16 v[128:131], a[32:35], a[12:15], v[128:131]
  ds_read_b64_tr_b16 a[82:83], v11 offset:25088
  v_mfma_f32_16x16x32_bf16 v[20:23], a[20:23], a[0:3], v[20:23]
  ds_read_b64_tr_b16 a[68:69], v11 offset:14368
  v_mfma_f32_16x16x32_bf16 v[52:55], a[20:23], a[4:7], v[52:55]
  ds_read_b64_tr_b16 a[70:71], v11 offset:17952
  v_mfma_f32_16x16x32_bf16 v[84:87], a[20:23], a[8:11], v[84:87]
  ds_read_b64_tr_b16 a[84:85], v11 offset:21536
  v_mfma_f32_16x16x32_bf16 v[116:119], a[20:23], a[12:15], v[116:119]
  ds_read_b64_tr_b16 a[86:87], v11 offset:25120
  v_mfma_f32_16x16x32_bf16 v[36:39], a[36:39], a[0:3], v[36:39]
  ds_read_b64_tr_b16 a[72:73], v11 offset:14400
  s_add_u32 m0, s44, 66560
  s_nop 0
  buffer_load_dwordx4 v4, s[12:15], s29 offen offset:1024 lds
  v_mfma_f32_16x16x32_bf16 v[68:71], a[36:39], a[4:7], v[68:71]
  ds_read_b64_tr_b16 a[74:75], v11 offset:17984
  v_mfma_f32_16x16x32_bf16 v[100:103], a[36:39], a[8:11], v[100:103]
  ds_read_b64_tr_b16 a[88:89], v11 offset:21568
  v_mfma_f32_16x16x32_bf16 v[132:135], a[36:39], a[12:15], v[132:135]
  ds_read_b64_tr_b16 a[90:91], v11 offset:25152
  v_mfma_f32_16x16x32_bf16 v[24:27], a[24:27], a[0:3], v[24:27]
  ds_read_b64_tr_b16 a[76:77], v11 offset:14432
  v_mfma_f32_16x16x32_bf16 v[56:59], a[24:27], a[4:7], v[56:59]
  ds_read_b64_tr_b16 a[78:79], v11 offset:18016
  v_mfma_f32_16x16x32_bf16 v[88:91], a[24:27], a[8:11], v[88:91]
  ds_read_b64_tr_b16 a[92:93], v11 offset:21600
  v_mfma_f32_16x16x32_bf16 v[120:123], a[24:27], a[12:15], v[120:123]
  ds_read_b64_tr_b16 a[94:95], v11 offset:25184
  v_mfma_f32_16x16x32_bf16 v[40:43], a[40:43], a[0:3], v[40:43]
  s_add_u32 m0, s44, 67584
  s_nop 0
  buffer_load_dwordx4 v5, s[12:15], s29 offen offset:1024 lds
  v_mfma_f32_16x16x32_bf16 v[72:75], a[40:43], a[4:7], v[72:75]
  v_mfma_f32_16x16x32_bf16 v[104:107], a[40:43], a[8:11], v[104:107]
  v_mfma_f32_16x16x32_bf16 v[136:139], a[40:43], a[12:15], v[136:139]
  v_mfma_f32_16x16x32_bf16 v[28:31], a[28:31], a[0:3], v[28:31]
  v_mfma_f32_16x16x32_bf16 v[60:63], a[28:31], a[4:7], v[60:63]
  v_mfma_f32_16x16x32_bf16 v[92:95], a[28:31], a[8:11], v[92:95]
  v_mfma_f32_16x16x32_bf16 v[124:127], a[28:31], a[12:15], v[124:127]
  v_mfma_f32_16x16x32_bf16 v[44:47], a[44:47], a[0:3], v[44:47]
  v_mfma_f32_16x16x32_bf16 v[76:79], a[44:47], a[4:7], v[76:79]
  v_mfma_f32_16x16x32_bf16 v[108:111], a[44:47], a[8:11], v[108:111]
  v_mfma_f32_16x16x32_bf16 v[140:143], a[44:47], a[12:15], v[140:143]
  s_waitcnt vmcnt(8) lgkmcnt(0)
  s_barrier
  v_mfma_f32_16x16x32_bf16 v[16:19], a[64:67], a[48:51], v[16:19]
  ds_read_b128 a[0:3], v7 offset:32768
  v_mfma_f32_16x16x32_bf16 v[48:51], a[64:67], a[52:55], v[48:51]
  ds_read_b128 a[4:7], v7 offset:34816
  v_mfma_f32_16x16x32_bf16 v[80:83], a[64:67], a[56:59], v[80:83]
  ds_read_b128 a[8:11], v7 offset:36864
  v_mfma_f32_16x16x32_bf16 v[112:115], a[64:67], a[60:63], v[112:115]
  ds_read_b128 a[12:15], v7 offset:38912
  s_mov_b64 exec, s[36:37]
  s_add_u32 m0, s45, 14336
  s_add_u32 s40, s31, 3899392
  buffer_load_dwordx4 v6, s[16:19], s40 offen lds
  s_add_u32 m0, s45, 15232
  s_add_u32 s40, s31, 3956736
  buffer_load_dwordx4 v6, s[16:19], s40 offen lds
  s_mov_b64 exec, -1
  v_mfma_f32_16x16x32_bf16 v[32:35], a[80:83], a[48:51], v[32:35]
  ds_read_b64_tr_b16 a[16:17], v11 offset:28672
  v_mfma_f32_16x16x32_bf16 v[64:67], a[80:83], a[52:55], v[64:67]
  ds_read_b64_tr_b16 a[18:19], v11 offset:32256
  v_mfma_f32_16x16x32_bf16 v[96:99], a[80:83], a[56:59], v[96:99]
  ds_read_b64_tr_b16 a[32:33], v11 offset:35840
  v_mfma_f32_16x16x32_bf16 v[128:131], a[80:83], a[60:63], v[128:131]
  ds_read_b64_tr_b16 a[34:35], v11 offset:39424
  v_mfma_f32_16x16x32_bf16 v[20:23], a[68:71], a[48:51], v[20:23]
  ds_read_b64_tr_b16 a[20:21], v11 offset:28704
  v_mfma_f32_16x16x32_bf16 v[52:55], a[68:71], a[52:55], v[52:55]
  ds_read_b64_tr_b16 a[22:23], v11 offset:32288
  v_mfma_f32_16x16x32_bf16 v[84:87], a[68:71], a[56:59], v[84:87]
  ds_read_b64_tr_b16 a[36:37], v11 offset:35872
  v_mfma_f32_16x16x32_bf16 v[116:119], a[68:71], a[60:63], v[116:119]
  ds_read_b64_tr_b16 a[38:39], v11 offset:39456
  v_mfma_f32_16x16x32_bf16 v[36:39], a[84:87], a[48:51], v[36:39]
  ds_read_b64_tr_b16 a[24:25], v11 offset:28736
  s_add_u32 m0, s44, 4294966144
  s_nop 0
  buffer_load_dwordx4 v2, s[12:15], s29 offen offset:1152 lds
  v_mfma_f32_16x16x32_bf16 v[68:71], a[84:87], a[52:55], v[68:71]
  ds_read_b64_tr_b16 a[26:27], v11 offset:32320
  v_mfma_f32_16x16x32_bf16 v[100:103], a[84:87], a[56:59], v[100:103]
  ds_read_b64_tr_b16 a[40:41], v11 offset:35904
  v_mfma_f32_16x16x32_bf16 v[132:135], a[84:87], a[60:63], v[132:135]
  ds_read_b64_tr_b16 a[42:43], v11 offset:39488
  v_mfma_f32_16x16x32_bf16 v[24:27], a[72:75], a[48:51], v[24:27]
  ds_read_b64_tr_b16 a[28:29], v11 offset:28768
  v_mfma_f32_16x16x32_bf16 v[56:59], a[72:75], a[52:55], v[56:59]
  ds_read_b64_tr_b16 a[30:31], v11 offset:32352
  v_mfma_f32_16x16x32_bf16 v[88:91], a[72:75], a[56:59], v[88:91]
  ds_read_b64_tr_b16 a[44:45], v11 offset:35936
  v_mfma_f32_16x16x32_bf16 v[120:123], a[72:75], a[60:63], v[120:123]
  ds_read_b64_tr_b16 a[46:47], v11 offset:39520
  v_mfma_f32_16x16x32_bf16 v[40:43], a[88:91], a[48:51], v[40:43]
  s_add_u32 m0, s44, 4294967168
  s_nop 0
  buffer_load_dwordx4 v3, s[12:15], s29 offen offset:1152 lds
  v_mfma_f32_16x16x32_bf16 v[72:75], a[88:91], a[52:55], v[72:75]
  v_mfma_f32_16x16x32_bf16 v[104:107], a[88:91], a[56:59], v[104:107]
  v_mfma_f32_16x16x32_bf16 v[136:139], a[88:91], a[60:63], v[136:139]
  v_mfma_f32_16x16x32_bf16 v[28:31], a[76:79], a[48:51], v[28:31]
  v_mfma_f32_16x16x32_bf16 v[60:63], a[76:79], a[52:55], v[60:63]
  v_mfma_f32_16x16x32_bf16 v[92:95], a[76:79], a[56:59], v[92:95]
  v_mfma_f32_16x16x32_bf16 v[124:127], a[76:79], a[60:63], v[124:127]
  v_mfma_f32_16x16x32_bf16 v[44:47], a[92:95], a[48:51], v[44:47]
  v_mfma_f32_16x16x32_bf16 v[76:79], a[92:95], a[52:55], v[76:79]
  v_mfma_f32_16x16x32_bf16 v[108:111], a[92:95], a[56:59], v[108:111]
  v_mfma_f32_16x16x32_bf16 v[140:143], a[92:95], a[60:63], v[140:143]
  s_waitcnt vmcnt(10) lgkmcnt(0)
  s_barrier
  v_mfma_f32_16x16x32_bf16 v[16:19], a[16:19], a[0:3], v[16:19]
  ds_read_b128 a[48:51], v8 offset:32768
  v_mfma_f32_16x16x32_bf16 v[48:51], a[16:19], a[4:7], v[48:51]
  ds_read_b128 a[52:55], v8 offset:34816
  v_mfma_f32_16x16x32_bf16 v[80:83], a[16:19], a[8:11], v[80:83]
  ds_read_b128 a[56:59], v8 offset:36864
  v_mfma_f32_16x16x32_bf16 v[112:115], a[16:19], a[12:15], v[112:115]
  ds_read_b128 a[60:63], v8 offset:38912
  s_mov_b64 exec, s[36:37]
  s_add_u32 m0, s45, 28672
  s_add_u32 s40, s31, 4128768
  buffer_load_dwordx4 v6, s[16:19], s40 offen lds
  s_add_u32 m0, s45, 29568
  s_add_u32 s40, s31, 4186112
  buffer_load_dwordx4 v6, s[16:19], s40 offen lds
  s_mov_b64 exec, -1
  v_mfma_f32_16x16x32_bf16 v[32:35], a[32:35], a[0:3], v[32:35]
  ds_read_b64_tr_b16 a[64:65], v11 offset:43008
  v_mfma_f32_16x16x32_bf16 v[64:67], a[32:35], a[4:7], v[64:67]
  ds_read_b64_tr_b16 a[66:67], v11 offset:46592
  v_mfma_f32_16x16x32_bf16 v[96:99], a[32:35], a[8:11], v[96:99]
  ds_read_b64_tr_b16 a[80:81], v11 offset:50176
  v_mfma_f32_16x16x32_bf16 v[128:131], a[32:35], a[12:15], v[128:131]
  ds_read_b64_tr_b16 a[82:83], v11 offset:53760
  v_mfma_f32_16x16x32_bf16 v[20:23], a[20:23], a[0:3], v[20:23]
  ds_read_b64_tr_b16 a[68:69], v11 offset:43040
  v_mfma_f32_16x16x32_bf16 v[52:55], a[20:23], a[4:7], v[52:55]
  ds_read_b64_tr_b16 a[70:71], v11 offset:46624
  v_mfma_f32_16x16x32_bf16 v[84:87], a[20:23], a[8:11], v[84:87]
  ds_read_b64_tr_b16 a[84:85], v11 offset:50208
  v_mfma_f32_16x16x32_bf16 v[116:119], a[20:23], a[12:15], v[116:119]
  ds_read_b64_tr_b16 a[86:87], v11 offset:53792
  v_mfma_f32_16x16x32_bf16 v[36:39], a[36:39], a[0:3], v[36:39]
  ds_read_b64_tr_b16 a[72:73], v11 offset:43072
  s_add_u32 m0, s44, 896
  s_nop 0
  buffer_load_dwordx4 v4, s[12:15], s29 offen offset:1152 lds
  v_mfma_f32_16x16x32_bf16 v[68:71], a[36:39], a[4:7], v[68:71]
  ds_read_b64_tr_b16 a[74:75], v11 offset:46656
  v_mfma_f32_16x16x32_bf16 v[100:103], a[36:39], a[8:11], v[100:103]
  ds_read_b64_tr_b16 a[88:89], v11 offset:50240
  v_mfma_f32_16x16x32_bf16 v[132:135], a[36:39], a[12:15], v[132:135]
  ds_read_b64_tr_b16 a[90:91], v11 offset:53824
  v_mfma_f32_16x16x32_bf16 v[24:27], a[24:27], a[0:3], v[24:27]
  ds_read_b64_tr_b16 a[76:77], v11 offset:43104
  v_mfma_f32_16x16x32_bf16 v[56:59], a[24:27], a[4:7], v[56:59]
  ds_read_b64_tr_b16 a[78:79], v11 offset:46688
  v_mfma_f32_16x16x32_bf16 v[88:91], a[24:27], a[8:11], v[88:91]
  ds_read_b64_tr_b16 a[92:93], v11 offset:50272
  v_mfma_f32_16x16x32_bf16 v[120:123], a[24:27], a[12:15], v[120:123]
  ds_read_b64_tr_b16 a[94:95], v11 offset:53856
  v_mfma_f32_16x16x32_bf16 v[40:43], a[40:43], a[0:3], v[40:43]
  s_add_u32 m0, s44, 1920
  s_nop 0
  buffer_load_dwordx4 v5, s[12:15], s29 offen offset:1152 lds
  v_mfma_f32_16x16x32_bf16 v[72:75], a[40:43], a[4:7], v[72:75]
  v_mfma_f32_16x16x32_bf16 v[104:107], a[40:43], a[8:11], v[104:107]
  v_mfma_f32_16x16x32_bf16 v[136:139], a[40:43], a[12:15], v[136:139]
  v_mfma_f32_16x16x32_bf16 v[28:31], a[28:31], a[0:3], v[28:31]
  v_mfma_f32_16x16x32_bf16 v[60:63], a[28:31], a[4:7], v[60:63]
  v_mfma_f32_16x16x32_bf16 v[92:95], a[28:31], a[8:11], v[92:95]
  v_mfma_f32_16x16x32_bf16 v[124:127], a[28:31], a[12:15], v[124:127]
  v_mfma_f32_16x16x32_bf16 v[44:47], a[44:47], a[0:3], v[44:47]
  v_mfma_f32_16x16x32_bf16 v[76:79], a[44:47], a[4:7], v[76:79]
  v_mfma_f32_16x16x32_bf16 v[108:111], a[44:47], a[8:11], v[108:111]
  v_mfma_f32_16x16x32_bf16 v[140:143], a[44:47], a[12:15], v[140:143]
  s_waitcnt vmcnt(8) lgkmcnt(0)
  s_barrier
  v_mfma_f32_16x16x32_bf16 v[16:19], a[64:67], a[48:51], v[16:19]
  ds_read_b128 a[0:3], v9 offset:0
  v_mfma_f32_16x16x32_bf16 v[48:51], a[64:67], a[52:55], v[48:51]
  ds_read_b128 a[4:7], v9 offset:2048
  v_mfma_f32_16x16x32_bf16 v[80:83], a[64:67], a[56:59], v[80:83]
  ds_read_b128 a[8:11], v9 offset:4096
  v_mfma_f32_16x16x32_bf16 v[112:115], a[64:67], a[60:63], v[112:115]
  ds_read_b128 a[12:15], v9 offset:6144
  s_mov_b64 exec, s[36:37]
  s_add_u32 m0, s45, 43008
  s_add_u32 s40, s31, 4358144
  buffer_load_dwordx4 v6, s[16:19], s40 offen lds
  s_add_u32 m0, s45, 43904
  s_add_u32 s40, s31, 4415488
  buffer_load_dwordx4 v6, s[16:19], s40 offen lds
  s_mov_b64 exec, -1
  v_mfma_f32_16x16x32_bf16 v[32:35], a[80:83], a[48:51], v[32:35]
  ds_read_b64_tr_b16 a[16:17], v11 offset:0
  v_mfma_f32_16x16x32_bf16 v[64:67], a[80:83], a[52:55], v[64:67]
  ds_read_b64_tr_b16 a[18:19], v11 offset:3584
  v_mfma_f32_16x16x32_bf16 v[96:99], a[80:83], a[56:59], v[96:99]
  ds_read_b64_tr_b16 a[32:33], v11 offset:7168
  v_mfma_f32_16x16x32_bf16 v[128:131], a[80:83], a[60:63], v[128:131]
  ds_read_b64_tr_b16 a[34:35], v11 offset:10752
  v_mfma_f32_16x16x32_bf16 v[20:23], a[68:71], a[48:51], v[20:23]
  ds_read_b64_tr_b16 a[20:21], v11 offset:32
  v_mfma_f32_16x16x32_bf16 v[52:55], a[68:71], a[52:55], v[52:55]
  ds_read_b64_tr_b16 a[22:23], v11 offset:3616
  v_mfma_f32_16x16x32_bf16 v[84:87], a[68:71], a[56:59], v[84:87]
  ds_read_b64_tr_b16 a[36:37], v11 offset:7200
  v_mfma_f32_16x16x32_bf16 v[116:119], a[68:71], a[60:63], v[116:119]
  ds_read_b64_tr_b16 a[38:39], v11 offset:10784
  v_mfma_f32_16x16x32_bf16 v[36:39], a[84:87], a[48:51], v[36:39]
  ds_read_b64_tr_b16 a[24:25], v11 offset:64
  s_add_u32 m0, s44, 31488
  s_nop 0
  buffer_load_dwordx4 v2, s[12:15], s29 offen offset:1280 lds
  v_mfma_f32_16x16x32_bf16 v[68:71], a[84:87], a[52:55], v[68:71]
  ds_read_b64_tr_b16 a[26:27], v11 offset:3648
  v_mfma_f32_16x16x32_bf16 v[100:103], a[84:87], a[56:59], v[100:103]
  ds_read_b64_tr_b16 a[40:41], v11 offset:7232
  v_mfma_f32_16x16x32_bf16 v[132:135], a[84:87], a[60:63], v[132:135]
  ds_read_b64_tr_b16 a[42:43], v11 offset:10816
  v_mfma_f32_16x16x32_bf16 v[24:27], a[72:75], a[48:51], v[24:27]
  ds_read_b64_tr_b16 a[28:29], v11 offset:96
  v_mfma_f32_16x16x32_bf16 v[56:59], a[72:75], a[52:55], v[56:59]
  ds_read_b64_tr_b16 a[30:31], v11 offset:3680
  v_mfma_f32_16x16x32_bf16 v[88:91], a[72:75], a[56:59], v[88:91]
  ds_read_b64_tr_b16 a[44:45], v11 offset:7264
  v_mfma_f32_16x16x32_bf16 v[120:123], a[72:75], a[60:63], v[120:123]
  ds_read_b64_tr_b16 a[46:47], v11 offset:10848
  v_mfma_f32_16x16x32_bf16 v[40:43], a[88:91], a[48:51], v[40:43]
  s_add_u32 m0, s44, 32512
  s_nop 0
  buffer_load_dwordx4 v3, s[12:15], s29 offen offset:1280 lds
  v_mfma_f32_16x16x32_bf16 v[72:75], a[88:91], a[52:55], v[72:75]
  v_mfma_f32_16x16x32_bf16 v[104:107], a[88:91], a[56:59], v[104:107]
  v_mfma_f32_16x16x32_bf16 v[136:139], a[88:91], a[60:63], v[136:139]
  v_mfma_f32_16x16x32_bf16 v[28:31], a[76:79], a[48:51], v[28:31]
  v_mfma_f32_16x16x32_bf16 v[60:63], a[76:79], a[52:55], v[60:63]
  v_mfma_f32_16x16x32_bf16 v[92:95], a[76:79], a[56:59], v[92:95]
  v_mfma_f32_16x16x32_bf16 v[124:127], a[76:79], a[60:63], v[124:127]
  v_mfma_f32_16x16x32_bf16 v[44:47], a[92:95], a[48:51], v[44:47]
  v_mfma_f32_16x16x32_bf16 v[76:79], a[92:95], a[52:55], v[76:79]
  v_mfma_f32_16x16x32_bf16 v[108:111], a[92:95], a[56:59], v[108:111]
  v_mfma_f32_16x16x32_bf16 v[140:143], a[92:95], a[60:63], v[140:143]
  s_waitcnt vmcnt(10) lgkmcnt(0)
  s_barrier
  v_mfma_f32_16x16x32_bf16 v[16:19], a[16:19], a[0:3], v[16:19]
  ds_read_b128 a[48:51], v10 offset:0
  v_mfma_f32_16x16x32_bf16 v[48:51], a[16:19], a[4:7], v[48:51]
  ds_read_b128 a[52:55], v10 offset:2048
  v_mfma_f32_16x16x32_bf16 v[80:83], a[16:19], a[8:11], v[80:83]
  ds_read_b128 a[56:59], v10 offset:4096
  v_mfma_f32_16x16x32_bf16 v[112:115], a[16:19], a[12:15], v[112:115]
  ds_read_b128 a[60:63], v10 offset:6144
  s_mov_b64 exec, s[36:37]
  s_add_u32 m0, s45, 0
  s_add_u32 s40, s31, 4587520
  buffer_load_dwordx4 v6, s[16:19], s40 offen lds
  s_add_u32 m0, s45, 896
  s_add_u32 s40, s31, 4644864
  buffer_load_dwordx4 v6, s[16:19], s40 offen lds
  s_mov_b64 exec, -1
  v_mfma_f32_16x16x32_bf16 v[32:35], a[32:35], a[0:3], v[32:35]
  ds_read_b64_tr_b16 a[64:65], v11 offset:14336
  v_mfma_f32_16x16x32_bf16 v[64:67], a[32:35], a[4:7], v[64:67]
  ds_read_b64_tr_b16 a[66:67], v11 offset:17920
  v_mfma_f32_16x16x32_bf16 v[96:99], a[32:35], a[8:11], v[96:99]
  ds_read_b64_tr_b16 a[80:81], v11 offset:21504
  v_mfma_f32_16x16x32_bf16 v[128:131], a[32:35], a[12:15], v[128:131]
  ds_read_b64_tr_b16 a[82:83], v11 offset:25088
  v_mfma_f32_16x16x32_bf16 v[20:23], a[20:23], a[0:3], v[20:23]
  ds_read_b64_tr_b16 a[68:69], v11 offset:14368
  v_mfma_f32_16x16x32_bf16 v[52:55], a[20:23], a[4:7], v[52:55]
  ds_read_b64_tr_b16 a[70:71], v11 offset:17952
  v_mfma_f32_16x16x32_bf16 v[84:87], a[20:23], a[8:11], v[84:87]
  ds_read_b64_tr_b16 a[84:85], v11 offset:21536
  v_mfma_f32_16x16x32_bf16 v[116:119], a[20:23], a[12:15], v[116:119]
  ds_read_b64_tr_b16 a[86:87], v11 offset:25120
  v_mfma_f32_16x16x32_bf16 v[36:39], a[36:39], a[0:3], v[36:39]
  ds_read_b64_tr_b16 a[72:73], v11 offset:14400
  s_add_u32 m0, s44, 33536
  s_nop 0
  buffer_load_dwordx4 v4, s[12:15], s29 offen offset:1280 lds
  v_mfma_f32_16x16x32_bf16 v[68:71], a[36:39], a[4:7], v[68:71]
  ds_read_b64_tr_b16 a[74:75], v11 offset:17984
  v_mfma_f32_16x16x32_bf16 v[100:103], a[36:39], a[8:11], v[100:103]
  ds_read_b64_tr_b16 a[88:89], v11 offset:21568
  v_mfma_f32_16x16x32_bf16 v[132:135], a[36:39], a[12:15], v[132:135]
  ds_read_b64_tr_b16 a[90:91], v11 offset:25152
  v_mfma_f32_16x16x32_bf16 v[24:27], a[24:27], a[0:3], v[24:27]
  ds_read_b64_tr_b16 a[76:77], v11 offset:14432
  v_mfma_f32_16x16x32_bf16 v[56:59], a[24:27], a[4:7], v[56:59]
  ds_read_b64_tr_b16 a[78:79], v11 offset:18016
  v_mfma_f32_16x16x32_bf16 v[88:91], a[24:27], a[8:11], v[88:91]
  ds_read_b64_tr_b16 a[92:93], v11 offset:21600
  v_mfma_f32_16x16x32_bf16 v[120:123], a[24:27], a[12:15], v[120:123]
  ds_read_b64_tr_b16 a[94:95], v11 offset:25184
  v_mfma_f32_16x16x32_bf16 v[40:43], a[40:43], a[0:3], v[40:43]
  s_add_u32 m0, s44, 34560
  s_nop 0
  buffer_load_dwordx4 v5, s[12:15], s29 offen offset:1280 lds
  v_mfma_f32_16x16x32_bf16 v[72:75], a[40:43], a[4:7], v[72:75]
  v_mfma_f32_16x16x32_bf16 v[104:107], a[40:43], a[8:11], v[104:107]
  v_mfma_f32_16x16x32_bf16 v[136:139], a[40:43], a[12:15], v[136:139]
  v_mfma_f32_16x16x32_bf16 v[28:31], a[28:31], a[0:3], v[28:31]
  v_mfma_f32_16x16x32_bf16 v[60:63], a[28:31], a[4:7], v[60:63]
  v_mfma_f32_16x16x32_bf16 v[92:95], a[28:31], a[8:11], v[92:95]
  v_mfma_f32_16x16x32_bf16 v[124:127], a[28:31], a[12:15], v[124:127]
  v_mfma_f32_16x16x32_bf16 v[44:47], a[44:47], a[0:3], v[44:47]
  v_mfma_f32_16x16x32_bf16 v[76:79], a[44:47], a[4:7], v[76:79]
  v_mfma_f32_16x16x32_bf16 v[108:111], a[44:47], a[8:11], v[108:111]
  v_mfma_f32_16x16x32_bf16 v[140:143], a[44:47], a[12:15], v[140:143]
  s_waitcnt vmcnt(8) lgkmcnt(0)
  s_barrier
  v_mfma_f32_16x16x32_bf16 v[16:19], a[64:67], a[48:51], v[16:19]
  ds_read_b128 a[0:3], v7 offset:0
  v_mfma_f32_16x16x32_bf16 v[48:51], a[64:67], a[52:55], v[48:51]
  ds_read_b128 a[4:7], v7 offset:2048
  v_mfma_f32_16x16x32_bf16 v[80:83], a[64:67], a[56:59], v[80:83]
  ds_read_b128 a[8:11], v7 offset:4096
  v_mfma_f32_16x16x32_bf16 v[112:115], a[64:67], a[60:63], v[112:115]
  ds_read_b128 a[12:15], v7 offset:6144
  s_mov_b64 exec, s[36:37]
  s_add_u32 m0, s45, 14336
  s_add_u32 s40, s31, 4816896
  buffer_load_dwordx4 v6, s[16:19], s40 offen lds
  s_add_u32 m0, s45, 15232
  s_add_u32 s40, s31, 4874240
  buffer_load_dwordx4 v6, s[16:19], s40 offen lds
  s_mov_b64 exec, -1
  v_mfma_f32_16x16x32_bf16 v[32:35], a[80:83], a[48:51], v[32:35]
  ds_read_b64_tr_b16 a[16:17], v11 offset:28672
  v_mfma_f32_16x16x32_bf16 v[64:67], a[80:83], a[52:55], v[64:67]
  ds_read_b64_tr_b16 a[18:19], v11 offset:32256
  v_mfma_f32_16x16x32_bf16 v[96:99], a[80:83], a[56:59], v[96:99]
  ds_read_b64_tr_b16 a[32:33], v11 offset:35840
  v_mfma_f32_16x16x32_bf16 v[128:131], a[80:83], a[60:63], v[128:131]
  ds_read_b64_tr_b16 a[34:35], v11 offset:39424
  v_mfma_f32_16x16x32_bf16 v[20:23], a[68:71], a[48:51], v[20:23]
  ds_read_b64_tr_b16 a[20:21], v11 offset:28704
  v_mfma_f32_16x16x32_bf16 v[52:55], a[68:71], a[52:55], v[52:55]
  ds_read_b64_tr_b16 a[22:23], v11 offset:32288
  v_mfma_f32_16x16x32_bf16 v[84:87], a[68:71], a[56:59], v[84:87]
  ds_read_b64_tr_b16 a[36:37], v11 offset:35872
  v_mfma_f32_16x16x32_bf16 v[116:119], a[68:71], a[60:63], v[116:119]
  ds_read_b64_tr_b16 a[38:39], v11 offset:39456
  v_mfma_f32_16x16x32_bf16 v[36:39], a[84:87], a[48:51], v[36:39]
  ds_read_b64_tr_b16 a[24:25], v11 offset:28736
  s_add_u32 m0, s44, 64128
  s_nop 0
  buffer_load_dwordx4 v2, s[12:15], s29 offen offset:1408 lds
  v_mfma_f32_16x16x32_bf16 v[68:71], a[84:87], a[52:55], v[68:71]
  ds_read_b64_tr_b16 a[26:27], v11 offset:32320
  v_mfma_f32_16x16x32_bf16 v[100:103], a[84:87], a[56:59], v[100:103]
  ds_read_b64_tr_b16 a[40:41], v11 offset:35904
  v_mfma_f32_16x16x32_bf16 v[132:135], a[84:87], a[60:63], v[132:135]
  ds_read_b64_tr_b16 a[42:43], v11 offset:39488
  v_mfma_f32_16x16x32_bf16 v[24:27], a[72:75], a[48:51], v[24:27]
  ds_read_b64_tr_b16 a[28:29], v11 offset:28768
  v_mfma_f32_16x16x32_bf16 v[56:59], a[72:75], a[52:55], v[56:59]
  ds_read_b64_tr_b16 a[30:31], v11 offset:32352
  v_mfma_f32_16x16x32_bf16 v[88:91], a[72:75], a[56:59], v[88:91]
  ds_read_b64_tr_b16 a[44:45], v11 offset:35936
  v_mfma_f32_16x16x32_bf16 v[120:123], a[72:75], a[60:63], v[120:123]
  ds_read_b64_tr_b16 a[46:47], v11 offset:39520
  v_mfma_f32_16x16x32_bf16 v[40:43], a[88:91], a[48:51], v[40:43]
  s_add_u32 m0, s44, 65152
  s_nop 0
  buffer_load_dwordx4 v3, s[12:15], s29 offen offset:1408 lds
  v_mfma_f32_16x16x32_bf16 v[72:75], a[88:91], a[52:55], v[72:75]
  v_mfma_f32_16x16x32_bf16 v[104:107], a[88:91], a[56:59], v[104:107]
  v_mfma_f32_16x16x32_bf16 v[136:139], a[88:91], a[60:63], v[136:139]
  v_mfma_f32_16x16x32_bf16 v[28:31], a[76:79], a[48:51], v[28:31]
  v_mfma_f32_16x16x32_bf16 v[60:63], a[76:79], a[52:55], v[60:63]
  v_mfma_f32_16x16x32_bf16 v[92:95], a[76:79], a[56:59], v[92:95]
  v_mfma_f32_16x16x32_bf16 v[124:127], a[76:79], a[60:63], v[124:127]
  v_mfma_f32_16x16x32_bf16 v[44:47], a[92:95], a[48:51], v[44:47]
  v_mfma_f32_16x16x32_bf16 v[76:79], a[92:95], a[52:55], v[76:79]
  v_mfma_f32_16x16x32_bf16 v[108:111], a[92:95], a[56:59], v[108:111]
  v_mfma_f32_16x16x32_bf16 v[140:143], a[92:95], a[60:63], v[140:143]
  s_waitcnt vmcnt(10) lgkmcnt(0)
  s_barrier
  v_mfma_f32_16x16x32_bf16 v[16:19], a[16:19], a[0:3], v[16:19]
  ds_read_b128 a[48:51], v8 offset:0
  v_mfma_f32_16x16x32_bf16 v[48:51], a[16:19], a[4:7], v[48:51]
  ds_read_b128 a[52:55], v8 offset:2048
  v_mfma_f32_16x16x32_bf16 v[80:83], a[16:19], a[8:11], v[80:83]
  ds_read_b128 a[56:59], v8 offset:4096
  v_mfma_f32_16x16x32_bf16 v[112:115], a[16:19], a[12:15], v[112:115]
  ds_read_b128 a[60:63], v8 offset:6144
  s_mov_b64 exec, s[36:37]
  s_add_u32 m0, s45, 28672
  s_add_u32 s40, s31, 5046272
  buffer_load_dwordx4 v6, s[16:19], s40 offen lds
  s_add_u32 m0, s45, 29568
  s_add_u32 s40, s31, 5103616
  buffer_load_dwordx4 v6, s[16:19], s40 offen lds
  s_mov_b64 exec, -1
  v_mfma_f32_16x16x32_bf16 v[32:35], a[32:35], a[0:3], v[32:35]
  ds_read_b64_tr_b16 a[64:65], v11 offset:43008
  v_mfma_f32_16x16x32_bf16 v[64:67], a[32:35], a[4:7], v[64:67]
  ds_read_b64_tr_b16 a[66:67], v11 offset:46592
  v_mfma_f32_16x16x32_bf16 v[96:99], a[32:35], a[8:11], v[96:99]
  ds_read_b64_tr_b16 a[80:81], v11 offset:50176
  v_mfma_f32_16x16x32_bf16 v[128:131], a[32:35], a[12:15], v[128:131]
  ds_read_b64_tr_b16 a[82:83], v11 offset:53760
  v_mfma_f32_16x16x32_bf16 v[20:23], a[20:23], a[0:3], v[20:23]
  ds_read_b64_tr_b16 a[68:69], v11 offset:43040
  v_mfma_f32_16x16x32_bf16 v[52:55], a[20:23], a[4:7], v[52:55]
  ds_read_b64_tr_b16 a[70:71], v11 offset:46624
  v_mfma_f32_16x16x32_bf16 v[84:87], a[20:23], a[8:11], v[84:87]
  ds_read_b64_tr_b16 a[84:85], v11 offset:50208
  v_mfma_f32_16x16x32_bf16 v[116:119], a[20:23], a[12:15], v[116:119]
  ds_read_b64_tr_b16 a[86:87], v11 offset:53792
  v_mfma_f32_16x16x32_bf16 v[36:39], a[36:39], a[0:3], v[36:39]
  ds_read_b64_tr_b16 a[72:73], v11 offset:43072
  s_add_u32 m0, s44, 66176
  s_nop 0
  buffer_load_dwordx4 v4, s[12:15], s29 offen offset:1408 lds
  v_mfma_f32_16x16x32_bf16 v[68:71], a[36:39], a[4:7], v[68:71]
  ds_read_b64_tr_b16 a[74:75], v11 offset:46656
  v_mfma_f32_16x16x32_bf16 v[100:103], a[36:39], a[8:11], v[100:103]
  ds_read_b64_tr_b16 a[88:89], v11 offset:50240
  v_mfma_f32_16x16x32_bf16 v[132:135], a[36:39], a[12:15], v[132:135]
  ds_read_b64_tr_b16 a[90:91], v11 offset:53824
  v_mfma_f32_16x16x32_bf16 v[24:27], a[24:27], a[0:3], v[24:27]
  ds_read_b64_tr_b16 a[76:77], v11 offset:43104
  v_mfma_f32_16x16x32_bf16 v[56:59], a[24:27], a[4:7], v[56:59]
  ds_read_b64_tr_b16 a[78:79], v11 offset:46688
  v_mfma_f32_16x16x32_bf16 v[88:91], a[24:27], a[8:11], v[88:91]
  ds_read_b64_tr_b16 a[92:93], v11 offset:50272
  v_mfma_f32_16x16x32_bf16 v[120:123], a[24:27], a[12:15], v[120:123]
  ds_read_b64_tr_b16 a[94:95], v11 offset:53856
  v_mfma_f32_16x16x32_bf16 v[40:43], a[40:43], a[0:3], v[40:43]
  s_add_u32 m0, s44, 67200
  s_nop 0
  buffer_load_dwordx4 v5, s[12:15], s29 offen offset:1408 lds
  v_mfma_f32_16x16x32_bf16 v[72:75], a[40:43], a[4:7], v[72:75]
  v_mfma_f32_16x16x32_bf16 v[104:107], a[40:43], a[8:11], v[104:107]
  v_mfma_f32_16x16x32_bf16 v[136:139], a[40:43], a[12:15], v[136:139]
  v_mfma_f32_16x16x32_bf16 v[28:31], a[28:31], a[0:3], v[28:31]
  v_mfma_f32_16x16x32_bf16 v[60:63], a[28:31], a[4:7], v[60:63]
  v_mfma_f32_16x16x32_bf16 v[92:95], a[28:31], a[8:11], v[92:95]
  v_mfma_f32_16x16x32_bf16 v[124:127], a[28:31], a[12:15], v[124:127]
  v_mfma_f32_16x16x32_bf16 v[44:47], a[44:47], a[0:3], v[44:47]
  v_mfma_f32_16x16x32_bf16 v[76:79], a[44:47], a[4:7], v[76:79]
  v_mfma_f32_16x16x32_bf16 v[108:111], a[44:47], a[8:11], v[108:111]
  v_mfma_f32_16x16x32_bf16 v[140:143], a[44:47], a[12:15], v[140:143]
  s_waitcnt vmcnt(8) lgkmcnt(0)
  s_barrier
  v_mfma_f32_16x16x32_bf16 v[16:19], a[64:67], a[48:51], v[16:19]
  ds_read_b128 a[0:3], v7 offset:32768
  v_mfma_f32_16x16x32_bf16 v[48:51], a[64:67], a[52:55], v[48:51]
  ds_read_b128 a[4:7], v7 offset:34816
  v_mfma_f32_16x16x32_bf16 v[80:83], a[64:67], a[56:59], v[80:83]
  ds_read_b128 a[8:11], v7 offset:36864
  v_mfma_f32_16x16x32_bf16 v[112:115], a[64:67], a[60:63], v[112:115]
  ds_read_b128 a[12:15], v7 offset:38912
  s_mov_b64 exec, s[36:37]
  s_add_u32 m0, s45, 43008
  s_add_u32 s40, s31, 5275648
  buffer_load_dwordx4 v6, s[16:19], s40 offen lds
  s_add_u32 m0, s45, 43904
  s_add_u32 s40, s31, 5332992
  buffer_load_dwordx4 v6, s[16:19], s40 offen lds
  s_mov_b64 exec, -1
  v_mfma_f32_16x16x32_bf16 v[32:35], a[80:83], a[48:51], v[32:35]
  ds_read_b64_tr_b16 a[16:17], v11 offset:0
  v_mfma_f32_16x16x32_bf16 v[64:67], a[80:83], a[52:55], v[64:67]
  ds_read_b64_tr_b16 a[18:19], v11 offset:3584
  v_mfma_f32_16x16x32_bf16 v[96:99], a[80:83], a[56:59], v[96:99]
  ds_read_b64_tr_b16 a[32:33], v11 offset:7168
  v_mfma_f32_16x16x32_bf16 v[128:131], a[80:83], a[60:63], v[128:131]
  ds_read_b64_tr_b16 a[34:35], v11 offset:10752
  v_mfma_f32_16x16x32_bf16 v[20:23], a[68:71], a[48:51], v[20:23]
  ds_read_b64_tr_b16 a[20:21], v11 offset:32
  v_mfma_f32_16x16x32_bf16 v[52:55], a[68:71], a[52:55], v[52:55]
  ds_read_b64_tr_b16 a[22:23], v11 offset:3616
  v_mfma_f32_16x16x32_bf16 v[84:87], a[68:71], a[56:59], v[84:87]
  ds_read_b64_tr_b16 a[36:37], v11 offset:7200
  v_mfma_f32_16x16x32_bf16 v[116:119], a[68:71], a[60:63], v[116:119]
  ds_read_b64_tr_b16 a[38:39], v11 offset:10784
  v_mfma_f32_16x16x32_bf16 v[36:39], a[84:87], a[48:51], v[36:39]
  ds_read_b64_tr_b16 a[24:25], v11 offset:64
  s_add_u32 m0, s44, 4294965760
  s_nop 0
  buffer_load_dwordx4 v2, s[12:15], s29 offen offset:1536 lds
  v_mfma_f32_16x16x32_bf16 v[68:71], a[84:87], a[52:55], v[68:71]
  ds_read_b64_tr_b16 a[26:27], v11 offset:3648
  v_mfma_f32_16x16x32_bf16 v[100:103], a[84:87], a[56:59], v[100:103]
  ds_read_b64_tr_b16 a[40:41], v11 offset:7232
  v_mfma_f32_16x16x32_bf16 v[132:135], a[84:87], a[60:63], v[132:135]
  ds_read_b64_tr_b16 a[42:43], v11 offset:10816
  v_mfma_f32_16x16x32_bf16 v[24:27], a[72:75], a[48:51], v[24:27]
  ds_read_b64_tr_b16 a[28:29], v11 offset:96
  v_mfma_f32_16x16x32_bf16 v[56:59], a[72:75], a[52:55], v[56:59]
  ds_read_b64_tr_b16 a[30:31], v11 offset:3680
  v_mfma_f32_16x16x32_bf16 v[88:91], a[72:75], a[56:59], v[88:91]
  ds_read_b64_tr_b16 a[44:45], v11 offset:7264
  v_mfma_f32_16x16x32_bf16 v[120:123], a[72:75], a[60:63], v[120:123]
  ds_read_b64_tr_b16 a[46:47], v11 offset:10848
  v_mfma_f32_16x16x32_bf16 v[40:43], a[88:91], a[48:51], v[40:43]
  s_add_u32 m0, s44, 4294966784
  s_nop 0
  buffer_load_dwordx4 v3, s[12:15], s29 offen offset:1536 lds
  v_mfma_f32_16x16x32_bf16 v[72:75], a[88:91], a[52:55], v[72:75]
  v_mfma_f32_16x16x32_bf16 v[104:107], a[88:91], a[56:59], v[104:107]
  v_mfma_f32_16x16x32_bf16 v[136:139], a[88:91], a[60:63], v[136:139]
  v_mfma_f32_16x16x32_bf16 v[28:31], a[76:79], a[48:51], v[28:31]
  v_mfma_f32_16x16x32_bf16 v[60:63], a[76:79], a[52:55], v[60:63]
  v_mfma_f32_16x16x32_bf16 v[92:95], a[76:79], a[56:59], v[92:95]
  v_mfma_f32_16x16x32_bf16 v[124:127], a[76:79], a[60:63], v[124:127]
  v_mfma_f32_16x16x32_bf16 v[44:47], a[92:95], a[48:51], v[44:47]
  v_mfma_f32_16x16x32_bf16 v[76:79], a[92:95], a[52:55], v[76:79]
  v_mfma_f32_16x16x32_bf16 v[108:111], a[92:95], a[56:59], v[108:111]
  v_mfma_f32_16x16x32_bf16 v[140:143], a[92:95], a[60:63], v[140:143]
  s_waitcnt vmcnt(10) lgkmcnt(0)
  s_barrier
  v_mfma_f32_16x16x32_bf16 v[16:19], a[16:19], a[0:3], v[16:19]
  ds_read_b128 a[48:51], v8 offset:32768
  v_mfma_f32_16x16x32_bf16 v[48:51], a[16:19], a[4:7], v[48:51]
  ds_read_b128 a[52:55], v8 offset:34816
  v_mfma_f32_16x16x32_bf16 v[80:83], a[16:19], a[8:11], v[80:83]
  ds_read_b128 a[56:59], v8 offset:36864
  v_mfma_f32_16x16x32_bf16 v[112:115], a[16:19], a[12:15], v[112:115]
  ds_read_b128 a[60:63], v8 offset:38912
  s_mov_b64 exec, s[36:37]
  s_add_u32 m0, s45, 0
  s_add_u32 s40, s31, 5505024
  buffer_load_dwordx4 v6, s[16:19], s40 offen lds
  s_add_u32 m0, s45, 896
  s_add_u32 s40, s31, 5562368
  buffer_load_dwordx4 v6, s[16:19], s40 offen lds
  s_mov_b64 exec, -1
  v_mfma_f32_16x16x32_bf16 v[32:35], a[32:35], a[0:3], v[32:35]
  ds_read_b64_tr_b16 a[64:65], v11 offset:14336
  v_mfma_f32_16x16x32_bf16 v[64:67], a[32:35], a[4:7], v[64:67]
  ds_read_b64_tr_b16 a[66:67], v11 offset:17920
  v_mfma_f32_16x16x32_bf16 v[96:99], a[32:35], a[8:11], v[96:99]
  ds_read_b64_tr_b16 a[80:81], v11 offset:21504
  v_mfma_f32_16x16x32_bf16 v[128:131], a[32:35], a[12:15], v[128:131]
  ds_read_b64_tr_b16 a[82:83], v11 offset:25088
  v_mfma_f32_16x16x32_bf16 v[20:23], a[20:23], a[0:3], v[20:23]
  ds_read_b64_tr_b16 a[68:69], v11 offset:14368
  v_mfma_f32_16x16x32_bf16 v[52:55], a[20:23], a[4:7], v[52:55]
  ds_read_b64_tr_b16 a[70:71], v11 offset:17952
  v_mfma_f32_16x16x32_bf16 v[84:87], a[20:23], a[8:11], v[84:87]
  ds_read_b64_tr_b16 a[84:85], v11 offset:21536
  v_mfma_f32_16x16x32_bf16 v[116:119], a[20:23], a[12:15], v[116:119]
  ds_read_b64_tr_b16 a[86:87], v11 offset:25120
  v_mfma_f32_16x16x32_bf16 v[36:39], a[36:39], a[0:3], v[36:39]
  ds_read_b64_tr_b16 a[72:73], v11 offset:14400
  s_add_u32 m0, s44, 512
  s_nop 0
  buffer_load_dwordx4 v4, s[12:15], s29 offen offset:1536 lds
  v_mfma_f32_16x16x32_bf16 v[68:71], a[36:39], a[4:7], v[68:71]
  ds_read_b64_tr_b16 a[74:75], v11 offset:17984
  v_mfma_f32_16x16x32_bf16 v[100:103], a[36:39], a[8:11], v[100:103]
  ds_read_b64_tr_b16 a[88:89], v11 offset:21568
  v_mfma_f32_16x16x32_bf16 v[132:135], a[36:39], a[12:15], v[132:135]
  ds_read_b64_tr_b16 a[90:91], v11 offset:25152
  v_mfma_f32_16x16x32_bf16 v[24:27], a[24:27], a[0:3], v[24:27]
  ds_read_b64_tr_b16 a[76:77], v11 offset:14432
  v_mfma_f32_16x16x32_bf16 v[56:59], a[24:27], a[4:7], v[56:59]
  ds_read_b64_tr_b16 a[78:79], v11 offset:18016
  v_mfma_f32_16x16x32_bf16 v[88:91], a[24:27], a[8:11], v[88:91]
  ds_read_b64_tr_b16 a[92:93], v11 offset:21600
  v_mfma_f32_16x16x32_bf16 v[120:123], a[24:27], a[12:15], v[120:123]
  ds_read_b64_tr_b16 a[94:95], v11 offset:25184
  v_mfma_f32_16x16x32_bf16 v[40:43], a[40:43], a[0:3], v[40:43]
  s_add_u32 m0, s44, 1536
  s_nop 0
  buffer_load_dwordx4 v5, s[12:15], s29 offen offset:1536 lds
  v_mfma_f32_16x16x32_bf16 v[72:75], a[40:43], a[4:7], v[72:75]
  v_mfma_f32_16x16x32_bf16 v[104:107], a[40:43], a[8:11], v[104:107]
  v_mfma_f32_16x16x32_bf16 v[136:139], a[40:43], a[12:15], v[136:139]
  v_mfma_f32_16x16x32_bf16 v[28:31], a[28:31], a[0:3], v[28:31]
  v_mfma_f32_16x16x32_bf16 v[60:63], a[28:31], a[4:7], v[60:63]
  v_mfma_f32_16x16x32_bf16 v[92:95], a[28:31], a[8:11], v[92:95]
  v_mfma_f32_16x16x32_bf16 v[124:127], a[28:31], a[12:15], v[124:127]
  v_mfma_f32_16x16x32_bf16 v[44:47], a[44:47], a[0:3], v[44:47]
  v_mfma_f32_16x16x32_bf16 v[76:79], a[44:47], a[4:7], v[76:79]
  v_mfma_f32_16x16x32_bf16 v[108:111], a[44:47], a[8:11], v[108:111]
  v_mfma_f32_16x16x32_bf16 v[140:143], a[44:47], a[12:15], v[140:143]
  s_waitcnt vmcnt(8) lgkmcnt(0)
  s_barrier
  v_mfma_f32_16x16x32_bf16 v[16:19], a[64:67], a[48:51], v[16:19]
  ds_read_b128 a[0:3], v9 offset:0
  v_mfma_f32_16x16x32_bf16 v[48:51], a[64:67], a[52:55], v[48:51]
  ds_read_b128 a[4:7], v9 offset:2048
  v_mfma_f32_16x16x32_bf16 v[80:83], a[64:67], a[56:59], v[80:83]
  ds_read_b128 a[8:11], v9 offset:4096
  v_mfma_f32_16x16x32_bf16 v[112:115], a[64:67], a[60:63], v[112:115]
  ds_read_b128 a[12:15], v9 offset:6144
  s_mov_b64 exec, s[36:37]
  s_add_u32 m0, s45, 14336
  s_add_u32 s40, s31, 5734400
  buffer_load_dwordx4 v6, s[16:19], s40 offen lds
  s_add_u32 m0, s45, 15232
  s_add_u32 s40, s31, 5791744
  buffer_load_dwordx4 v6, s[16:19], s40 offen lds
  s_mov_b64 exec, -1
  v_mfma_f32_16x16x32_bf16 v[32:35], a[80:83], a[48:51], v[32:35]
  ds_read_b64_tr_b16 a[16:17], v11 offset:28672
  v_mfma_f32_16x16x32_bf16 v[64:67], a[80:83], a[52:55], v[64:67]
  ds_read_b64_tr_b16 a[18:19], v11 offset:32256
  v_mfma_f32_16x16x32_bf16 v[96:99], a[80:83], a[56:59], v[96:99]
  ds_read_b64_tr_b16 a[32:33], v11 offset:35840
  v_mfma_f32_16x16x32_bf16 v[128:131], a[80:83], a[60:63], v[128:131]
  ds_read_b64_tr_b16 a[34:35], v11 offset:39424
  v_mfma_f32_16x16x32_bf16 v[20:23], a[68:71], a[48:51], v[20:23]
  ds_read_b64_tr_b16 a[20:21], v11 offset:28704
  v_mfma_f32_16x16x32_bf16 v[52:55], a[68:71], a[52:55], v[52:55]
  ds_read_b64_tr_b16 a[22:23], v11 offset:32288
  v_mfma_f32_16x16x32_bf16 v[84:87], a[68:71], a[56:59], v[84:87]
  ds_read_b64_tr_b16 a[36:37], v11 offset:35872
  v_mfma_f32_16x16x32_bf16 v[116:119], a[68:71], a[60:63], v[116:119]
  ds_read_b64_tr_b16 a[38:39], v11 offset:39456
  v_mfma_f32_16x16x32_bf16 v[36:39], a[84:87], a[48:51], v[36:39]
  ds_read_b64_tr_b16 a[24:25], v11 offset:28736
  s_add_u32 m0, s44, 31104
  s_nop 0
  buffer_load_dwordx4 v2, s[12:15], s29 offen offset:1664 lds
  v_mfma_f32_16x16x32_bf16 v[68:71], a[84:87], a[52:55], v[68:71]
  ds_read_b64_tr_b16 a[26:27], v11 offset:32320
  v_mfma_f32_16x16x32_bf16 v[100:103], a[84:87], a[56:59], v[100:103]
  ds_read_b64_tr_b16 a[40:41], v11 offset:35904
  v_mfma_f32_16x16x32_bf16 v[132:135], a[84:87], a[60:63], v[132:135]
  ds_read_b64_tr_b16 a[42:43], v11 offset:39488
  v_mfma_f32_16x16x32_bf16 v[24:27], a[72:75], a[48:51], v[24:27]
  ds_read_b64_tr_b16 a[28:29], v11 offset:28768
  v_mfma_f32_16x16x32_bf16 v[56:59], a[72:75], a[52:55], v[56:59]
  ds_read_b64_tr_b16 a[30:31], v11 offset:32352
  v_mfma_f32_16x16x32_bf16 v[88:91], a[72:75], a[56:59], v[88:91]
  ds_read_b64_tr_b16 a[44:45], v11 offset:35936
  v_mfma_f32_16x16x32_bf16 v[120:123], a[72:75], a[60:63], v[120:123]
  ds_read_b64_tr_b16 a[46:47], v11 offset:39520
  v_mfma_f32_16x16x32_bf16 v[40:43], a[88:91], a[48:51], v[40:43]
  s_add_u32 m0, s44, 32128
  s_nop 0
  buffer_load_dwordx4 v3, s[12:15], s29 offen offset:1664 lds
  v_mfma_f32_16x16x32_bf16 v[72:75], a[88:91], a[52:55], v[72:75]
  v_mfma_f32_16x16x32_bf16 v[104:107], a[88:91], a[56:59], v[104:107]
  v_mfma_f32_16x16x32_bf16 v[136:139], a[88:91], a[60:63], v[136:139]
  v_mfma_f32_16x16x32_bf16 v[28:31], a[76:79], a[48:51], v[28:31]
  v_mfma_f32_16x16x32_bf16 v[60:63], a[76:79], a[52:55], v[60:63]
  v_mfma_f32_16x16x32_bf16 v[92:95], a[76:79], a[56:59], v[92:95]
  v_mfma_f32_16x16x32_bf16 v[124:127], a[76:79], a[60:63], v[124:127]
  v_mfma_f32_16x16x32_bf16 v[44:47], a[92:95], a[48:51], v[44:47]
  v_mfma_f32_16x16x32_bf16 v[76:79], a[92:95], a[52:55], v[76:79]
  v_mfma_f32_16x16x32_bf16 v[108:111], a[92:95], a[56:59], v[108:111]
  v_mfma_f32_16x16x32_bf16 v[140:143], a[92:95], a[60:63], v[140:143]
  s_waitcnt vmcnt(10) lgkmcnt(0)
  s_barrier
  v_mfma_f32_16x16x32_bf16 v[16:19], a[16:19], a[0:3], v[16:19]
  ds_read_b128 a[48:51], v10 offset:0
  v_mfma_f32_16x16x32_bf16 v[48:51], a[16:19], a[4:7], v[48:51]
  ds_read_b128 a[52:55], v10 offset:2048
  v_mfma_f32_16x16x32_bf16 v[80:83], a[16:19], a[8:11], v[80:83]
  ds_read_b128 a[56:59], v10 offset:4096
  v_mfma_f32_16x16x32_bf16 v[112:115], a[16:19], a[12:15], v[112:115]
  ds_read_b128 a[60:63], v10 offset:6144
  s_mov_b64 exec, s[36:37]
  s_add_u32 m0, s45, 28672
  s_add_u32 s40, s31, 5963776
  buffer_load_dwordx4 v6, s[16:19], s40 offen lds
  s_add_u32 m0, s45, 29568
  s_add_u32 s40, s31, 6021120
  buffer_load_dwordx4 v6, s[16:19], s40 offen lds
  s_mov_b64 exec, -1
  v_mfma_f32_16x16x32_bf16 v[32:35], a[32:35], a[0:3], v[32:35]
  ds_read_b64_tr_b16 a[64:65], v11 offset:43008
  v_mfma_f32_16x16x32_bf16 v[64:67], a[32:35], a[4:7], v[64:67]
  ds_read_b64_tr_b16 a[66:67], v11 offset:46592
  v_mfma_f32_16x16x32_bf16 v[96:99], a[32:35], a[8:11], v[96:99]
  ds_read_b64_tr_b16 a[80:81], v11 offset:50176
  v_mfma_f32_16x16x32_bf16 v[128:131], a[32:35], a[12:15], v[128:131]
  ds_read_b64_tr_b16 a[82:83], v11 offset:53760
  v_mfma_f32_16x16x32_bf16 v[20:23], a[20:23], a[0:3], v[20:23]
  ds_read_b64_tr_b16 a[68:69], v11 offset:43040
  v_mfma_f32_16x16x32_bf16 v[52:55], a[20:23], a[4:7], v[52:55]
  ds_read_b64_tr_b16 a[70:71], v11 offset:46624
  v_mfma_f32_16x16x32_bf16 v[84:87], a[20:23], a[8:11], v[84:87]
  ds_read_b64_tr_b16 a[84:85], v11 offset:50208
  v_mfma_f32_16x16x32_bf16 v[116:119], a[20:23], a[12:15], v[116:119]
  ds_read_b64_tr_b16 a[86:87], v11 offset:53792
  v_mfma_f32_16x16x32_bf16 v[36:39], a[36:39], a[0:3], v[36:39]
  ds_read_b64_tr_b16 a[72:73], v11 offset:43072
  s_add_u32 m0, s44, 33152
  s_nop 0
  buffer_load_dwordx4 v4, s[12:15], s29 offen offset:1664 lds
  v_mfma_f32_16x16x32_bf16 v[68:71], a[36:39], a[4:7], v[68:71]
  ds_read_b64_tr_b16 a[74:75], v11 offset:46656
  v_mfma_f32_16x16x32_bf16 v[100:103], a[36:39], a[8:11], v[100:103]
  ds_read_b64_tr_b16 a[88:89], v11 offset:50240
  v_mfma_f32_16x16x32_bf16 v[132:135], a[36:39], a[12:15], v[132:135]
  ds_read_b64_tr_b16 a[90:91], v11 offset:53824
  v_mfma_f32_16x16x32_bf16 v[24:27], a[24:27], a[0:3], v[24:27]
  ds_read_b64_tr_b16 a[76:77], v11 offset:43104
  v_mfma_f32_16x16x32_bf16 v[56:59], a[24:27], a[4:7], v[56:59]
  ds_read_b64_tr_b16 a[78:79], v11 offset:46688
  v_mfma_f32_16x16x32_bf16 v[88:91], a[24:27], a[8:11], v[88:91]
  ds_read_b64_tr_b16 a[92:93], v11 offset:50272
  v_mfma_f32_16x16x32_bf16 v[120:123], a[24:27], a[12:15], v[120:123]
  ds_read_b64_tr_b16 a[94:95], v11 offset:53856
  v_mfma_f32_16x16x32_bf16 v[40:43], a[40:43], a[0:3], v[40:43]
  s_add_u32 m0, s44, 34176
  s_nop 0
  buffer_load_dwordx4 v5, s[12:15], s29 offen offset:1664 lds
  v_mfma_f32_16x16x32_bf16 v[72:75], a[40:43], a[4:7], v[72:75]
  v_mfma_f32_16x16x32_bf16 v[104:107], a[40:43], a[8:11], v[104:107]
  v_mfma_f32_16x16x32_bf16 v[136:139], a[40:43], a[12:15], v[136:139]
  v_mfma_f32_16x16x32_bf16 v[28:31], a[28:31], a[0:3], v[28:31]
  v_mfma_f32_16x16x32_bf16 v[60:63], a[28:31], a[4:7], v[60:63]
  v_mfma_f32_16x16x32_bf16 v[92:95], a[28:31], a[8:11], v[92:95]
  v_mfma_f32_16x16x32_bf16 v[124:127], a[28:31], a[12:15], v[124:127]
  v_mfma_f32_16x16x32_bf16 v[44:47], a[44:47], a[0:3], v[44:47]
  v_mfma_f32_16x16x32_bf16 v[76:79], a[44:47], a[4:7], v[76:79]
  v_mfma_f32_16x16x32_bf16 v[108:111], a[44:47], a[8:11], v[108:111]
  v_mfma_f32_16x16x32_bf16 v[140:143], a[44:47], a[12:15], v[140:143]
  s_waitcnt vmcnt(8) lgkmcnt(0)
  s_barrier
  v_mfma_f32_16x16x32_bf16 v[16:19], a[64:67], a[48:51], v[16:19]
  ds_read_b128 a[0:3], v7 offset:0
  v_mfma_f32_16x16x32_bf16 v[48:51], a[64:67], a[52:55], v[48:51]
  ds_read_b128 a[4:7], v7 offset:2048
  v_mfma_f32_16x16x32_bf16 v[80:83], a[64:67], a[56:59], v[80:83]
  ds_read_b128 a[8:11], v7 offset:4096
  v_mfma_f32_16x16x32_bf16 v[112:115], a[64:67], a[60:63], v[112:115]
  ds_read_b128 a[12:15], v7 offset:6144
  s_mov_b64 exec, s[36:37]
  s_add_u32 m0, s45, 43008
  s_add_u32 s40, s31, 6193152
  buffer_load_dwordx4 v6, s[16:19], s40 offen lds
  s_add_u32 m0, s45, 43904
  s_add_u32 s40, s31, 6250496
  buffer_load_dwordx4 v6, s[16:19], s40 offen lds
  s_mov_b64 exec, -1
  v_mfma_f32_16x16x32_bf16 v[32:35], a[80:83], a[48:51], v[32:35]
  ds_read_b64_tr_b16 a[16:17], v11 offset:0
  v_mfma_f32_16x16x32_bf16 v[64:67], a[80:83], a[52:55], v[64:67]
  ds_read_b64_tr_b16 a[18:19], v11 offset:3584
  v_mfma_f32_16x16x32_bf16 v[96:99], a[80:83], a[56:59], v[96:99]
  ds_read_b64_tr_b16 a[32:33], v11 offset:7168
  v_mfma_f32_16x16x32_bf16 v[128:131], a[80:83], a[60:63], v[128:131]
  ds_read_b64_tr_b16 a[34:35], v11 offset:10752
  v_mfma_f32_16x16x32_bf16 v[20:23], a[68:71], a[48:51], v[20:23]
  ds_read_b64_tr_b16 a[20:21], v11 offset:32
  v_mfma_f32_16x16x32_bf16 v[52:55], a[68:71], a[52:55], v[52:55]
  ds_read_b64_tr_b16 a[22:23], v11 offset:3616
  v_mfma_f32_16x16x32_bf16 v[84:87], a[68:71], a[56:59], v[84:87]
  ds_read_b64_tr_b16 a[36:37], v11 offset:7200
  v_mfma_f32_16x16x32_bf16 v[116:119], a[68:71], a[60:63], v[116:119]
  ds_read_b64_tr_b16 a[38:39], v11 offset:10784
  v_mfma_f32_16x16x32_bf16 v[36:39], a[84:87], a[48:51], v[36:39]
  ds_read_b64_tr_b16 a[24:25], v11 offset:64
  s_add_u32 m0, s44, 63744
  s_nop 0
  buffer_load_dwordx4 v2, s[12:15], s29 offen offset:1792 lds
  v_mfma_f32_16x16x32_bf16 v[68:71], a[84:87], a[52:55], v[68:71]
  ds_read_b64_tr_b16 a[26:27], v11 offset:3648
  v_mfma_f32_16x16x32_bf16 v[100:103], a[84:87], a[56:59], v[100:103]
  ds_read_b64_tr_b16 a[40:41], v11 offset:7232
  v_mfma_f32_16x16x32_bf16 v[132:135], a[84:87], a[60:63], v[132:135]
  ds_read_b64_tr_b16 a[42:43], v11 offset:10816
  v_mfma_f32_16x16x32_bf16 v[24:27], a[72:75], a[48:51], v[24:27]
  ds_read_b64_tr_b16 a[28:29], v11 offset:96
  v_mfma_f32_16x16x32_bf16 v[56:59], a[72:75], a[52:55], v[56:59]
  ds_read_b64_tr_b16 a[30:31], v11 offset:3680
  v_mfma_f32_16x16x32_bf16 v[88:91], a[72:75], a[56:59], v[88:91]
  ds_read_b64_tr_b16 a[44:45], v11 offset:7264
  v_mfma_f32_16x16x32_bf16 v[120:123], a[72:75], a[60:63], v[120:123]
  ds_read_b64_tr_b16 a[46:47], v11 offset:10848
  v_mfma_f32_16x16x32_bf16 v[40:43], a[88:91], a[48:51], v[40:43]
  s_add_u32 m0, s44, 64768
  s_nop 0
  buffer_load_dwordx4 v3, s[12:15], s29 offen offset:1792 lds
  v_mfma_f32_16x16x32_bf16 v[72:75], a[88:91], a[52:55], v[72:75]
  v_mfma_f32_16x16x32_bf16 v[104:107], a[88:91], a[56:59], v[104:107]
  v_mfma_f32_16x16x32_bf16 v[136:139], a[88:91], a[60:63], v[136:139]
  v_mfma_f32_16x16x32_bf16 v[28:31], a[76:79], a[48:51], v[28:31]
  v_mfma_f32_16x16x32_bf16 v[60:63], a[76:79], a[52:55], v[60:63]
  v_mfma_f32_16x16x32_bf16 v[92:95], a[76:79], a[56:59], v[92:95]
  v_mfma_f32_16x16x32_bf16 v[124:127], a[76:79], a[60:63], v[124:127]
  v_mfma_f32_16x16x32_bf16 v[44:47], a[92:95], a[48:51], v[44:47]
  v_mfma_f32_16x16x32_bf16 v[76:79], a[92:95], a[52:55], v[76:79]
  v_mfma_f32_16x16x32_bf16 v[108:111], a[92:95], a[56:59], v[108:111]
  v_mfma_f32_16x16x32_bf16 v[140:143], a[92:95], a[60:63], v[140:143]
  s_waitcnt vmcnt(10) lgkmcnt(0)
  s_barrier
  v_mfma_f32_16x16x32_bf16 v[16:19], a[16:19], a[0:3], v[16:19]
  ds_read_b128 a[48:51], v8 offset:0
  v_mfma_f32_16x16x32_bf16 v[48:51], a[16:19], a[4:7], v[48:51]
  ds_read_b128 a[52:55], v8 offset:2048
  v_mfma_f32_16x16x32_bf16 v[80:83], a[16:19], a[8:11], v[80:83]
  ds_read_b128 a[56:59], v8 offset:4096
  v_mfma_f32_16x16x32_bf16 v[112:115], a[16:19], a[12:15], v[112:115]
  ds_read_b128 a[60:63], v8 offset:6144
  s_mov_b64 exec, s[36:37]
  s_add_u32 m0, s45, 0
  s_add_u32 s40, s31, 6422528
  buffer_load_dwordx4 v6, s[16:19], s40 offen lds
  s_add_u32 m0, s45, 896
  s_add_u32 s40, s31, 6479872
  buffer_load_dwordx4 v6, s[16:19], s40 offen lds
  s_mov_b64 exec, -1
  v_mfma_f32_16x16x32_bf16 v[32:35], a[32:35], a[0:3], v[32:35]
  ds_read_b64_tr_b16 a[64:65], v11 offset:14336
  v_mfma_f32_16x16x32_bf16 v[64:67], a[32:35], a[4:7], v[64:67]
  ds_read_b64_tr_b16 a[66:67], v11 offset:17920
  v_mfma_f32_16x16x32_bf16 v[96:99], a[32:35], a[8:11], v[96:99]
  ds_read_b64_tr_b16 a[80:81], v11 offset:21504
  v_mfma_f32_16x16x32_bf16 v[128:131], a[32:35], a[12:15], v[128:131]
  ds_read_b64_tr_b16 a[82:83], v11 offset:25088
  v_mfma_f32_16x16x32_bf16 v[20:23], a[20:23], a[0:3], v[20:23]
  ds_read_b64_tr_b16 a[68:69], v11 offset:14368
  v_mfma_f32_16x16x32_bf16 v[52:55], a[20:23], a[4:7], v[52:55]
  ds_read_b64_tr_b16 a[70:71], v11 offset:17952
  v_mfma_f32_16x16x32_bf16 v[84:87], a[20:23], a[8:11], v[84:87]
  ds_read_b64_tr_b16 a[84:85], v11 offset:21536
  v_mfma_f32_16x16x32_bf16 v[116:119], a[20:23], a[12:15], v[116:119]
  ds_read_b64_tr_b16 a[86:87], v11 offset:25120
  v_mfma_f32_16x16x32_bf16 v[36:39], a[36:39], a[0:3], v[36:39]
  ds_read_b64_tr_b16 a[72:73], v11 offset:14400
  s_add_u32 m0, s44, 65792
  s_nop 0
  buffer_load_dwordx4 v4, s[12:15], s29 offen offset:1792 lds
  v_mfma_f32_16x16x32_bf16 v[68:71], a[36:39], a[4:7], v[68:71]
  ds_read_b64_tr_b16 a[74:75], v11 offset:17984
  v_mfma_f32_16x16x32_bf16 v[100:103], a[36:39], a[8:11], v[100:103]
  ds_read_b64_tr_b16 a[88:89], v11 offset:21568
  v_mfma_f32_16x16x32_bf16 v[132:135], a[36:39], a[12:15], v[132:135]
  ds_read_b64_tr_b16 a[90:91], v11 offset:25152
  v_mfma_f32_16x16x32_bf16 v[24:27], a[24:27], a[0:3], v[24:27]
  ds_read_b64_tr_b16 a[76:77], v11 offset:14432
  v_mfma_f32_16x16x32_bf16 v[56:59], a[24:27], a[4:7], v[56:59]
  ds_read_b64_tr_b16 a[78:79], v11 offset:18016
  v_mfma_f32_16x16x32_bf16 v[88:91], a[24:27], a[8:11], v[88:91]
  ds_read_b64_tr_b16 a[92:93], v11 offset:21600
  v_mfma_f32_16x16x32_bf16 v[120:123], a[24:27], a[12:15], v[120:123]
  ds_read_b64_tr_b16 a[94:95], v11 offset:25184
  v_mfma_f32_16x16x32_bf16 v[40:43], a[40:43], a[0:3], v[40:43]
  s_add_u32 m0, s44, 66816
  s_nop 0
  buffer_load_dwordx4 v5, s[12:15], s29 offen offset:1792 lds
  v_mfma_f32_16x16x32_bf16 v[72:75], a[40:43], a[4:7], v[72:75]
  v_mfma_f32_16x16x32_bf16 v[104:107], a[40:43], a[8:11], v[104:107]
  v_mfma_f32_16x16x32_bf16 v[136:139], a[40:43], a[12:15], v[136:139]
  v_mfma_f32_16x16x32_bf16 v[28:31], a[28:31], a[0:3], v[28:31]
  v_mfma_f32_16x16x32_bf16 v[60:63], a[28:31], a[4:7], v[60:63]
  v_mfma_f32_16x16x32_bf16 v[92:95], a[28:31], a[8:11], v[92:95]
  v_mfma_f32_16x16x32_bf16 v[124:127], a[28:31], a[12:15], v[124:127]
  v_mfma_f32_16x16x32_bf16 v[44:47], a[44:47], a[0:3], v[44:47]
  v_mfma_f32_16x16x32_bf16 v[76:79], a[44:47], a[4:7], v[76:79]
  v_mfma_f32_16x16x32_bf16 v[108:111], a[44:47], a[8:11], v[108:111]
  v_mfma_f32_16x16x32_bf16 v[140:143], a[44:47], a[12:15], v[140:143]
  s_waitcnt vmcnt(8) lgkmcnt(0)
  s_barrier
  v_mfma_f32_16x16x32_bf16 v[16:19], a[64:67], a[48:51], v[16:19]
  ds_read_b128 a[0:3], v7 offset:32768
  v_mfma_f32_16x16x32_bf16 v[48:51], a[64:67], a[52:55], v[48:51]
  ds_read_b128 a[4:7], v7 offset:34816
  v_mfma_f32_16x16x32_bf16 v[80:83], a[64:67], a[56:59], v[80:83]
  ds_read_b128 a[8:11], v7 offset:36864
  v_mfma_f32_16x16x32_bf16 v[112:115], a[64:67], a[60:63], v[112:115]
  ds_read_b128 a[12:15], v7 offset:38912
  s_mov_b64 exec, s[36:37]
  s_add_u32 m0, s45, 14336
  s_add_u32 s40, s31, 6651904
  buffer_load_dwordx4 v6, s[16:19], s40 offen lds
  s_add_u32 m0, s45, 15232
  s_add_u32 s40, s31, 6709248
  buffer_load_dwordx4 v6, s[16:19], s40 offen lds
  s_mov_b64 exec, -1
  v_mfma_f32_16x16x32_bf16 v[32:35], a[80:83], a[48:51], v[32:35]
  ds_read_b64_tr_b16 a[16:17], v11 offset:28672
  v_mfma_f32_16x16x32_bf16 v[64:67], a[80:83], a[52:55], v[64:67]
  ds_read_b64_tr_b16 a[18:19], v11 offset:32256
  v_mfma_f32_16x16x32_bf16 v[96:99], a[80:83], a[56:59], v[96:99]
  ds_read_b64_tr_b16 a[32:33], v11 offset:35840
  v_mfma_f32_16x16x32_bf16 v[128:131], a[80:83], a[60:63], v[128:131]
  ds_read_b64_tr_b16 a[34:35], v11 offset:39424
  v_mfma_f32_16x16x32_bf16 v[20:23], a[68:71], a[48:51], v[20:23]
  ds_read_b64_tr_b16 a[20:21], v11 offset:28704
  v_mfma_f32_16x16x32_bf16 v[52:55], a[68:71], a[52:55], v[52:55]
  ds_read_b64_tr_b16 a[22:23], v11 offset:32288
  v_mfma_f32_16x16x32_bf16 v[84:87], a[68:71], a[56:59], v[84:87]
  ds_read_b64_tr_b16 a[36:37], v11 offset:35872
  v_mfma_f32_16x16x32_bf16 v[116:119], a[68:71], a[60:63], v[116:119]
  ds_read_b64_tr_b16 a[38:39], v11 offset:39456
  v_mfma_f32_16x16x32_bf16 v[36:39], a[84:87], a[48:51], v[36:39]
  ds_read_b64_tr_b16 a[24:25], v11 offset:28736
  s_add_u32 m0, s44, 4294965376
  s_nop 0
  buffer_load_dwordx4 v2, s[12:15], s29 offen offset:1920 lds
  v_mfma_f32_16x16x32_bf16 v[68:71], a[84:87], a[52:55], v[68:71]
  ds_read_b64_tr_b16 a[26:27], v11 offset:32320
  v_mfma_f32_16x16x32_bf16 v[100:103], a[84:87], a[56:59], v[100:103]
  ds_read_b64_tr_b16 a[40:41], v11 offset:35904
  v_mfma_f32_16x16x32_bf16 v[132:135], a[84:87], a[60:63], v[132:135]
  ds_read_b64_tr_b16 a[42:43], v11 offset:39488
  v_mfma_f32_16x16x32_bf16 v[24:27], a[72:75], a[48:51], v[24:27]
  ds_read_b64_tr_b16 a[28:29], v11 offset:28768
  v_mfma_f32_16x16x32_bf16 v[56:59], a[72:75], a[52:55], v[56:59]
  ds_read_b64_tr_b16 a[30:31], v11 offset:32352
  v_mfma_f32_16x16x32_bf16 v[88:91], a[72:75], a[56:59], v[88:91]
  ds_read_b64_tr_b16 a[44:45], v11 offset:35936
  v_mfma_f32_16x16x32_bf16 v[120:123], a[72:75], a[60:63], v[120:123]
  ds_read_b64_tr_b16 a[46:47], v11 offset:39520
  v_mfma_f32_16x16x32_bf16 v[40:43], a[88:91], a[48:51], v[40:43]
  s_add_u32 m0, s44, 4294966400
  s_nop 0
  buffer_load_dwordx4 v3, s[12:15], s29 offen offset:1920 lds
  v_mfma_f32_16x16x32_bf16 v[72:75], a[88:91], a[52:55], v[72:75]
  v_mfma_f32_16x16x32_bf16 v[104:107], a[88:91], a[56:59], v[104:107]
  v_mfma_f32_16x16x32_bf16 v[136:139], a[88:91], a[60:63], v[136:139]
  v_mfma_f32_16x16x32_bf16 v[28:31], a[76:79], a[48:51], v[28:31]
  v_mfma_f32_16x16x32_bf16 v[60:63], a[76:79], a[52:55], v[60:63]
  v_mfma_f32_16x16x32_bf16 v[92:95], a[76:79], a[56:59], v[92:95]
  v_mfma_f32_16x16x32_bf16 v[124:127], a[76:79], a[60:63], v[124:127]
  v_mfma_f32_16x16x32_bf16 v[44:47], a[92:95], a[48:51], v[44:47]
  v_mfma_f32_16x16x32_bf16 v[76:79], a[92:95], a[52:55], v[76:79]
  v_mfma_f32_16x16x32_bf16 v[108:111], a[92:95], a[56:59], v[108:111]
  v_mfma_f32_16x16x32_bf16 v[140:143], a[92:95], a[60:63], v[140:143]
  s_waitcnt vmcnt(10) lgkmcnt(0)
  s_barrier
  v_mfma_f32_16x16x32_bf16 v[16:19], a[16:19], a[0:3], v[16:19]
  ds_read_b128 a[48:51], v8 offset:32768
  v_mfma_f32_16x16x32_bf16 v[48:51], a[16:19], a[4:7], v[48:51]
  ds_read_b128 a[52:55], v8 offset:34816
  v_mfma_f32_16x16x32_bf16 v[80:83], a[16:19], a[8:11], v[80:83]
  ds_read_b128 a[56:59], v8 offset:36864
  v_mfma_f32_16x16x32_bf16 v[112:115], a[16:19], a[12:15], v[112:115]
  ds_read_b128 a[60:63], v8 offset:38912
  s_mov_b64 exec, s[36:37]
  s_add_u32 m0, s45, 28672
  s_add_u32 s40, s31, 6881280
  buffer_load_dwordx4 v6, s[16:19], s40 offen lds
  s_add_u32 m0, s45, 29568
  s_add_u32 s40, s31, 6938624
  buffer_load_dwordx4 v6, s[16:19], s40 offen lds
  s_mov_b64 exec, -1
  v_mfma_f32_16x16x32_bf16 v[32:35], a[32:35], a[0:3], v[32:35]
  ds_read_b64_tr_b16 a[64:65], v11 offset:43008
  v_mfma_f32_16x16x32_bf16 v[64:67], a[32:35], a[4:7], v[64:67]
  ds_read_b64_tr_b16 a[66:67], v11 offset:46592
  v_mfma_f32_16x16x32_bf16 v[96:99], a[32:35], a[8:11], v[96:99]
  ds_read_b64_tr_b16 a[80:81], v11 offset:50176
  v_mfma_f32_16x16x32_bf16 v[128:131], a[32:35], a[12:15], v[128:131]
  ds_read_b64_tr_b16 a[82:83], v11 offset:53760
  v_mfma_f32_16x16x32_bf16 v[20:23], a[20:23], a[0:3], v[20:23]
  ds_read_b64_tr_b16 a[68:69], v11 offset:43040
  v_mfma_f32_16x16x32_bf16 v[52:55], a[20:23], a[4:7], v[52:55]
  ds_read_b64_tr_b16 a[70:71], v11 offset:46624
  v_mfma_f32_16x16x32_bf16 v[84:87], a[20:23], a[8:11], v[84:87]
  ds_read_b64_tr_b16 a[84:85], v11 offset:50208
  v_mfma_f32_16x16x32_bf16 v[116:119], a[20:23], a[12:15], v[116:119]
  ds_read_b64_tr_b16 a[86:87], v11 offset:53792
  v_mfma_f32_16x16x32_bf16 v[36:39], a[36:39], a[0:3], v[36:39]
  ds_read_b64_tr_b16 a[72:73], v11 offset:43072
  s_add_u32 m0, s44, 128
  s_nop 0
  buffer_load_dwordx4 v4, s[12:15], s29 offen offset:1920 lds
  v_mfma_f32_16x16x32_bf16 v[68:71], a[36:39], a[4:7], v[68:71]
  ds_read_b64_tr_b16 a[74:75], v11 offset:46656
  v_mfma_f32_16x16x32_bf16 v[100:103], a[36:39], a[8:11], v[100:103]
  ds_read_b64_tr_b16 a[88:89], v11 offset:50240
  v_mfma_f32_16x16x32_bf16 v[132:135], a[36:39], a[12:15], v[132:135]
  ds_read_b64_tr_b16 a[90:91], v11 offset:53824
  v_mfma_f32_16x16x32_bf16 v[24:27], a[24:27], a[0:3], v[24:27]
  ds_read_b64_tr_b16 a[76:77], v11 offset:43104
  v_mfma_f32_16x16x32_bf16 v[56:59], a[24:27], a[4:7], v[56:59]
  ds_read_b64_tr_b16 a[78:79], v11 offset:46688
  v_mfma_f32_16x16x32_bf16 v[88:91], a[24:27], a[8:11], v[88:91]
  ds_read_b64_tr_b16 a[92:93], v11 offset:50272
  v_mfma_f32_16x16x32_bf16 v[120:123], a[24:27], a[12:15], v[120:123]
  ds_read_b64_tr_b16 a[94:95], v11 offset:53856
  v_mfma_f32_16x16x32_bf16 v[40:43], a[40:43], a[0:3], v[40:43]
  s_add_u32 m0, s44, 1152
  s_nop 0
  buffer_load_dwordx4 v5, s[12:15], s29 offen offset:1920 lds
  v_mfma_f32_16x16x32_bf16 v[72:75], a[40:43], a[4:7], v[72:75]
  v_mfma_f32_16x16x32_bf16 v[104:107], a[40:43], a[8:11], v[104:107]
  v_mfma_f32_16x16x32_bf16 v[136:139], a[40:43], a[12:15], v[136:139]
  v_mfma_f32_16x16x32_bf16 v[28:31], a[28:31], a[0:3], v[28:31]
  v_mfma_f32_16x16x32_bf16 v[60:63], a[28:31], a[4:7], v[60:63]
  v_mfma_f32_16x16x32_bf16 v[92:95], a[28:31], a[8:11], v[92:95]
  v_mfma_f32_16x16x32_bf16 v[124:127], a[28:31], a[12:15], v[124:127]
  v_mfma_f32_16x16x32_bf16 v[44:47], a[44:47], a[0:3], v[44:47]
  v_mfma_f32_16x16x32_bf16 v[76:79], a[44:47], a[4:7], v[76:79]
  v_mfma_f32_16x16x32_bf16 v[108:111], a[44:47], a[8:11], v[108:111]
  v_mfma_f32_16x16x32_bf16 v[140:143], a[44:47], a[12:15], v[140:143]
  s_waitcnt vmcnt(8) lgkmcnt(0)
  s_barrier
  v_mfma_f32_16x16x32_bf16 v[16:19], a[64:67], a[48:51], v[16:19]
  ds_read_b128 a[0:3], v9 offset:0
  v_mfma_f32_16x16x32_bf16 v[48:51], a[64:67], a[52:55], v[48:51]
  ds_read_b128 a[4:7], v9 offset:2048
  v_mfma_f32_16x16x32_bf16 v[80:83], a[64:67], a[56:59], v[80:83]
  ds_read_b128 a[8:11], v9 offset:4096
  v_mfma_f32_16x16x32_bf16 v[112:115], a[64:67], a[60:63], v[112:115]
  ds_read_b128 a[12:15], v9 offset:6144
  s_mov_b64 exec, s[36:37]
  s_add_u32 m0, s45, 43008
  s_add_u32 s40, s31, 7110656
  buffer_load_dwordx4 v6, s[16:19], s40 offen lds
  s_add_u32 m0, s45, 43904
  s_add_u32 s40, s31, 7168000
  buffer_load_dwordx4 v6, s[16:19], s40 offen lds
  s_mov_b64 exec, -1
  v_mfma_f32_16x16x32_bf16 v[32:35], a[80:83], a[48:51], v[32:35]
  ds_read_b64_tr_b16 a[16:17], v11 offset:0
  v_mfma_f32_16x16x32_bf16 v[64:67], a[80:83], a[52:55], v[64:67]
  ds_read_b64_tr_b16 a[18:19], v11 offset:3584
  v_mfma_f32_16x16x32_bf16 v[96:99], a[80:83], a[56:59], v[96:99]
  ds_read_b64_tr_b16 a[32:33], v11 offset:7168
  v_mfma_f32_16x16x32_bf16 v[128:131], a[80:83], a[60:63], v[128:131]
  ds_read_b64_tr_b16 a[34:35], v11 offset:10752
  v_mfma_f32_16x16x32_bf16 v[20:23], a[68:71], a[48:51], v[20:23]
  ds_read_b64_tr_b16 a[20:21], v11 offset:32
  v_mfma_f32_16x16x32_bf16 v[52:55], a[68:71], a[52:55], v[52:55]
  ds_read_b64_tr_b16 a[22:23], v11 offset:3616
  v_mfma_f32_16x16x32_bf16 v[84:87], a[68:71], a[56:59], v[84:87]
  ds_read_b64_tr_b16 a[36:37], v11 offset:7200
  v_mfma_f32_16x16x32_bf16 v[116:119], a[68:71], a[60:63], v[116:119]
  ds_read_b64_tr_b16 a[38:39], v11 offset:10784
  v_mfma_f32_16x16x32_bf16 v[36:39], a[84:87], a[48:51], v[36:39]
  ds_read_b64_tr_b16 a[24:25], v11 offset:64
  v_mfma_f32_16x16x32_bf16 v[68:71], a[84:87], a[52:55], v[68:71]
  ds_read_b64_tr_b16 a[26:27], v11 offset:3648
  v_mfma_f32_16x16x32_bf16 v[100:103], a[84:87], a[56:59], v[100:103]
  ds_read_b64_tr_b16 a[40:41], v11 offset:7232
  v_mfma_f32_16x16x32_bf16 v[132:135], a[84:87], a[60:63], v[132:135]
  ds_read_b64_tr_b16 a[42:43], v11 offset:10816
  v_mfma_f32_16x16x32_bf16 v[24:27], a[72:75], a[48:51], v[24:27]
  ds_read_b64_tr_b16 a[28:29], v11 offset:96
  v_mfma_f32_16x16x32_bf16 v[56:59], a[72:75], a[52:55], v[56:59]
  ds_read_b64_tr_b16 a[30:31], v11 offset:3680
  v_mfma_f32_16x16x32_bf16 v[88:91], a[72:75], a[56:59], v[88:91]
  ds_read_b64_tr_b16 a[44:45], v11 offset:7264
  v_mfma_f32_16x16x32_bf16 v[120:123], a[72:75], a[60:63], v[120:123]
  ds_read_b64_tr_b16 a[46:47], v11 offset:10848
  v_mfma_f32_16x16x32_bf16 v[40:43], a[88:91], a[48:51], v[40:43]
  v_mfma_f32_16x16x32_bf16 v[72:75], a[88:91], a[52:55], v[72:75]
  v_mfma_f32_16x16x32_bf16 v[104:107], a[88:91], a[56:59], v[104:107]
  v_mfma_f32_16x16x32_bf16 v[136:139], a[88:91], a[60:63], v[136:139]
  v_mfma_f32_16x16x32_bf16 v[28:31], a[76:79], a[48:51], v[28:31]
  v_mfma_f32_16x16x32_bf16 v[60:63], a[76:79], a[52:55], v[60:63]
  v_mfma_f32_16x16x32_bf16 v[92:95], a[76:79], a[56:59], v[92:95]
  v_mfma_f32_16x16x32_bf16 v[124:127], a[76:79], a[60:63], v[124:127]
  v_mfma_f32_16x16x32_bf16 v[44:47], a[92:95], a[48:51], v[44:47]
  v_mfma_f32_16x16x32_bf16 v[76:79], a[92:95], a[52:55], v[76:79]
  v_mfma_f32_16x16x32_bf16 v[108:111], a[92:95], a[56:59], v[108:111]
  v_mfma_f32_16x16x32_bf16 v[140:143], a[92:95], a[60:63], v[140:143]
  s_waitcnt vmcnt(8) lgkmcnt(0)
  s_barrier
  v_mfma_f32_16x16x32_bf16 v[16:19], a[16:19], a[0:3], v[16:19]
  ds_read_b128 a[48:51], v10 offset:0
  v_mfma_f32_16x16x32_bf16 v[48:51], a[16:19], a[4:7], v[48:51]
  ds_read_b128 a[52:55], v10 offset:2048
  v_mfma_f32_16x16x32_bf16 v[80:83], a[16:19], a[8:11], v[80:83]
  ds_read_b128 a[56:59], v10 offset:4096
  v_mfma_f32_16x16x32_bf16 v[112:115], a[16:19], a[12:15], v[112:115]
  ds_read_b128 a[60:63], v10 offset:6144
  v_mfma_f32_16x16x32_bf16 v[32:35], a[32:35], a[0:3], v[32:35]
  ds_read_b64_tr_b16 a[64:65], v11 offset:14336
  v_mfma_f32_16x16x32_bf16 v[64:67], a[32:35], a[4:7], v[64:67]
  ds_read_b64_tr_b16 a[66:67], v11 offset:17920
  v_mfma_f32_16x16x32_bf16 v[96:99], a[32:35], a[8:11], v[96:99]
  ds_read_b64_tr_b16 a[80:81], v11 offset:21504
  v_mfma_f32_16x16x32_bf16 v[128:131], a[32:35], a[12:15], v[128:131]
  ds_read_b64_tr_b16 a[82:83], v11 offset:25088
  v_mfma_f32_16x16x32_bf16 v[20:23], a[20:23], a[0:3], v[20:23]
  ds_read_b64_tr_b16 a[68:69], v11 offset:14368
  v_mfma_f32_16x16x32_bf16 v[52:55], a[20:23], a[4:7], v[52:55]
  ds_read_b64_tr_b16 a[70:71], v11 offset:17952
  v_mfma_f32_16x16x32_bf16 v[84:87], a[20:23], a[8:11], v[84:87]
  ds_read_b64_tr_b16 a[84:85], v11 offset:21536
  v_mfma_f32_16x16x32_bf16 v[116:119], a[20:23], a[12:15], v[116:119]
  ds_read_b64_tr_b16 a[86:87], v11 offset:25120
  v_mfma_f32_16x16x32_bf16 v[36:39], a[36:39], a[0:3], v[36:39]
  ds_read_b64_tr_b16 a[72:73], v11 offset:14400
  v_mfma_f32_16x16x32_bf16 v[68:71], a[36:39], a[4:7], v[68:71]
  ds_read_b64_tr_b16 a[74:75], v11 offset:17984
  v_mfma_f32_16x16x32_bf16 v[100:103], a[36:39], a[8:11], v[100:103]
  ds_read_b64_tr_b16 a[88:89], v11 offset:21568
  v_mfma_f32_16x16x32_bf16 v[132:135], a[36:39], a[12:15], v[132:135]
  ds_read_b64_tr_b16 a[90:91], v11 offset:25152
  v_mfma_f32_16x16x32_bf16 v[24:27], a[24:27], a[0:3], v[24:27]
  ds_read_b64_tr_b16 a[76:77], v11 offset:14432
  v_mfma_f32_16x16x32_bf16 v[56:59], a[24:27], a[4:7], v[56:59]
  ds_read_b64_tr_b16 a[78:79], v11 offset:18016
  v_mfma_f32_16x16x32_bf16 v[88:91], a[24:27], a[8:11], v[88:91]
  ds_read_b64_tr_b16 a[92:93], v11 offset:21600
  v_mfma_f32_16x16x32_bf16 v[120:123], a[24:27], a[12:15], v[120:123]
  ds_read_b64_tr_b16 a[94:95], v11 offset:25184
  v_mfma_f32_16x16x32_bf16 v[40:43], a[40:43], a[0:3], v[40:43]
  v_mfma_f32_16x16x32_bf16 v[72:75], a[40:43], a[4:7], v[72:75]
  v_mfma_f32_16x16x32_bf16 v[104:107], a[40:43], a[8:11], v[104:107]
  v_mfma_f32_16x16x32_bf16 v[136:139], a[40:43], a[12:15], v[136:139]
  v_mfma_f32_16x16x32_bf16 v[28:31], a[28:31], a[0:3], v[28:31]
  v_mfma_f32_16x16x32_bf16 v[60:63], a[28:31], a[4:7], v[60:63]
  v_mfma_f32_16x16x32_bf16 v[92:95], a[28:31], a[8:11], v[92:95]
  v_mfma_f32_16x16x32_bf16 v[124:127], a[28:31], a[12:15], v[124:127]
  v_mfma_f32_16x16x32_bf16 v[44:47], a[44:47], a[0:3], v[44:47]
  v_mfma_f32_16x16x32_bf16 v[76:79], a[44:47], a[4:7], v[76:79]
  v_mfma_f32_16x16x32_bf16 v[108:111], a[44:47], a[8:11], v[108:111]
  v_mfma_f32_16x16x32_bf16 v[140:143], a[44:47], a[12:15], v[140:143]
  s_waitcnt vmcnt(2) lgkmcnt(0)
  s_barrier
  v_mfma_f32_16x16x32_bf16 v[16:19], a[64:67], a[48:51], v[16:19]
  ds_read_b128 a[0:3], v7 offset:0
  v_mfma_f32_16x16x32_bf16 v[48:51], a[64:67], a[52:55], v[48:51]
  ds_read_b128 a[4:7], v7 offset:2048
  v_mfma_f32_16x16x32_bf16 v[80:83], a[64:67], a[56:59], v[80:83]
  ds_read_b128 a[8:11], v7 offset:4096
  v_mfma_f32_16x16x32_bf16 v[112:115], a[64:67], a[60:63], v[112:115]
  ds_read_b128 a[12:15], v7 offset:6144
  v_mfma_f32_16x16x32_bf16 v[32:35], a[80:83], a[48:51], v[32:35]
  ds_read_b64_tr_b16 a[16:17], v11 offset:28672
  v_mfma_f32_16x16x32_bf16 v[64:67], a[80:83], a[52:55], v[64:67]
  ds_read_b64_tr_b16 a[18:19], v11 offset:32256
  v_mfma_f32_16x16x32_bf16 v[96:99], a[80:83], a[56:59], v[96:99]
  ds_read_b64_tr_b16 a[32:33], v11 offset:35840
  v_mfma_f32_16x16x32_bf16 v[128:131], a[80:83], a[60:63], v[128:131]
  ds_read_b64_tr_b16 a[34:35], v11 offset:39424
  v_mfma_f32_16x16x32_bf16 v[20:23], a[68:71], a[48:51], v[20:23]
  ds_read_b64_tr_b16 a[20:21], v11 offset:28704
  v_mfma_f32_16x16x32_bf16 v[52:55], a[68:71], a[52:55], v[52:55]
  ds_read_b64_tr_b16 a[22:23], v11 offset:32288
  v_mfma_f32_16x16x32_bf16 v[84:87], a[68:71], a[56:59], v[84:87]
  ds_read_b64_tr_b16 a[36:37], v11 offset:35872
  v_mfma_f32_16x16x32_bf16 v[116:119], a[68:71], a[60:63], v[116:119]
  ds_read_b64_tr_b16 a[38:39], v11 offset:39456
  v_mfma_f32_16x16x32_bf16 v[36:39], a[84:87], a[48:51], v[36:39]
  ds_read_b64_tr_b16 a[24:25], v11 offset:28736
  v_mfma_f32_16x16x32_bf16 v[68:71], a[84:87], a[52:55], v[68:71]
  ds_read_b64_tr_b16 a[26:27], v11 offset:32320
  v_mfma_f32_16x16x32_bf16 v[100:103], a[84:87], a[56:59], v[100:103]
  ds_read_b64_tr_b16 a[40:41], v11 offset:35904
  v_mfma_f32_16x16x32_bf16 v[132:135], a[84:87], a[60:63], v[132:135]
  ds_read_b64_tr_b16 a[42:43], v11 offset:39488
  v_mfma_f32_16x16x32_bf16 v[24:27], a[72:75], a[48:51], v[24:27]
  ds_read_b64_tr_b16 a[28:29], v11 offset:28768
  v_mfma_f32_16x16x32_bf16 v[56:59], a[72:75], a[52:55], v[56:59]
  ds_read_b64_tr_b16 a[30:31], v11 offset:32352
  v_mfma_f32_16x16x32_bf16 v[88:91], a[72:75], a[56:59], v[88:91]
  ds_read_b64_tr_b16 a[44:45], v11 offset:35936
  v_mfma_f32_16x16x32_bf16 v[120:123], a[72:75], a[60:63], v[120:123]
  ds_read_b64_tr_b16 a[46:47], v11 offset:39520
  v_mfma_f32_16x16x32_bf16 v[40:43], a[88:91], a[48:51], v[40:43]
  v_mfma_f32_16x16x32_bf16 v[72:75], a[88:91], a[52:55], v[72:75]
  v_mfma_f32_16x16x32_bf16 v[104:107], a[88:91], a[56:59], v[104:107]
  v_mfma_f32_16x16x32_bf16 v[136:139], a[88:91], a[60:63], v[136:139]
  v_mfma_f32_16x16x32_bf16 v[28:31], a[76:79], a[48:51], v[28:31]
  v_mfma_f32_16x16x32_bf16 v[60:63], a[76:79], a[52:55], v[60:63]
  v_mfma_f32_16x16x32_bf16 v[92:95], a[76:79], a[56:59], v[92:95]
  v_mfma_f32_16x16x32_bf16 v[124:127], a[76:79], a[60:63], v[124:127]
  v_mfma_f32_16x16x32_bf16 v[44:47], a[92:95], a[48:51], v[44:47]
  v_mfma_f32_16x16x32_bf16 v[76:79], a[92:95], a[52:55], v[76:79]
  v_mfma_f32_16x16x32_bf16 v[108:111], a[92:95], a[56:59], v[108:111]
  v_mfma_f32_16x16x32_bf16 v[140:143], a[92:95], a[60:63], v[140:143]
  s_waitcnt vmcnt(0) lgkmcnt(0)
  s_barrier
  v_mfma_f32_16x16x32_bf16 v[16:19], a[16:19], a[0:3], v[16:19]
  ds_read_b128 a[48:51], v8 offset:0
  v_mfma_f32_16x16x32_bf16 v[48:51], a[16:19], a[4:7], v[48:51]
  ds_read_b128 a[52:55], v8 offset:2048
  v_mfma_f32_16x16x32_bf16 v[80:83], a[16:19], a[8:11], v[80:83]
  ds_read_b128 a[56:59], v8 offset:4096
  v_mfma_f32_16x16x32_bf16 v[112:115], a[16:19], a[12:15], v[112:115]
  ds_read_b128 a[60:63], v8 offset:6144
  v_mfma_f32_16x16x32_bf16 v[32:35], a[32:35], a[0:3], v[32:35]
  ds_read_b64_tr_b16 a[64:65], v11 offset:43008
  v_mfma_f32_16x16x32_bf16 v[64:67], a[32:35], a[4:7], v[64:67]
  ds_read_b64_tr_b16 a[66:67], v11 offset:46592
  v_mfma_f32_16x16x32_bf16 v[96:99], a[32:35], a[8:11], v[96:99]
  ds_read_b64_tr_b16 a[80:81], v11 offset:50176
  v_mfma_f32_16x16x32_bf16 v[128:131], a[32:35], a[12:15], v[128:131]
  ds_read_b64_tr_b16 a[82:83], v11 offset:53760
  v_mfma_f32_16x16x32_bf16 v[20:23], a[20:23], a[0:3], v[20:23]
  ds_read_b64_tr_b16 a[68:69], v11 offset:43040
  v_mfma_f32_16x16x32_bf16 v[52:55], a[20:23], a[4:7], v[52:55]
  ds_read_b64_tr_b16 a[70:71], v11 offset:46624
  v_mfma_f32_16x16x32_bf16 v[84:87], a[20:23], a[8:11], v[84:87]
  ds_read_b64_tr_b16 a[84:85], v11 offset:50208
  v_mfma_f32_16x16x32_bf16 v[116:119], a[20:23], a[12:15], v[116:119]
  ds_read_b64_tr_b16 a[86:87], v11 offset:53792
  v_mfma_f32_16x16x32_bf16 v[36:39], a[36:39], a[0:3], v[36:39]
  ds_read_b64_tr_b16 a[72:73], v11 offset:43072
  v_mfma_f32_16x16x32_bf16 v[68:71], a[36:39], a[4:7], v[68:71]
  ds_read_b64_tr_b16 a[74:75], v11 offset:46656
  v_mfma_f32_16x16x32_bf16 v[100:103], a[36:39], a[8:11], v[100:103]
  ds_read_b64_tr_b16 a[88:89], v11 offset:50240
  v_mfma_f32_16x16x32_bf16 v[132:135], a[36:39], a[12:15], v[132:135]
  ds_read_b64_tr_b16 a[90:91], v11 offset:53824
  v_mfma_f32_16x16x32_bf16 v[24:27], a[24:27], a[0:3], v[24:27]
  ds_read_b64_tr_b16 a[76:77], v11 offset:43104
  v_mfma_f32_16x16x32_bf16 v[56:59], a[24:27], a[4:7], v[56:59]
  ds_read_b64_tr_b16 a[78:79], v11 offset:46688
  v_mfma_f32_16x16x32_bf16 v[88:91], a[24:27], a[8:11], v[88:91]
  ds_read_b64_tr_b16 a[92:93], v11 offset:50272
  v_mfma_f32_16x16x32_bf16 v[120:123], a[24:27], a[12:15], v[120:123]
  ds_read_b64_tr_b16 a[94:95], v11 offset:53856
  v_mfma_f32_16x16x32_bf16 v[40:43], a[40:43], a[0:3], v[40:43]
  v_mfma_f32_16x16x32_bf16 v[72:75], a[40:43], a[4:7], v[72:75]
  v_mfma_f32_16x16x32_bf16 v[104:107], a[40:43], a[8:11], v[104:107]
  v_mfma_f32_16x16x32_bf16 v[136:139], a[40:43], a[12:15], v[136:139]
  v_mfma_f32_16x16x32_bf16 v[28:31], a[28:31], a[0:3], v[28:31]
  v_mfma_f32_16x16x32_bf16 v[60:63], a[28:31], a[4:7], v[60:63]
  v_mfma_f32_16x16x32_bf16 v[92:95], a[28:31], a[8:11], v[92:95]
  v_mfma_f32_16x16x32_bf16 v[124:127], a[28:31], a[12:15], v[124:127]
  v_mfma_f32_16x16x32_bf16 v[44:47], a[44:47], a[0:3], v[44:47]
  v_mfma_f32_16x16x32_bf16 v[76:79], a[44:47], a[4:7], v[76:79]
  v_mfma_f32_16x16x32_bf16 v[108:111], a[44:47], a[8:11], v[108:111]
  v_mfma_f32_16x16x32_bf16 v[140:143], a[44:47], a[12:15], v[140:143]
  s_waitcnt lgkmcnt(0)
  v_mfma_f32_16x16x32_bf16 v[16:19], a[64:67], a[48:51], v[16:19]
  v_mfma_f32_16x16x32_bf16 v[48:51], a[64:67], a[52:55], v[48:51]
  v_mfma_f32_16x16x32_bf16 v[80:83], a[64:67], a[56:59], v[80:83]
  v_mfma_f32_16x16x32_bf16 v[112:115], a[64:67], a[60:63], v[112:115]
  v_mfma_f32_16x16x32_bf16 v[32:35], a[80:83], a[48:51], v[32:35]
  v_mfma_f32_16x16x32_bf16 v[64:67], a[80:83], a[52:55], v[64:67]
  v_mfma_f32_16x16x32_bf16 v[96:99], a[80:83], a[56:59], v[96:99]
  v_mfma_f32_16x16x32_bf16 v[128:131], a[80:83], a[60:63], v[128:131]
  v_mfma_f32_16x16x32_bf16 v[20:23], a[68:71], a[48:51], v[20:23]
  v_mfma_f32_16x16x32_bf16 v[52:55], a[68:71], a[52:55], v[52:55]
  v_mfma_f32_16x16x32_bf16 v[84:87], a[68:71], a[56:59], v[84:87]
  v_mfma_f32_16x16x32_bf16 v[116:119], a[68:71], a[60:63], v[116:119]
  v_mfma_f32_16x16x32_bf16 v[36:39], a[84:87], a[48:51], v[36:39]
  v_mfma_f32_16x16x32_bf16 v[68:71], a[84:87], a[52:55], v[68:71]
  v_mfma_f32_16x16x32_bf16 v[100:103], a[84:87], a[56:59], v[100:103]
  v_mfma_f32_16x16x32_bf16 v[132:135], a[84:87], a[60:63], v[132:135]
  v_mfma_f32_16x16x32_bf16 v[24:27], a[72:75], a[48:51], v[24:27]
  v_mfma_f32_16x16x32_bf16 v[56:59], a[72:75], a[52:55], v[56:59]
  v_mfma_f32_16x16x32_bf16 v[88:91], a[72:75], a[56:59], v[88:91]
  v_mfma_f32_16x16x32_bf16 v[120:123], a[72:75], a[60:63], v[120:123]
  v_mfma_f32_16x16x32_bf16 v[40:43], a[88:91], a[48:51], v[40:43]
  v_mfma_f32_16x16x32_bf16 v[72:75], a[88:91], a[52:55], v[72:75]
  v_mfma_f32_16x16x32_bf16 v[104:107], a[88:91], a[56:59], v[104:107]
  v_mfma_f32_16x16x32_bf16 v[136:139], a[88:91], a[60:63], v[136:139]
  v_mfma_f32_16x16x32_bf16 v[28:31], a[76:79], a[48:51], v[28:31]
  v_mfma_f32_16x16x32_bf16 v[60:63], a[76:79], a[52:55], v[60:63]
  v_mfma_f32_16x16x32_bf16 v[92:95], a[76:79], a[56:59], v[92:95]
  v_mfma_f32_16x16x32_bf16 v[124:127], a[76:79], a[60:63], v[124:127]
  v_mfma_f32_16x16x32_bf16 v[44:47], a[92:95], a[48:51], v[44:47]
  v_mfma_f32_16x16x32_bf16 v[76:79], a[92:95], a[52:55], v[76:79]
  v_mfma_f32_16x16x32_bf16 v[108:111], a[92:95], a[56:59], v[108:111]
  v_mfma_f32_16x16x32_bf16 v[140:143], a[92:95], a[60:63], v[140:143]
  v_mov_b32 v144, 0xbdd2d3e8
  v_mov_b32 v145, 0xbdd2d3e8
  v_mov_b32 v146, 0xc0135761
  v_mov_b32 v147, 0xc0135761
  v_mov_b32 v148, 1.0
  v_mov_b32 v149, 1.0
  v_lshlrev_b32 v12, 4, v1
  s_lshl_b32 s40, s24, 4
  s_lshl_b32 s41, s27, 2
  s_add_u32 s40, s40, s41
  s_mul_i32 s40, s40, 114688
  s_mul_i32 s41, s25, 7
  s_lshr_b32 s42, s41, 1
  s_lshl_b32 s42, s42, 10
  s_add_u32 s52, s40, s42
  s_add_u32 s53, s52, 114688
  s_add_u32 s54, s53, 114688
  s_add_u32 s55, s54, 114688
  s_and_b32 s56, s25, 1
  s_nop 7
  v_pk_mul_f32 v[152:153], v[16:17], v[16:17]
  v_pk_mul_f32 v[154:155], v[18:19], v[18:19]
  v_pk_mul_f32 v[156:157], v[48:49], v[48:49]
  v_pk_mul_f32 v[158:159], v[50:51], v[50:51]
  v_pk_fma_f32 v[152:153], v[152:153], v[144:145], v[146:147]
  v_pk_fma_f32 v[154:155], v[154:155], v[144:145], v[146:147]
  v_pk_fma_f32 v[156:157], v[156:157], v[144:145], v[146:147]
  v_pk_fma_f32 v[158:159], v[158:159], v[144:145], v[146:147]
  v_pk_mul_f32 v[152:153], v[152:153], v[16:17]
  v_pk_mul_f32 v[154:155], v[154:155], v[18:19]
  v_pk_mul_f32 v[156:157], v[156:157], v[48:49]
  v_pk_mul_f32 v[158:159], v[158:159], v[50:51]
  v_exp_f32 v152, v152
  v_exp_f32 v153, v153
  v_exp_f32 v154, v154
  v_exp_f32 v155, v155
  v_exp_f32 v156, v156
  v_exp_f32 v157, v157
  v_exp_f32 v158, v158
  v_exp_f32 v159, v159
  v_pk_mul_f32 v[32:33], v[16:17], v[32:33]
  v_pk_mul_f32 v[34:35], v[18:19], v[34:35]
  v_pk_mul_f32 v[64:65], v[48:49], v[64:65]
  v_pk_mul_f32 v[66:67], v[50:51], v[66:67]
  v_pk_add_f32 v[152:153], v[152:153], v[148:149]
  v_pk_add_f32 v[154:155], v[154:155], v[148:149]
  v_pk_add_f32 v[156:157], v[156:157], v[148:149]
  v_pk_add_f32 v[158:159], v[158:159], v[148:149]
  v_rcp_f32 v152, v152
  v_rcp_f32 v153, v153
  v_rcp_f32 v154, v154
  v_rcp_f32 v155, v155
  v_rcp_f32 v156, v156
  v_rcp_f32 v157, v157
  v_rcp_f32 v158, v158
  v_rcp_f32 v159, v159
  s_nop 0
  v_pk_mul_f32 v[152:153], v[152:153], v[32:33]
  v_pk_mul_f32 v[154:155], v[154:155], v[34:35]
  v_pk_mul_f32 v[156:157], v[156:157], v[64:65]
  v_pk_mul_f32 v[158:159], v[158:159], v[66:67]
  v_cvt_pk_bf16_f32 v16, v152, v153
  v_cvt_pk_bf16_f32 v17, v154, v155
  v_cvt_pk_bf16_f32 v48, v156, v157
  v_cvt_pk_bf16_f32 v49, v158, v159
  v_pk_mul_f32 v[152:153], v[80:81], v[80:81]
  v_pk_mul_f32 v[154:155], v[82:83], v[82:83]
  v_pk_mul_f32 v[156:157], v[112:113], v[112:113]
  v_pk_mul_f32 v[158:159], v[114:115], v[114:115]
  v_pk_fma_f32 v[152:153], v[152:153], v[144:145], v[146:147]
  v_pk_fma_f32 v[154:155], v[154:155], v[144:145], v[146:147]
  v_pk_fma_f32 v[156:157], v[156:157], v[144:145], v[146:147]
  v_pk_fma_f32 v[158:159], v[158:159], v[144:145], v[146:147]
  v_pk_mul_f32 v[152:153], v[152:153], v[80:81]
  v_pk_mul_f32 v[154:155], v[154:155], v[82:83]
  v_pk_mul_f32 v[156:157], v[156:157], v[112:113]
  v_pk_mul_f32 v[158:159], v[158:159], v[114:115]
  v_exp_f32 v152, v152
  v_exp_f32 v153, v153
  v_exp_f32 v154, v154
  v_exp_f32 v155, v155
  v_exp_f32 v156, v156
  v_exp_f32 v157, v157
  v_exp_f32 v158, v158
  v_exp_f32 v159, v159
  v_pk_mul_f32 v[96:97], v[80:81], v[96:97]
  v_pk_mul_f32 v[98:99], v[82:83], v[98:99]
  v_pk_mul_f32 v[128:129], v[112:113], v[128:129]
  v_pk_mul_f32 v[130:131], v[114:115], v[130:131]
  v_pk_add_f32 v[152:153], v[152:153], v[148:149]
  v_pk_add_f32 v[154:155], v[154:155], v[148:149]
  v_pk_add_f32 v[156:157], v[156:157], v[148:149]
  v_pk_add_f32 v[158:159], v[158:159], v[148:149]
  v_rcp_f32 v152, v152
  v_rcp_f32 v153, v153
  v_rcp_f32 v154, v154
  v_rcp_f32 v155, v155
  v_rcp_f32 v156, v156
  v_rcp_f32 v157, v157
  v_rcp_f32 v158, v158
  v_rcp_f32 v159, v159
  s_nop 0
  v_pk_mul_f32 v[152:153], v[152:153], v[96:97]
  v_pk_mul_f32 v[154:155], v[154:155], v[98:99]
  v_pk_mul_f32 v[156:157], v[156:157], v[128:129]
  v_pk_mul_f32 v[158:159], v[158:159], v[130:131]
  v_cvt_pk_bf16_f32 v80, v152, v153
  v_cvt_pk_bf16_f32 v81, v154, v155
  v_cvt_pk_bf16_f32 v112, v156, v157
  v_cvt_pk_bf16_f32 v113, v158, v159
  v_pk_mul_f32 v[152:153], v[20:21], v[20:21]
  v_pk_mul_f32 v[154:155], v[22:23], v[22:23]
  v_pk_mul_f32 v[156:157], v[52:53], v[52:53]
  v_pk_mul_f32 v[158:159], v[54:55], v[54:55]
  v_pk_fma_f32 v[152:153], v[152:153], v[144:145], v[146:147]
  v_pk_fma_f32 v[154:155], v[154:155], v[144:145], v[146:147]
  v_pk_fma_f32 v[156:157], v[156:157], v[144:145], v[146:147]
  v_pk_fma_f32 v[158:159], v[158:159], v[144:145], v[146:147]
  v_pk_mul_f32 v[152:153], v[152:153], v[20:21]
  v_pk_mul_f32 v[154:155], v[154:155], v[22:23]
  v_pk_mul_f32 v[156:157], v[156:157], v[52:53]
  v_pk_mul_f32 v[158:159], v[158:159], v[54:55]
  v_exp_f32 v152, v152
  v_exp_f32 v153, v153
  v_exp_f32 v154, v154
  v_exp_f32 v155, v155
  v_exp_f32 v156, v156
  v_exp_f32 v157, v157
  v_exp_f32 v158, v158
  v_exp_f32 v159, v159
  v_pk_mul_f32 v[36:37], v[20:21], v[36:37]
  v_pk_mul_f32 v[38:39], v[22:23], v[38:39]
  v_pk_mul_f32 v[68:69], v[52:53], v[68:69]
  v_pk_mul_f32 v[70:71], v[54:55], v[70:71]
  v_pk_add_f32 v[152:153], v[152:153], v[148:149]
  v_pk_add_f32 v[154:155], v[154:155], v[148:149]
  v_pk_add_f32 v[156:157], v[156:157], v[148:149]
  v_pk_add_f32 v[158:159], v[158:159], v[148:149]
  v_rcp_f32 v152, v152
  v_rcp_f32 v153, v153
  v_rcp_f32 v154, v154
  v_rcp_f32 v155, v155
  v_rcp_f32 v156, v156
  v_rcp_f32 v157, v157
  v_rcp_f32 v158, v158
  v_rcp_f32 v159, v159
  s_nop 0
  v_pk_mul_f32 v[152:153], v[152:153], v[36:37]
  v_pk_mul_f32 v[154:155], v[154:155], v[38:39]
  v_pk_mul_f32 v[156:157], v[156:157], v[68:69]
  v_pk_mul_f32 v[158:159], v[158:159], v[70:71]
  v_cvt_pk_bf16_f32 v18, v152, v153
  v_cvt_pk_bf16_f32 v19, v154, v155
  v_cvt_pk_bf16_f32 v50, v156, v157
  v_cvt_pk_bf16_f32 v51, v158, v159
  v_pk_mul_f32 v[152:153], v[84:85], v[84:85]
  v_pk_mul_f32 v[154:155], v[86:87], v[86:87]
  v_pk_mul_f32 v[156:157], v[116:117], v[116:117]
  v_pk_mul_f32 v[158:159], v[118:119], v[118:119]
  v_pk_fma_f32 v[152:153], v[152:153], v[144:145], v[146:147]
  v_pk_fma_f32 v[154:155], v[154:155], v[144:145], v[146:147]
  v_pk_fma_f32 v[156:157], v[156:157], v[144:145], v[146:147]
  v_pk_fma_f32 v[158:159], v[158:159], v[144:145], v[146:147]
  v_pk_mul_f32 v[152:153], v[152:153], v[84:85]
  v_pk_mul_f32 v[154:155], v[154:155], v[86:87]
  v_pk_mul_f32 v[156:157], v[156:157], v[116:117]
  v_pk_mul_f32 v[158:159], v[158:159], v[118:119]
  v_exp_f32 v152, v152
  v_exp_f32 v153, v153
  v_exp_f32 v154, v154
  v_exp_f32 v155, v155
  v_exp_f32 v156, v156
  v_exp_f32 v157, v157
  v_exp_f32 v158, v158
  v_exp_f32 v159, v159
  v_pk_mul_f32 v[100:101], v[84:85], v[100:101]
  v_pk_mul_f32 v[102:103], v[86:87], v[102:103]
  v_pk_mul_f32 v[132:133], v[116:117], v[132:133]
  v_pk_mul_f32 v[134:135], v[118:119], v[134:135]
  v_pk_add_f32 v[152:153], v[152:153], v[148:149]
  v_pk_add_f32 v[154:155], v[154:155], v[148:149]
  v_pk_add_f32 v[156:157], v[156:157], v[148:149]
  v_pk_add_f32 v[158:159], v[158:159], v[148:149]
  v_rcp_f32 v152, v152
  v_rcp_f32 v153, v153
  v_rcp_f32 v154, v154
  v_rcp_f32 v155, v155
  v_rcp_f32 v156, v156
  v_rcp_f32 v157, v157
  v_rcp_f32 v158, v158
  v_rcp_f32 v159, v159
  s_nop 0
  v_pk_mul_f32 v[152:153], v[152:153], v[100:101]
  v_pk_mul_f32 v[154:155], v[154:155], v[102:103]
  v_pk_mul_f32 v[156:157], v[156:157], v[132:133]
  v_pk_mul_f32 v[158:159], v[158:159], v[134:135]
  v_cvt_pk_bf16_f32 v82, v152, v153
  v_cvt_pk_bf16_f32 v83, v154, v155
  v_cvt_pk_bf16_f32 v114, v156, v157
  v_cvt_pk_bf16_f32 v115, v158, v159
  v_pk_mul_f32 v[152:153], v[24:25], v[24:25]
  v_pk_mul_f32 v[154:155], v[26:27], v[26:27]
  v_pk_mul_f32 v[156:157], v[56:57], v[56:57]
  v_pk_mul_f32 v[158:159], v[58:59], v[58:59]
  v_pk_fma_f32 v[152:153], v[152:153], v[144:145], v[146:147]
  v_pk_fma_f32 v[154:155], v[154:155], v[144:145], v[146:147]
  v_pk_fma_f32 v[156:157], v[156:157], v[144:145], v[146:147]
  v_pk_fma_f32 v[158:159], v[158:159], v[144:145], v[146:147]
  v_pk_mul_f32 v[152:153], v[152:153], v[24:25]
  v_pk_mul_f32 v[154:155], v[154:155], v[26:27]
  v_pk_mul_f32 v[156:157], v[156:157], v[56:57]
  v_pk_mul_f32 v[158:159], v[158:159], v[58:59]
  v_exp_f32 v152, v152
  v_exp_f32 v153, v153
  v_exp_f32 v154, v154
  v_exp_f32 v155, v155
  v_exp_f32 v156, v156
  v_exp_f32 v157, v157
  v_exp_f32 v158, v158
  v_exp_f32 v159, v159
  v_pk_mul_f32 v[40:41], v[24:25], v[40:41]
  v_pk_mul_f32 v[42:43], v[26:27], v[42:43]
  v_pk_mul_f32 v[72:73], v[56:57], v[72:73]
  v_pk_mul_f32 v[74:75], v[58:59], v[74:75]
  v_pk_add_f32 v[152:153], v[152:153], v[148:149]
  v_pk_add_f32 v[154:155], v[154:155], v[148:149]
  v_pk_add_f32 v[156:157], v[156:157], v[148:149]
  v_pk_add_f32 v[158:159], v[158:159], v[148:149]
  v_rcp_f32 v152, v152
  v_rcp_f32 v153, v153
  v_rcp_f32 v154, v154
  v_rcp_f32 v155, v155
  v_rcp_f32 v156, v156
  v_rcp_f32 v157, v157
  v_rcp_f32 v158, v158
  v_rcp_f32 v159, v159
  s_nop 0
  v_pk_mul_f32 v[152:153], v[152:153], v[40:41]
  v_pk_mul_f32 v[154:155], v[154:155], v[42:43]
  v_pk_mul_f32 v[156:157], v[156:157], v[72:73]
  v_pk_mul_f32 v[158:159], v[158:159], v[74:75]
  v_cvt_pk_bf16_f32 v20, v152, v153
  v_cvt_pk_bf16_f32 v21, v154, v155
  v_cvt_pk_bf16_f32 v52, v156, v157
  v_cvt_pk_bf16_f32 v53, v158, v159
  v_pk_mul_f32 v[152:153], v[88:89], v[88:89]
  v_pk_mul_f32 v[154:155], v[90:91], v[90:91]
  v_pk_mul_f32 v[156:157], v[120:121], v[120:121]
  v_pk_mul_f32 v[158:159], v[122:123], v[122:123]
  v_pk_fma_f32 v[152:153], v[152:153], v[144:145], v[146:147]
  v_pk_fma_f32 v[154:155], v[154:155], v[144:145], v[146:147]
  v_pk_fma_f32 v[156:157], v[156:157], v[144:145], v[146:147]
  v_pk_fma_f32 v[158:159], v[158:159], v[144:145], v[146:147]
  v_pk_mul_f32 v[152:153], v[152:153], v[88:89]
  v_pk_mul_f32 v[154:155], v[154:155], v[90:91]
  v_pk_mul_f32 v[156:157], v[156:157], v[120:121]
  v_pk_mul_f32 v[158:159], v[158:159], v[122:123]
  v_exp_f32 v152, v152
  v_exp_f32 v153, v153
  v_exp_f32 v154, v154
  v_exp_f32 v155, v155
  v_exp_f32 v156, v156
  v_exp_f32 v157, v157
  v_exp_f32 v158, v158
  v_exp_f32 v159, v159
  v_pk_mul_f32 v[104:105], v[88:89], v[104:105]
  v_pk_mul_f32 v[106:107], v[90:91], v[106:107]
  v_pk_mul_f32 v[136:137], v[120:121], v[136:137]
  v_pk_mul_f32 v[138:139], v[122:123], v[138:139]
  v_pk_add_f32 v[152:153], v[152:153], v[148:149]
  v_pk_add_f32 v[154:155], v[154:155], v[148:149]
  v_pk_add_f32 v[156:157], v[156:157], v[148:149]
  v_pk_add_f32 v[158:159], v[158:159], v[148:149]
  v_rcp_f32 v152, v152
  v_rcp_f32 v153, v153
  v_rcp_f32 v154, v154
  v_rcp_f32 v155, v155
  v_rcp_f32 v156, v156
  v_rcp_f32 v157, v157
  v_rcp_f32 v158, v158
  v_rcp_f32 v159, v159
  s_nop 0
  v_pk_mul_f32 v[152:153], v[152:153], v[104:105]
  v_pk_mul_f32 v[154:155], v[154:155], v[106:107]
  v_pk_mul_f32 v[156:157], v[156:157], v[136:137]
  v_pk_mul_f32 v[158:159], v[158:159], v[138:139]
  v_cvt_pk_bf16_f32 v84, v152, v153
  v_cvt_pk_bf16_f32 v85, v154, v155
  v_cvt_pk_bf16_f32 v116, v156, v157
  v_cvt_pk_bf16_f32 v117, v158, v159
  v_pk_mul_f32 v[152:153], v[28:29], v[28:29]
  v_pk_mul_f32 v[154:155], v[30:31], v[30:31]
  v_pk_mul_f32 v[156:157], v[60:61], v[60:61]
  v_pk_mul_f32 v[158:159], v[62:63], v[62:63]
  v_pk_fma_f32 v[152:153], v[152:153], v[144:145], v[146:147]
  v_pk_fma_f32 v[154:155], v[154:155], v[144:145], v[146:147]
  v_pk_fma_f32 v[156:157], v[156:157], v[144:145], v[146:147]
  v_pk_fma_f32 v[158:159], v[158:159], v[144:145], v[146:147]
  v_pk_mul_f32 v[152:153], v[152:153], v[28:29]
  v_pk_mul_f32 v[154:155], v[154:155], v[30:31]
  v_pk_mul_f32 v[156:157], v[156:157], v[60:61]
  v_pk_mul_f32 v[158:159], v[158:159], v[62:63]
  v_exp_f32 v152, v152
  v_exp_f32 v153, v153
  v_exp_f32 v154, v154
  v_exp_f32 v155, v155
  v_exp_f32 v156, v156
  v_exp_f32 v157, v157
  v_exp_f32 v158, v158
  v_exp_f32 v159, v159
  v_pk_mul_f32 v[44:45], v[28:29], v[44:45]
  v_pk_mul_f32 v[46:47], v[30:31], v[46:47]
  v_pk_mul_f32 v[76:77], v[60:61], v[76:77]
  v_pk_mul_f32 v[78:79], v[62:63], v[78:79]
  v_pk_add_f32 v[152:153], v[152:153], v[148:149]
  v_pk_add_f32 v[154:155], v[154:155], v[148:149]
  v_pk_add_f32 v[156:157], v[156:157], v[148:149]
  v_pk_add_f32 v[158:159], v[158:159], v[148:149]
  v_rcp_f32 v152, v152
  v_rcp_f32 v153, v153
  v_rcp_f32 v154, v154
  v_rcp_f32 v155, v155
  v_rcp_f32 v156, v156
  v_rcp_f32 v157, v157
  v_rcp_f32 v158, v158
  v_rcp_f32 v159, v159
  s_nop 0
  v_pk_mul_f32 v[152:153], v[152:153], v[44:45]
  v_pk_mul_f32 v[154:155], v[154:155], v[46:47]
  v_pk_mul_f32 v[156:157], v[156:157], v[76:77]
  v_pk_mul_f32 v[158:159], v[158:159], v[78:79]
  v_cvt_pk_bf16_f32 v22, v152, v153
  v_cvt_pk_bf16_f32 v23, v154, v155
  v_cvt_pk_bf16_f32 v54, v156, v157
  v_cvt_pk_bf16_f32 v55, v158, v159
  v_pk_mul_f32 v[152:153], v[92:93], v[92:93]
  v_pk_mul_f32 v[154:155], v[94:95], v[94:95]
  v_pk_mul_f32 v[156:157], v[124:125], v[124:125]
  v_pk_mul_f32 v[158:159], v[126:127], v[126:127]
  v_pk_fma_f32 v[152:153], v[152:153], v[144:145], v[146:147]
  v_pk_fma_f32 v[154:155], v[154:155], v[144:145], v[146:147]
  v_pk_fma_f32 v[156:157], v[156:157], v[144:145], v[146:147]
  v_pk_fma_f32 v[158:159], v[158:159], v[144:145], v[146:147]
  v_pk_mul_f32 v[152:153], v[152:153], v[92:93]
  v_pk_mul_f32 v[154:155], v[154:155], v[94:95]
  v_pk_mul_f32 v[156:157], v[156:157], v[124:125]
  v_pk_mul_f32 v[158:159], v[158:159], v[126:127]
  v_exp_f32 v152, v152
  v_exp_f32 v153, v153
  v_exp_f32 v154, v154
  v_exp_f32 v155, v155
  v_exp_f32 v156, v156
  v_exp_f32 v157, v157
  v_exp_f32 v158, v158
  v_exp_f32 v159, v159
  v_pk_mul_f32 v[108:109], v[92:93], v[108:109]
  v_pk_mul_f32 v[110:111], v[94:95], v[110:111]
  v_pk_mul_f32 v[140:141], v[124:125], v[140:141]
  v_pk_mul_f32 v[142:143], v[126:127], v[142:143]
  v_pk_add_f32 v[152:153], v[152:153], v[148:149]
  v_pk_add_f32 v[154:155], v[154:155], v[148:149]
  v_pk_add_f32 v[156:157], v[156:157], v[148:149]
  v_pk_add_f32 v[158:159], v[158:159], v[148:149]
  v_rcp_f32 v152, v152
  v_rcp_f32 v153, v153
  v_rcp_f32 v154, v154
  v_rcp_f32 v155, v155
  v_rcp_f32 v156, v156
  v_rcp_f32 v157, v157
  v_rcp_f32 v158, v158
  v_rcp_f32 v159, v159
  s_nop 0
  v_pk_mul_f32 v[152:153], v[152:153], v[108:109]
  v_pk_mul_f32 v[154:155], v[154:155], v[110:111]
  v_pk_mul_f32 v[156:157], v[156:157], v[140:141]
  v_pk_mul_f32 v[158:159], v[158:159], v[142:143]
  v_cvt_pk_bf16_f32 v86, v152, v153
  v_cvt_pk_bf16_f32 v87, v154, v155
  v_cvt_pk_bf16_f32 v118, v156, v157
  v_cvt_pk_bf16_f32 v119, v158, v159
  s_cmp_eq_u32 s56, 0
  s_cbranch_scc0 G1_ODD0
  buffer_store_dwordx4 v[16:19], v12, s[20:23], s52 offen offset:0
  buffer_store_dwordx4 v[20:23], v12, s[20:23], s52 offen offset:1024
  buffer_store_dwordx4 v[48:51], v12, s[20:23], s53 offen offset:0
  buffer_store_dwordx4 v[52:55], v12, s[20:23], s53 offen offset:1024
  buffer_store_dwordx4 v[80:83], v12, s[20:23], s54 offen offset:0
  buffer_store_dwordx4 v[84:87], v12, s[20:23], s54 offen offset:1024
  buffer_store_dwordx4 v[112:115], v12, s[20:23], s55 offen offset:0
  buffer_store_dwordx4 v[116:119], v12, s[20:23], s55 offen offset:1024
  s_branch G1_END
G1_ODD0:
  buffer_store_dwordx2 v[16:17], v12, s[20:23], s52 offen offset:8
  buffer_store_dwordx4 v[18:21], v12, s[20:23], s52 offen offset:1024
  buffer_store_dwordx2 v[22:23], v12, s[20:23], s52 offen offset:2048
  buffer_store_dwordx2 v[48:49], v12, s[20:23], s53 offen offset:8
  buffer_store_dwordx4 v[50:53], v12, s[20:23], s53 offen offset:1024
  buffer_store_dwordx2 v[54:55], v12, s[20:23], s53 offen offset:2048
  buffer_store_dwordx2 v[80:81], v12, s[20:23], s54 offen offset:8
  buffer_store_dwordx4 v[82:85], v12, s[20:23], s54 offen offset:1024
  buffer_store_dwordx2 v[86:87], v12, s[20:23], s54 offen offset:2048
  buffer_store_dwordx2 v[112:113], v12, s[20:23], s55 offen offset:8
  buffer_store_dwordx4 v[114:117], v12, s[20:23], s55 offen offset:1024
  buffer_store_dwordx2 v[118:119], v12, s[20:23], s55 offen offset:2048
  s_branch G1_END
G1_VAR1:
  ds_read_b128 a[0:3], v7 offset:0
  ds_read_b128 a[4:7], v7 offset:2048
  ds_read_b128 a[8:11], v7 offset:4096
  ds_read_b128 a[12:15], v7 offset:6144
  ds_read_b64_tr_b16 a[16:17], v11 offset:128
  ds_read_b64_tr_b16 a[18:19], v11 offset:3712
  ds_read_b64_tr_b16 a[32:33], v11 offset:7296
  ds_read_b64_tr_b16 a[34:35], v11 offset:10880
  ds_read_b64_tr_b16 a[20:21], v11 offset:160
  ds_read_b64_tr_b16 a[22:23], v11 offset:3744
  ds_read_b64_tr_b16 a[36:37], v11 offset:7328
  ds_read_b64_tr_b16 a[38:39], v11 offset:10912
  ds_read_b64_tr_b16 a[24:25], v11 offset:192
  ds_read_b64_tr_b16 a[26:27], v11 offset:3776
  ds_read_b64_tr_b16 a[40:41], v11 offset:7360
  ds_read_b64_tr_b16 a[42:43], v11 offset:10944
  s_waitcnt vmcnt(10) lgkmcnt(0)
  s_barrier
  v_mfma_f32_16x16x32_bf16 v[16:19], a[16:19], a[0:3], v[16:19]
  ds_read_b128 a[48:51], v8 offset:0
  v_mfma_f32_16x16x32_bf16 v[40:43], a[16:19], a[4:7], v[40:43]
  ds_read_b128 a[52:55], v8 offset:2048
  v_mfma_f32_16x16x32_bf16 v[64:67], a[16:19], a[8:11], v[64:67]
  ds_read_b128 a[56:59], v8 offset:4096
  v_mfma_f32_16x16x32_bf16 v[88:91], a[16:19], a[12:15], v[88:91]
  ds_read_b128 a[60:63], v8 offset:6144
  s_mov_b64 exec, s[36:37]
  s_add_u32 m0, s45, 0
  s_add_u32 s40, s31, 917504
  buffer_load_dwordx4 v6, s[16:19], s40 offen lds
  s_add_u32 m0, s45, 896
  s_add_u32 s40, s31, 974848
  buffer_load_dwordx4 v6, s[16:19], s40 offen lds
  s_mov_b64 exec, -1
  v_mfma_f32_16x16x32_bf16 v[28:31], a[32:35], a[0:3], v[28:31]
  ds_read_b64_tr_b16 a[64:65], v11 offset:14464
  v_mfma_f32_16x16x32_bf16 v[52:55], a[32:35], a[4:7], v[52:55]
  ds_read_b64_tr_b16 a[66:67], v11 offset:18048
  v_mfma_f32_16x16x32_bf16 v[76:79], a[32:35], a[8:11], v[76:79]
  ds_read_b64_tr_b16 a[80:81], v11 offset:21632
  v_mfma_f32_16x16x32_bf16 v[100:103], a[32:35], a[12:15], v[100:103]
  ds_read_b64_tr_b16 a[82:83], v11 offset:25216
  v_mfma_f32_16x16x32_bf16 v[20:23], a[20:23], a[0:3], v[20:23]
  ds_read_b64_tr_b16 a[68:69], v11 offset:14496
  v_mfma_f32_16x16x32_bf16 v[44:47], a[20:23], a[4:7], v[44:47]
  ds_read_b64_tr_b16 a[70:71], v11 offset:18080
  v_mfma_f32_16x16x32_bf16 v[68:71], a[20:23], a[8:11], v[68:71]
  ds_read_b64_tr_b16 a[84:85], v11 offset:21664
  v_mfma_f32_16x16x32_bf16 v[92:95], a[20:23], a[12:15], v[92:95]
  ds_read_b64_tr_b16 a[86:87], v11 offset:25248
  v_mfma_f32_16x16x32_bf16 v[32:35], a[36:39], a[0:3], v[32:35]
  ds_read_b64_tr_b16 a[72:73], v11 offset:14528
  s_add_u32 m0, s44, 67328
  s_nop 0
  buffer_load_dwordx4 v4, s[12:15], s29 offen offset:256 lds
  v_mfma_f32_16x16x32_bf16 v[56:59], a[36:39], a[4:7], v[56:59]
  ds_read_b64_tr_b16 a[74:75], v11 offset:18112
  v_mfma_f32_16x16x32_bf16 v[80:83], a[36:39], a[8:11], v[80:83]
  ds_read_b64_tr_b16 a[88:89], v11 offset:21696
  v_mfma_f32_16x16x32_bf16 v[104:107], a[36:39], a[12:15], v[104:107]
  ds_read_b64_tr_b16 a[90:91], v11 offset:25280
  v_mfma_f32_16x16x32_bf16 v[24:27], a[24:27], a[0:3], v[24:27]
  v_mfma_f32_16x16x32_bf16 v[48:51], a[24:27], a[4:7], v[48:51]
  v_mfma_f32_16x16x32_bf16 v[72:75], a[24:27], a[8:11], v[72:75]
  v_mfma_f32_16x16x32_bf16 v[96:99], a[24:27], a[12:15], v[96:99]
  v_mfma_f32_16x16x32_bf16 v[36:39], a[40:43], a[0:3], v[36:39]
  s_add_u32 m0, s44, 68352
  s_nop 0
  buffer_load_dwordx4 v5, s[12:15], s29 offen offset:256 lds
  v_mfma_f32_16x16x32_bf16 v[60:63], a[40:43], a[4:7], v[60:63]
  v_mfma_f32_16x16x32_bf16 v[84:87], a[40:43], a[8:11], v[84:87]
  v_mfma_f32_16x16x32_bf16 v[108:111], a[40:43], a[12:15], v[108:111]
  s_waitcnt vmcnt(8) lgkmcnt(0)
  s_barrier
  v_mfma_f32_16x16x32_bf16 v[16:19], a[64:67], a[48:51], v[16:19]
  ds_read_b128 a[0:3], v7 offset:32768
  v_mfma_f32_16x16x32_bf16 v[40:43], a[64:67], a[52:55], v[40:43]
  ds_read_b128 a[4:7], v7 offset:34816
  v_mfma_f32_16x16x32_bf16 v[64:67], a[64:67], a[56:59], v[64:67]
  ds_read_b128 a[8:11], v7 offset:36864
  v_mfma_f32_16x16x32_bf16 v[88:91], a[64:67], a[60:63], v[88:91]
  ds_read_b128 a[12:15], v7 offset:38912
  s_mov_b64 exec, s[36:37]
  s_add_u32 m0, s45, 14336
  s_add_u32 s40, s31, 1146880
  buffer_load_dwordx4 v6, s[16:19], s40 offen lds
  s_add_u32 m0, s45, 15232
  s_add_u32 s40, s31, 1204224
  buffer_load_dwordx4 v6, s[16:19], s40 offen lds
  s_mov_b64 exec, -1
  v_mfma_f32_16x16x32_bf16 v[28:31], a[80:83], a[48:51], v[28:31]
  ds_read_b64_tr_b16 a[16:17], v11 offset:28800
  v_mfma_f32_16x16x32_bf16 v[52:55], a[80:83], a[52:55], v[52:55]
  ds_read_b64_tr_b16 a[18:19], v11 offset:32384
  v_mfma_f32_16x16x32_bf16 v[76:79], a[80:83], a[56:59], v[76:79]
  ds_read_b64_tr_b16 a[32:33], v11 offset:35968
  v_mfma_f32_16x16x32_bf16 v[100:103], a[80:83], a[60:63], v[100:103]
  ds_read_b64_tr_b16 a[34:35], v11 offset:39552
  v_mfma_f32_16x16x32_bf16 v[20:23], a[68:71], a[48:51], v[20:23]
  ds_read_b64_tr_b16 a[20:21], v11 offset:28832
  v_mfma_f32_16x16x32_bf16 v[44:47], a[68:71], a[52:55], v[44:47]
  ds_read_b64_tr_b16 a[22:23], v11 offset:32416
  v_mfma_f32_16x16x32_bf16 v[68:71], a[68:71], a[56:59], v[68:71]
  ds_read_b64_tr_b16 a[36:37], v11 offset:36000
  v_mfma_f32_16x16x32_bf16 v[92:95], a[68:71], a[60:63], v[92:95]
  ds_read_b64_tr_b16 a[38:39], v11 offset:39584
  v_mfma_f32_16x16x32_bf16 v[32:35], a[84:87], a[48:51], v[32:35]
  ds_read_b64_tr_b16 a[24:25], v11 offset:28864
  s_add_u32 m0, s44, 4294966912
  s_nop 0
  buffer_load_dwordx4 v2, s[12:15], s29 offen offset:384 lds
  v_mfma_f32_16x16x32_bf16 v[56:59], a[84:87], a[52:55], v[56:59]
  ds_read_b64_tr_b16 a[26:27], v11 offset:32448
  v_mfma_f32_16x16x32_bf16 v[80:83], a[84:87], a[56:59], v[80:83]
  ds_read_b64_tr_b16 a[40:41], v11 offset:36032
  v_mfma_f32_16x16x32_bf16 v[104:107], a[84:87], a[60:63], v[104:107]
  ds_read_b64_tr_b16 a[42:43], v11 offset:39616
  v_mfma_f32_16x16x32_bf16 v[24:27], a[72:75], a[48:51], v[24:27]
  v_mfma_f32_16x16x32_bf16 v[48:51], a[72:75], a[52:55], v[48:51]
  v_mfma_f32_16x16x32_bf16 v[72:75], a[72:75], a[56:59], v[72:75]
  v_mfma_f32_16x16x32_bf16 v[96:99], a[72:75], a[60:63], v[96:99]
  v_mfma_f32_16x16x32_bf16 v[36:39], a[88:91], a[48:51], v[36:39]
  s_add_u32 m0, s44, 640
  s_nop 0
  buffer_load_dwordx4 v3, s[12:15], s29 offen offset:384 lds
  v_mfma_f32_16x16x32_bf16 v[60:63], a[88:91], a[52:55], v[60:63]
  v_mfma_f32_16x16x32_bf16 v[84:87], a[88:91], a[56:59], v[84:87]
  v_mfma_f32_16x16x32_bf16 v[108:111], a[88:91], a[60:63], v[108:111]
  s_waitcnt vmcnt(10) lgkmcnt(0)
  s_barrier
  v_mfma_f32_16x16x32_bf16 v[16:19], a[16:19], a[0:3], v[16:19]
  ds_read_b128 a[48:51], v8 offset:32768
  v_mfma_f32_16x16x32_bf16 v[40:43], a[16:19], a[4:7], v[40:43]
  ds_read_b128 a[52:55], v8 offset:34816
  v_mfma_f32_16x16x32_bf16 v[64:67], a[16:19], a[8:11], v[64:67]
  ds_read_b128 a[56:59], v8 offset:36864
  v_mfma_f32_16x16x32_bf16 v[88:91], a[16:19], a[12:15], v[88:91]
  ds_read_b128 a[60:63], v8 offset:38912
  s_mov_b64 exec, s[36:37]
  s_add_u32 m0, s45, 28672
  s_add_u32 s40, s31, 1376256
  buffer_load_dwordx4 v6, s[16:19], s40 offen lds
  s_add_u32 m0, s45, 29568
  s_add_u32 s40, s31, 1433600
  buffer_load_dwordx4 v6, s[16:19], s40 offen lds
  s_mov_b64 exec, -1
  v_mfma_f32_16x16x32_bf16 v[28:31], a[32:35], a[0:3], v[28:31]
  ds_read_b64_tr_b16 a[64:65], v11 offset:43136
  v_mfma_f32_16x16x32_bf16 v[52:55], a[32:35], a[4:7], v[52:55]
  ds_read_b64_tr_b16 a[66:67], v11 offset:46720
  v_mfma_f32_16x16x32_bf16 v[76:79], a[32:35], a[8:11], v[76:79]
  ds_read_b64_tr_b16 a[80:81], v11 offset:50304
  v_mfma_f32_16x16x32_bf16 v[100:103], a[32:35], a[12:15], v[100:103]
  ds_read_b64_tr_b16 a[82:83], v11 offset:53888
  v_mfma_f32_16x16x32_bf16 v[20:23], a[20:23], a[0:3], v[20:23]
  ds_read_b64_tr_b16 a[68:69], v11 offset:43168
  v_mfma_f32_16x16x32_bf16 v[44:47], a[20:23], a[4:7], v[44:47]
  ds_read_b64_tr_b16 a[70:71], v11 offset:46752
  v_mfma_f32_16x16x32_bf16 v[68:71], a[20:23], a[8:11], v[68:71]
  ds_read_b64_tr_b16 a[84:85], v11 offset:50336
  v_mfma_f32_16x16x32_bf16 v[92:95], a[20:23], a[12:15], v[92:95]
  ds_read_b64_tr_b16 a[86:87], v11 offset:53920
  v_mfma_f32_16x16x32_bf16 v[32:35], a[36:39], a[0:3], v[32:35]
  ds_read_b64_tr_b16 a[72:73], v11 offset:43200
  s_add_u32 m0, s44, 1664
  s_nop 0
  buffer_load_dwordx4 v4, s[12:15], s29 offen offset:384 lds
  v_mfma_f32_16x16x32_bf16 v[56:59], a[36:39], a[4:7], v[56:59]
  ds_read_b64_tr_b16 a[74:75], v11 offset:46784
  v_mfma_f32_16x16x32_bf16 v[80:83], a[36:39], a[8:11], v[80:83]
  ds_read_b64_tr_b16 a[88:89], v11 offset:50368
  v_mfma_f32_16x16x32_bf16 v[104:107], a[36:39], a[12:15], v[104:107]
  ds_read_b64_tr_b16 a[90:91], v11 offset:53952
  v_mfma_f32_16x16x32_bf16 v[24:27], a[24:27], a[0:3], v[24:27]
  v_mfma_f32_16x16x32_bf16 v[48:51], a[24:27], a[4:7], v[48:51]
  v_mfma_f32_16x16x32_bf16 v[72:75], a[24:27], a[8:11], v[72:75]
  v_mfma_f32_16x16x32_bf16 v[96:99], a[24:27], a[12:15], v[96:99]
  v_mfma_f32_16x16x32_bf16 v[36:39], a[40:43], a[0:3], v[36:39]
  s_add_u32 m0, s44, 2688
  s_nop 0
  buffer_load_dwordx4 v5, s[12:15], s29 offen offset:384 lds
  v_mfma_f32_16x16x32_bf16 v[60:63], a[40:43], a[4:7], v[60:63]
  v_mfma_f32_16x16x32_bf16 v[84:87], a[40:43], a[8:11], v[84:87]
  v_mfma_f32_16x16x32_bf16 v[108:111], a[40:43], a[12:15], v[108:111]
  s_waitcnt vmcnt(8) lgkmcnt(0)
  s_barrier
  v_mfma_f32_16x16x32_bf16 v[16:19], a[64:67], a[48:51], v[16:19]
  ds_read_b128 a[0:3], v9 offset:0
  v_mfma_f32_16x16x32_bf16 v[40:43], a[64:67], a[52:55], v[40:43]
  ds_read_b128 a[4:7], v9 offset:2048
  v_mfma_f32_16x16x32_bf16 v[64:67], a[64:67], a[56:59], v[64:67]
  ds_read_b128 a[8:11], v9 offset:4096
  v_mfma_f32_16x16x32_bf16 v[88:91], a[64:67], a[60:63], v[88:91]
  ds_read_b128 a[12:15], v9 offset:6144
  s_mov_b64 exec, s[36:37]
  s_add_u32 m0, s45, 43008
  s_add_u32 s40, s31, 1605632
  buffer_load_dwordx4 v6, s[16:19], s40 offen lds
  s_add_u32 m0, s45, 43904
  s_add_u32 s40, s31, 1662976
  buffer_load_dwordx4 v6, s[16:19], s40 offen lds
  s_mov_b64 exec, -1
  v_mfma_f32_16x16x32_bf16 v[28:31], a[80:83], a[48:51], v[28:31]
  ds_read_b64_tr_b16 a[16:17], v11 offset:128
  v_mfma_f32_16x16x32_bf16 v[52:55], a[80:83], a[52:55], v[52:55]
  ds_read_b64_tr_b16 a[18:19], v11 offset:3712
  v_mfma_f32_16x16x32_bf16 v[76:79], a[80:83], a[56:59], v[76:79]
  ds_read_b64_tr_b16 a[32:33], v11 offset:7296
  v_mfma_f32_16x16x32_bf16 v[100:103], a[80:83], a[60:63], v[100:103]
  ds_read_b64_tr_b16 a[34:35], v11 offset:10880
  v_mfma_f32_16x16x32_bf16 v[20:23], a[68:71], a[48:51], v[20:23]
  ds_read_b64_tr_b16 a[20:21], v11 offset:160
  v_mfma_f32_16x16x32_bf16 v[44:47], a[68:71], a[52:55], v[44:47]
  ds_read_b64_tr_b16 a[22:23], v11 offset:3744
  v_mfma_f32_16x16x32_bf16 v[68:71], a[68:71], a[56:59], v[68:71]
  ds_read_b64_tr_b16 a[36:37], v11 offset:7328
  v_mfma_f32_16x16x32_bf16 v[92:95], a[68:71], a[60:63], v[92:95]
  ds_read_b64_tr_b16 a[38:39], v11 offset:10912
  v_mfma_f32_16x16x32_bf16 v[32:35], a[84:87], a[48:51], v[32:35]
  ds_read_b64_tr_b16 a[24:25], v11 offset:192
  s_add_u32 m0, s44, 32256
  s_nop 0
  buffer_load_dwordx4 v2, s[12:15], s29 offen offset:512 lds
  v_mfma_f32_16x16x32_bf16 v[56:59], a[84:87], a[52:55], v[56:59]
  ds_read_b64_tr_b16 a[26:27], v11 offset:3776
  v_mfma_f32_16x16x32_bf16 v[80:83], a[84:87], a[56:59], v[80:83]
  ds_read_b64_tr_b16 a[40:41], v11 offset:7360
  v_mfma_f32_16x16x32_bf16 v[104:107], a[84:87], a[60:63], v[104:107]
  ds_read_b64_tr_b16 a[42:43], v11 offset:10944
  v_mfma_f32_16x16x32_bf16 v[24:27], a[72:75], a[48:51], v[24:27]
  v_mfma_f32_16x16x32_bf16 v[48:51], a[72:75], a[52:55], v[48:51]
  v_mfma_f32_16x16x32_bf16 v[72:75], a[72:75], a[56:59], v[72:75]
  v_mfma_f32_16x16x32_bf16 v[96:99], a[72:75], a[60:63], v[96:99]
  v_mfma_f32_16x16x32_bf16 v[36:39], a[88:91], a[48:51], v[36:39]
  s_add_u32 m0, s44, 33280
  s_nop 0
  buffer_load_dwordx4 v3, s[12:15], s29 offen offset:512 lds
  v_mfma_f32_16x16x32_bf16 v[60:63], a[88:91], a[52:55], v[60:63]
  v_mfma_f32_16x16x32_bf16 v[84:87], a[88:91], a[56:59], v[84:87]
  v_mfma_f32_16x16x32_bf16 v[108:111], a[88:91], a[60:63], v[108:111]
  s_waitcnt vmcnt(10) lgkmcnt(0)
  s_barrier
  v_mfma_f32_16x16x32_bf16 v[16:19], a[16:19], a[0:3], v[16:19]
  ds_read_b128 a[48:51], v10 offset:0
  v_mfma_f32_16x16x32_bf16 v[40:43], a[16:19], a[4:7], v[40:43]
  ds_read_b128 a[52:55], v10 offset:2048
  v_mfma_f32_16x16x32_bf16 v[64:67], a[16:19], a[8:11], v[64:67]
  ds_read_b128 a[56:59], v10 offset:4096
  v_mfma_f32_16x16x32_bf16 v[88:91], a[16:19], a[12:15], v[88:91]
  ds_read_b128 a[60:63], v10 offset:6144
  s_mov_b64 exec, s[36:37]
  s_add_u32 m0, s45, 0
  s_add_u32 s40, s31, 1835008
  buffer_load_dwordx4 v6, s[16:19], s40 offen lds
  s_add_u32 m0, s45, 896
  s_add_u32 s40, s31, 1892352
  buffer_load_dwordx4 v6, s[16:19], s40 offen lds
  s_mov_b64 exec, -1
  v_mfma_f32_16x16x32_bf16 v[28:31], a[32:35], a[0:3], v[28:31]
  ds_read_b64_tr_b16 a[64:65], v11 offset:14464
  v_mfma_f32_16x16x32_bf16 v[52:55], a[32:35], a[4:7], v[52:55]
  ds_read_b64_tr_b16 a[66:67], v11 offset:18048
  v_mfma_f32_16x16x32_bf16 v[76:79], a[32:35], a[8:11], v[76:79]
  ds_read_b64_tr_b16 a[80:81], v11 offset:21632
  v_mfma_f32_16x16x32_bf16 v[100:103], a[32:35], a[12:15], v[100:103]
  ds_read_b64_tr_b16 a[82:83], v11 offset:25216
  v_mfma_f32_16x16x32_bf16 v[20:23], a[20:23], a[0:3], v[20:23]
  ds_read_b64_tr_b16 a[68:69], v11 offset:14496
  v_mfma_f32_16x16x32_bf16 v[44:47], a[20:23], a[4:7], v[44:47]
  ds_read_b64_tr_b16 a[70:71], v11 offset:18080
  v_mfma_f32_16x16x32_bf16 v[68:71], a[20:23], a[8:11], v[68:71]
  ds_read_b64_tr_b16 a[84:85], v11 offset:21664
  v_mfma_f32_16x16x32_bf16 v[92:95], a[20:23], a[12:15], v[92:95]
  ds_read_b64_tr_b16 a[86:87], v11 offset:25248
  v_mfma_f32_16x16x32_bf16 v[32:35], a[36:39], a[0:3], v[32:35]
  ds_read_b64_tr_b16 a[72:73], v11 offset:14528
  s_add_u32 m0, s44, 34304
  s_nop 0
  buffer_load_dwordx4 v4, s[12:15], s29 offen offset:512 lds
  v_mfma_f32_16x16x32_bf16 v[56:59], a[36:39], a[4:7], v[56:59]
  ds_read_b64_tr_b16 a[74:75], v11 offset:18112
  v_mfma_f32_16x16x32_bf16 v[80:83], a[36:39], a[8:11], v[80:83]
  ds_read_b64_tr_b16 a[88:89], v11 offset:21696
  v_mfma_f32_16x16x32_bf16 v[104:107], a[36:39], a[12:15], v[104:107]
  ds_read_b64_tr_b16 a[90:91], v11 offset:25280
  v_mfma_f32_16x16x32_bf16 v[24:27], a[24:27], a[0:3], v[24:27]
  v_mfma_f32_16x16x32_bf16 v[48:51], a[24:27], a[4:7], v[48:51]
  v_mfma_f32_16x16x32_bf16 v[72:75], a[24:27], a[8:11], v[72:75]
  v_mfma_f32_16x16x32_bf16 v[96:99], a[24:27], a[12:15], v[96:99]
  v_mfma_f32_16x16x32_bf16 v[36:39], a[40:43], a[0:3], v[36:39]
  s_add_u32 m0, s44, 35328
  s_nop 0
  buffer_load_dwordx4 v5, s[12:15], s29 offen offset:512 lds
  v_mfma_f32_16x16x32_bf16 v[60:63], a[40:43], a[4:7], v[60:63]
  v_mfma_f32_16x16x32_bf16 v[84:87], a[40:43], a[8:11], v[84:87]
  v_mfma_f32_16x16x32_bf16 v[108:111], a[40:43], a[12:15], v[108:111]
  s_waitcnt vmcnt(8) lgkmcnt(0)
  s_barrier
  v_mfma_f32_16x16x32_bf16 v[16:19], a[64:67], a[48:51], v[16:19]
  ds_read_b128 a[0:3], v7 offset:0
  v_mfma_f32_16x16x32_bf16 v[40:43], a[64:67], a[52:55], v[40:43]
  ds_read_b128 a[4:7], v7 offset:2048
  v_mfma_f32_16x16x32_bf16 v[64:67], a[64:67], a[56:59], v[64:67]
  ds_read_b128 a[8:11], v7 offset:4096
  v_mfma_f32_16x16x32_bf16 v[88:91], a[64:67], a[60:63], v[88:91]
  ds_read_b128 a[12:15], v7 offset:6144
  s_mov_b64 exec, s[36:37]
  s_add_u32 m0, s45, 14336
  s_add_u32 s40, s31, 2064384
  buffer_load_dwordx4 v6, s[16:19], s40 offen lds
  s_add_u32 m0, s45, 15232
  s_add_u32 s40, s31, 2121728
  buffer_load_dwordx4 v6, s[16:19], s40 offen lds
  s_mov_b64 exec, -1
  v_mfma_f32_16x16x32_bf16 v[28:31], a[80:83], a[48:51], v[28:31]
  ds_read_b64_tr_b16 a[16:17], v11 offset:28800
  v_mfma_f32_16x16x32_bf16 v[52:55], a[80:83], a[52:55], v[52:55]
  ds_read_b64_tr_b16 a[18:19], v11 offset:32384
  v_mfma_f32_16x16x32_bf16 v[76:79], a[80:83], a[56:59], v[76:79]
  ds_read_b64_tr_b16 a[32:33], v11 offset:35968
  v_mfma_f32_16x16x32_bf16 v[100:103], a[80:83], a[60:63], v[100:103]
  ds_read_b64_tr_b16 a[34:35], v11 offset:39552
  v_mfma_f32_16x16x32_bf16 v[20:23], a[68:71], a[48:51], v[20:23]
  ds_read_b64_tr_b16 a[20:21], v11 offset:28832
  v_mfma_f32_16x16x32_bf16 v[44:47], a[68:71], a[52:55], v[44:47]
  ds_read_b64_tr_b16 a[22:23], v11 offset:32416
  v_mfma_f32_16x16x32_bf16 v[68:71], a[68:71], a[56:59], v[68:71]
  ds_read_b64_tr_b16 a[36:37], v11 offset:36000
  v_mfma_f32_16x16x32_bf16 v[92:95], a[68:71], a[60:63], v[92:95]
  ds_read_b64_tr_b16 a[38:39], v11 offset:39584
  v_mfma_f32_16x16x32_bf16 v[32:35], a[84:87], a[48:51], v[32:35]
  ds_read_b64_tr_b16 a[24:25], v11 offset:28864
  s_add_u32 m0, s44, 64896
  s_nop 0
  buffer_load_dwordx4 v2, s[12:15], s29 offen offset:640 lds
  v_mfma_f32_16x16x32_bf16 v[56:59], a[84:87], a[52:55], v[56:59]
  ds_read_b64_tr_b16 a[26:27], v11 offset:32448
  v_mfma_f32_16x16x32_bf16 v[80:83], a[84:87], a[56:59], v[80:83]
  ds_read_b64_tr_b16 a[40:41], v11 offset:36032
  v_mfma_f32_16x16x32_bf16 v[104:107], a[84:87], a[60:63], v[104:107]
  ds_read_b64_tr_b16 a[42:43], v11 offset:39616
  v_mfma_f32_16x16x32_bf16 v[24:27], a[72:75], a[48:51], v[24:27]
  v_mfma_f32_16x16x32_bf16 v[48:51], a[72:75], a[52:55], v[48:51]
  v_mfma_f32_16x16x32_bf16 v[72:75], a[72:75], a[56:59], v[72:75]
  v_mfma_f32_16x16x32_bf16 v[96:99], a[72:75], a[60:63], v[96:99]
  v_mfma_f32_16x16x32_bf16 v[36:39], a[88:91], a[48:51], v[36:39]
  s_add_u32 m0, s44, 65920
  s_nop 0
  buffer_load_dwordx4 v3, s[12:15], s29 offen offset:640 lds
  v_mfma_f32_16x16x32_bf16 v[60:63], a[88:91], a[52:55], v[60:63]
  v_mfma_f32_16x16x32_bf16 v[84:87], a[88:91], a[56:59], v[84:87]
  v_mfma_f32_16x16x32_bf16 v[108:111], a[88:91], a[60:63], v[108:111]
  s_waitcnt vmcnt(10) lgkmcnt(0)
  s_barrier
  v_mfma_f32_16x16x32_bf16 v[16:19], a[16:19], a[0:3], v[16:19]
  ds_read_b128 a[48:51], v8 offset:0
  v_mfma_f32_16x16x32_bf16 v[40:43], a[16:19], a[4:7], v[40:43]
  ds_read_b128 a[52:55], v8 offset:2048
  v_mfma_f32_16x16x32_bf16 v[64:67], a[16:19], a[8:11], v[64:67]
  ds_read_b128 a[56:59], v8 offset:4096
  v_mfma_f32_16x16x32_bf16 v[88:91], a[16:19], a[12:15], v[88:91]
  ds_read_b128 a[60:63], v8 offset:6144
  s_mov_b64 exec, s[36:37]
  s_add_u32 m0, s45, 28672
  s_add_u32 s40, s31, 2293760
  buffer_load_dwordx4 v6, s[16:19], s40 offen lds
  s_add_u32 m0, s45, 29568
  s_add_u32 s40, s31, 2351104
  buffer_load_dwordx4 v6, s[16:19], s40 offen lds
  s_mov_b64 exec, -1
  v_mfma_f32_16x16x32_bf16 v[28:31], a[32:35], a[0:3], v[28:31]
  ds_read_b64_tr_b16 a[64:65], v11 offset:43136
  v_mfma_f32_16x16x32_bf16 v[52:55], a[32:35], a[4:7], v[52:55]
  ds_read_b64_tr_b16 a[66:67], v11 offset:46720
  v_mfma_f32_16x16x32_bf16 v[76:79], a[32:35], a[8:11], v[76:79]
  ds_read_b64_tr_b16 a[80:81], v11 offset:50304
  v_mfma_f32_16x16x32_bf16 v[100:103], a[32:35], a[12:15], v[100:103]
  ds_read_b64_tr_b16 a[82:83], v11 offset:53888
  v_mfma_f32_16x16x32_bf16 v[20:23], a[20:23], a[0:3], v[20:23]
  ds_read_b64_tr_b16 a[68:69], v11 offset:43168
  v_mfma_f32_16x16x32_bf16 v[44:47], a[20:23], a[4:7], v[44:47]
  ds_read_b64_tr_b16 a[70:71], v11 offset:46752
  v_mfma_f32_16x16x32_bf16 v[68:71], a[20:23], a[8:11], v[68:71]
  ds_read_b64_tr_b16 a[84:85], v11 offset:50336
  v_mfma_f32_16x16x32_bf16 v[92:95], a[20:23], a[12:15], v[92:95]
  ds_read_b64_tr_b16 a[86:87], v11 offset:53920
  v_mfma_f32_16x16x32_bf16 v[32:35], a[36:39], a[0:3], v[32:35]
  ds_read_b64_tr_b16 a[72:73], v11 offset:43200
  s_add_u32 m0, s44, 66944
  s_nop 0
  buffer_load_dwordx4 v4, s[12:15], s29 offen offset:640 lds
  v_mfma_f32_16x16x32_bf16 v[56:59], a[36:39], a[4:7], v[56:59]
  ds_read_b64_tr_b16 a[74:75], v11 offset:46784
  v_mfma_f32_16x16x32_bf16 v[80:83], a[36:39], a[8:11], v[80:83]
  ds_read_b64_tr_b16 a[88:89], v11 offset:50368
  v_mfma_f32_16x16x32_bf16 v[104:107], a[36:39], a[12:15], v[104:107]
  ds_read_b64_tr_b16 a[90:91], v11 offset:53952
  v_mfma_f32_16x16x32_bf16 v[24:27], a[24:27], a[0:3], v[24:27]
  v_mfma_f32_16x16x32_bf16 v[48:51], a[24:27], a[4:7], v[48:51]
  v_mfma_f32_16x16x32_bf16 v[72:75], a[24:27], a[8:11], v[72:75]
  v_mfma_f32_16x16x32_bf16 v[96:99], a[24:27], a[12:15], v[96:99]
  v_mfma_f32_16x16x32_bf16 v[36:39], a[40:43], a[0:3], v[36:39]
  s_add_u32 m0, s44, 67968
  s_nop 0
  buffer_load_dwordx4 v5, s[12:15], s29 offen offset:640 lds
  v_mfma_f32_16x16x32_bf16 v[60:63], a[40:43], a[4:7], v[60:63]
  v_mfma_f32_16x16x32_bf16 v[84:87], a[40:43], a[8:11], v[84:87]
  v_mfma_f32_16x16x32_bf16 v[108:111], a[40:43], a[12:15], v[108:111]
  s_waitcnt vmcnt(8) lgkmcnt(0)
  s_barrier
  v_mfma_f32_16x16x32_bf16 v[16:19], a[64:67], a[48:51], v[16:19]
  ds_read_b128 a[0:3], v7 offset:32768
  v_mfma_f32_16x16x32_bf16 v[40:43], a[64:67], a[52:55], v[40:43]
  ds_read_b128 a[4:7], v7 offset:34816
  v_mfma_f32_16x16x32_bf16 v[64:67], a[64:67], a[56:59], v[64:67]
  ds_read_b128 a[8:11], v7 offset:36864
  v_mfma_f32_16x16x32_bf16 v[88:91], a[64:67], a[60:63], v[88:91]
  ds_read_b128 a[12:15], v7 offset:38912
  s_mov_b64 exec, s[36:37]
  s_add_u32 m0, s45, 43008
  s_add_u32 s40, s31, 2523136
  buffer_load_dwordx4 v6, s[16:19], s40 offen lds
  s_add_u32 m0, s45, 43904
  s_add_u32 s40, s31, 2580480
  buffer_load_dwordx4 v6, s[16:19], s40 offen lds
  s_mov_b64 exec, -1
  v_mfma_f32_16x16x32_bf16 v[28:31], a[80:83], a[48:51], v[28:31]
  ds_read_b64_tr_b16 a[16:17], v11 offset:128
  v_mfma_f32_16x16x32_bf16 v[52:55], a[80:83], a[52:55], v[52:55]
  ds_read_b64_tr_b16 a[18:19], v11 offset:3712
  v_mfma_f32_16x16x32_bf16 v[76:79], a[80:83], a[56:59], v[76:79]
  ds_read_b64_tr_b16 a[32:33], v11 offset:7296
  v_mfma_f32_16x16x32_bf16 v[100:103], a[80:83], a[60:63], v[100:103]
  ds_read_b64_tr_b16 a[34:35], v11 offset:10880
  v_mfma_f32_16x16x32_bf16 v[20:23], a[68:71], a[48:51], v[20:23]
  ds_read_b64_tr_b16 a[20:21], v11 offset:160
  v_mfma_f32_16x16x32_bf16 v[44:47], a[68:71], a[52:55], v[44:47]
  ds_read_b64_tr_b16 a[22:23], v11 offset:3744
  v_mfma_f32_16x16x32_bf16 v[68:71], a[68:71], a[56:59], v[68:71]
  ds_read_b64_tr_b16 a[36:37], v11 offset:7328
  v_mfma_f32_16x16x32_bf16 v[92:95], a[68:71], a[60:63], v[92:95]
  ds_read_b64_tr_b16 a[38:39], v11 offset:10912
  v_mfma_f32_16x16x32_bf16 v[32:35], a[84:87], a[48:51], v[32:35]
  ds_read_b64_tr_b16 a[24:25], v11 offset:192
  s_add_u32 m0, s44, 4294966528
  s_nop 0
  buffer_load_dwordx4 v2, s[12:15], s29 offen offset:768 lds
  v_mfma_f32_16x16x32_bf16 v[56:59], a[84:87], a[52:55], v[56:59]
  ds_read_b64_tr_b16 a[26:27], v11 offset:3776
  v_mfma_f32_16x16x32_bf16 v[80:83], a[84:87], a[56:59], v[80:83]
  ds_read_b64_tr_b16 a[40:41], v11 offset:7360
  v_mfma_f32_16x16x32_bf16 v[104:107], a[84:87], a[60:63], v[104:107]
  ds_read_b64_tr_b16 a[42:43], v11 offset:10944
  v_mfma_f32_16x16x32_bf16 v[24:27], a[72:75], a[48:51], v[24:27]
  v_mfma_f32_16x16x32_bf16 v[48:51], a[72:75], a[52:55], v[48:51]
  v_mfma_f32_16x16x32_bf16 v[72:75], a[72:75], a[56:59], v[72:75]
  v_mfma_f32_16x16x32_bf16 v[96:99], a[72:75], a[60:63], v[96:99]
  v_mfma_f32_16x16x32_bf16 v[36:39], a[88:91], a[48:51], v[36:39]
  s_add_u32 m0, s44, 256
  s_nop 0
  buffer_load_dwordx4 v3, s[12:15], s29 offen offset:768 lds
  v_mfma_f32_16x16x32_bf16 v[60:63], a[88:91], a[52:55], v[60:63]
  v_mfma_f32_16x16x32_bf16 v[84:87], a[88:91], a[56:59], v[84:87]
  v_mfma_f32_16x16x32_bf16 v[108:111], a[88:91], a[60:63], v[108:111]
  s_waitcnt vmcnt(10) lgkmcnt(0)
  s_barrier
  v_mfma_f32_16x16x32_bf16 v[16:19], a[16:19], a[0:3], v[16:19]
  ds_read_b128 a[48:51], v8 offset:32768
  v_mfma_f32_16x16x32_bf16 v[40:43], a[16:19], a[4:7], v[40:43]
  ds_read_b128 a[52:55], v8 offset:34816
  v_mfma_f32_16x16x32_bf16 v[64:67], a[16:19], a[8:11], v[64:67]
  ds_read_b128 a[56:59], v8 offset:36864
  v_mfma_f32_16x16x32_bf16 v[88:91], a[16:19], a[12:15], v[88:91]
  ds_read_b128 a[60:63], v8 offset:38912
  s_mov_b64 exec, s[36:37]
  s_add_u32 m0, s45, 0
  s_add_u32 s40, s31, 2752512
  buffer_load_dwordx4 v6, s[16:19], s40 offen lds
  s_add_u32 m0, s45, 896
  s_add_u32 s40, s31, 2809856
  buffer_load_dwordx4 v6, s[16:19], s40 offen lds
  s_mov_b64 exec, -1
  v_mfma_f32_16x16x32_bf16 v[28:31], a[32:35], a[0:3], v[28:31]
  ds_read_b64_tr_b16 a[64:65], v11 offset:14464
  v_mfma_f32_16x16x32_bf16 v[52:55], a[32:35], a[4:7], v[52:55]
  ds_read_b64_tr_b16 a[66:67], v11 offset:18048
  v_mfma_f32_16x16x32_bf16 v[76:79], a[32:35], a[8:11], v[76:79]
  ds_read_b64_tr_b16 a[80:81], v11 offset:21632
  v_mfma_f32_16x16x32_bf16 v[100:103], a[32:35], a[12:15], v[100:103]
  ds_read_b64_tr_b16 a[82:83], v11 offset:25216
  v_mfma_f32_16x16x32_bf16 v[20:23], a[20:23], a[0:3], v[20:23]
  ds_read_b64_tr_b16 a[68:69], v11 offset:14496
  v_mfma_f32_16x16x32_bf16 v[44:47], a[20:23], a[4:7], v[44:47]
  ds_read_b64_tr_b16 a[70:71], v11 offset:18080
  v_mfma_f32_16x16x32_bf16 v[68:71], a[20:23], a[8:11], v[68:71]
  ds_read_b64_tr_b16 a[84:85], v11 offset:21664
  v_mfma_f32_16x16x32_bf16 v[92:95], a[20:23], a[12:15], v[92:95]
  ds_read_b64_tr_b16 a[86:87], v11 offset:25248
  v_mfma_f32_16x16x32_bf16 v[32:35], a[36:39], a[0:3], v[32:35]
  ds_read_b64_tr_b16 a[72:73], v11 offset:14528
  s_add_u32 m0, s44, 1280
  s_nop 0
  buffer_load_dwordx4 v4, s[12:15], s29 offen offset:768 lds
  v_mfma_f32_16x16x32_bf16 v[56:59], a[36:39], a[4:7], v[56:59]
  ds_read_b64_tr_b16 a[74:75], v11 offset:18112
  v_mfma_f32_16x16x32_bf16 v[80:83], a[36:39], a[8:11], v[80:83]
  ds_read_b64_tr_b16 a[88:89], v11 offset:21696
  v_mfma_f32_16x16x32_bf16 v[104:107], a[36:39], a[12:15], v[104:107]
  ds_read_b64_tr_b16 a[90:91], v11 offset:25280
  v_mfma_f32_16x16x32_bf16 v[24:27], a[24:27], a[0:3], v[24:27]
  v_mfma_f32_16x16x32_bf16 v[48:51], a[24:27], a[4:7], v[48:51]
  v_mfma_f32_16x16x32_bf16 v[72:75], a[24:27], a[8:11], v[72:75]
  v_mfma_f32_16x16x32_bf16 v[96:99], a[24:27], a[12:15], v[96:99]
  v_mfma_f32_16x16x32_bf16 v[36:39], a[40:43], a[0:3], v[36:39]
  s_add_u32 m0, s44, 2304
  s_nop 0
  buffer_load_dwordx4 v5, s[12:15], s29 offen offset:768 lds
  v_mfma_f32_16x16x32_bf16 v[60:63], a[40:43], a[4:7], v[60:63]
  v_mfma_f32_16x16x32_bf16 v[84:87], a[40:43], a[8:11], v[84:87]
  v_mfma_f32_16x16x32_bf16 v[108:111], a[40:43], a[12:15], v[108:111]
  s_waitcnt vmcnt(8) lgkmcnt(0)
  s_barrier
  v_mfma_f32_16x16x32_bf16 v[16:19], a[64:67], a[48:51], v[16:19]
  ds_read_b128 a[0:3], v9 offset:0
  v_mfma_f32_16x16x32_bf16 v[40:43], a[64:67], a[52:55], v[40:43]
  ds_read_b128 a[4:7], v9 offset:2048
  v_mfma_f32_16x16x32_bf16 v[64:67], a[64:67], a[56:59], v[64:67]
  ds_read_b128 a[8:11], v9 offset:4096
  v_mfma_f32_16x16x32_bf16 v[88:91], a[64:67], a[60:63], v[88:91]
  ds_read_b128 a[12:15], v9 offset:6144
  s_mov_b64 exec, s[36:37]
  s_add_u32 m0, s45, 14336
  s_add_u32 s40, s31, 2981888
  buffer_load_dwordx4 v6, s[16:19], s40 offen lds
  s_add_u32 m0, s45, 15232
  s_add_u32 s40, s31, 3039232
  buffer_load_dwordx4 v6, s[16:19], s40 offen lds
  s_mov_b64 exec, -1
  v_mfma_f32_16x16x32_bf16 v[28:31], a[80:83], a[48:51], v[28:31]
  ds_read_b64_tr_b16 a[16:17], v11 offset:28800
  v_mfma_f32_16x16x32_bf16 v[52:55], a[80:83], a[52:55], v[52:55]
  ds_read_b64_tr_b16 a[18:19], v11 offset:32384
  v_mfma_f32_16x16x32_bf16 v[76:79], a[80:83], a[56:59], v[76:79]
  ds_read_b64_tr_b16 a[32:33], v11 offset:35968
  v_mfma_f32_16x16x32_bf16 v[100:103], a[80:83], a[60:63], v[100:103]
  ds_read_b64_tr_b16 a[34:35], v11 offset:39552
  v_mfma_f32_16x16x32_bf16 v[20:23], a[68:71], a[48:51], v[20:23]
  ds_read_b64_tr_b16 a[20:21], v11 offset:28832
  v_mfma_f32_16x16x32_bf16 v[44:47], a[68:71], a[52:55], v[44:47]
  ds_read_b64_tr_b16 a[22:23], v11 offset:32416
  v_mfma_f32_16x16x32_bf16 v[68:71], a[68:71], a[56:59], v[68:71]
  ds_read_b64_tr_b16 a[36:37], v11 offset:36000
  v_mfma_f32_16x16x32_bf16 v[92:95], a[68:71], a[60:63], v[92:95]
  ds_read_b64_tr_b16 a[38:39], v11 offset:39584
  v_mfma_f32_16x16x32_bf16 v[32:35], a[84:87], a[48:51], v[32:35]
  ds_read_b64_tr_b16 a[24:25], v11 offset:28864
  s_add_u32 m0, s44, 31872
  s_nop 0
  buffer_load_dwordx4 v2, s[12:15], s29 offen offset:896 lds
  v_mfma_f32_16x16x32_bf16 v[56:59], a[84:87], a[52:55], v[56:59]
  ds_read_b64_tr_b16 a[26:27], v11 offset:32448
  v_mfma_f32_16x16x32_bf16 v[80:83], a[84:87], a[56:59], v[80:83]
  ds_read_b64_tr_b16 a[40:41], v11 offset:36032
  v_mfma_f32_16x16x32_bf16 v[104:107], a[84:87], a[60:63], v[104:107]
  ds_read_b64_tr_b16 a[42:43], v11 offset:39616
  v_mfma_f32_16x16x32_bf16 v[24:27], a[72:75], a[48:51], v[24:27]
  v_mfma_f32_16x16x32_bf16 v[48:51], a[72:75], a[52:55], v[48:51]
  v_mfma_f32_16x16x32_bf16 v[72:75], a[72:75], a[56:59], v[72:75]
  v_mfma_f32_16x16x32_bf16 v[96:99], a[72:75], a[60:63], v[96:99]
  v_mfma_f32_16x16x32_bf16 v[36:39], a[88:91], a[48:51], v[36:39]
  s_add_u32 m0, s44, 32896
  s_nop 0
  buffer_load_dwordx4 v3, s[12:15], s29 offen offset:896 lds
  v_mfma_f32_16x16x32_bf16 v[60:63], a[88:91], a[52:55], v[60:63]
  v_mfma_f32_16x16x32_bf16 v[84:87], a[88:91], a[56:59], v[84:87]
  v_mfma_f32_16x16x32_bf16 v[108:111], a[88:91], a[60:63], v[108:111]
  s_waitcnt vmcnt(10) lgkmcnt(0)
  s_barrier
  v_mfma_f32_16x16x32_bf16 v[16:19], a[16:19], a[0:3], v[16:19]
  ds_read_b128 a[48:51], v10 offset:0
  v_mfma_f32_16x16x32_bf16 v[40:43], a[16:19], a[4:7], v[40:43]
  ds_read_b128 a[52:55], v10 offset:2048
  v_mfma_f32_16x16x32_bf16 v[64:67], a[16:19], a[8:11], v[64:67]
  ds_read_b128 a[56:59], v10 offset:4096
  v_mfma_f32_16x16x32_bf16 v[88:91], a[16:19], a[12:15], v[88:91]
  ds_read_b128 a[60:63], v10 offset:6144
  s_mov_b64 exec, s[36:37]
  s_add_u32 m0, s45, 28672
  s_add_u32 s40, s31, 3211264
  buffer_load_dwordx4 v6, s[16:19], s40 offen lds
  s_add_u32 m0, s45, 29568
  s_add_u32 s40, s31, 3268608
  buffer_load_dwordx4 v6, s[16:19], s40 offen lds
  s_mov_b64 exec, -1
  v_mfma_f32_16x16x32_bf16 v[28:31], a[32:35], a[0:3], v[28:31]
  ds_read_b64_tr_b16 a[64:65], v11 offset:43136
  v_mfma_f32_16x16x32_bf16 v[52:55], a[32:35], a[4:7], v[52:55]
  ds_read_b64_tr_b16 a[66:67], v11 offset:46720
  v_mfma_f32_16x16x32_bf16 v[76:79], a[32:35], a[8:11], v[76:79]
  ds_read_b64_tr_b16 a[80:81], v11 offset:50304
  v_mfma_f32_16x16x32_bf16 v[100:103], a[32:35], a[12:15], v[100:103]
  ds_read_b64_tr_b16 a[82:83], v11 offset:53888
  v_mfma_f32_16x16x32_bf16 v[20:23], a[20:23], a[0:3], v[20:23]
  ds_read_b64_tr_b16 a[68:69], v11 offset:43168
  v_mfma_f32_16x16x32_bf16 v[44:47], a[20:23], a[4:7], v[44:47]
  ds_read_b64_tr_b16 a[70:71], v11 offset:46752
  v_mfma_f32_16x16x32_bf16 v[68:71], a[20:23], a[8:11], v[68:71]
  ds_read_b64_tr_b16 a[84:85], v11 offset:50336
  v_mfma_f32_16x16x32_bf16 v[92:95], a[20:23], a[12:15], v[92:95]
  ds_read_b64_tr_b16 a[86:87], v11 offset:53920
  v_mfma_f32_16x16x32_bf16 v[32:35], a[36:39], a[0:3], v[32:35]
  ds_read_b64_tr_b16 a[72:73], v11 offset:43200
  s_add_u32 m0, s44, 33920
  s_nop 0
  buffer_load_dwordx4 v4, s[12:15], s29 offen offset:896 lds
  v_mfma_f32_16x16x32_bf16 v[56:59], a[36:39], a[4:7], v[56:59]
  ds_read_b64_tr_b16 a[74:75], v11 offset:46784
  v_mfma_f32_16x16x32_bf16 v[80:83], a[36:39], a[8:11], v[80:83]
  ds_read_b64_tr_b16 a[88:89], v11 offset:50368
  v_mfma_f32_16x16x32_bf16 v[104:107], a[36:39], a[12:15], v[104:107]
  ds_read_b64_tr_b16 a[90:91], v11 offset:53952
  v_mfma_f32_16x16x32_bf16 v[24:27], a[24:27], a[0:3], v[24:27]
  v_mfma_f32_16x16x32_bf16 v[48:51], a[24:27], a[4:7], v[48:51]
  v_mfma_f32_16x16x32_bf16 v[72:75], a[24:27], a[8:11], v[72:75]
  v_mfma_f32_16x16x32_bf16 v[96:99], a[24:27], a[12:15], v[96:99]
  v_mfma_f32_16x16x32_bf16 v[36:39], a[40:43], a[0:3], v[36:39]
  s_add_u32 m0, s44, 34944
  s_nop 0
  buffer_load_dwordx4 v5, s[12:15], s29 offen offset:896 lds
  v_mfma_f32_16x16x32_bf16 v[60:63], a[40:43], a[4:7], v[60:63]
  v_mfma_f32_16x16x32_bf16 v[84:87], a[40:43], a[8:11], v[84:87]
  v_mfma_f32_16x16x32_bf16 v[108:111], a[40:43], a[12:15], v[108:111]
  s_waitcnt vmcnt(8) lgkmcnt(0)
  s_barrier
  v_mfma_f32_16x16x32_bf16 v[16:19], a[64:67], a[48:51], v[16:19]
  ds_read_b128 a[0:3], v7 offset:0
  v_mfma_f32_16x16x32_bf16 v[40:43], a[64:67], a[52:55], v[40:43]
  ds_read_b128 a[4:7], v7 offset:2048
  v_mfma_f32_16x16x32_bf16 v[64:67], a[64:67], a[56:59], v[64:67]
  ds_read_b128 a[8:11], v7 offset:4096
  v_mfma_f32_16x16x32_bf16 v[88:91], a[64:67], a[60:63], v[88:91]
  ds_read_b128 a[12:15], v7 offset:6144
  s_mov_b64 exec, s[36:37]
  s_add_u32 m0, s45, 43008
  s_add_u32 s40, s31, 3440640
  buffer_load_dwordx4 v6, s[16:19], s40 offen lds
  s_add_u32 m0, s45, 43904
  s_add_u32 s40, s31, 3497984
  buffer_load_dwordx4 v6, s[16:19], s40 offen lds
  s_mov_b64 exec, -1
  v_mfma_f32_16x16x32_bf16 v[28:31], a[80:83], a[48:51], v[28:31]
  ds_read_b64_tr_b16 a[16:17], v11 offset:128
  v_mfma_f32_16x16x32_bf16 v[52:55], a[80:83], a[52:55], v[52:55]
  ds_read_b64_tr_b16 a[18:19], v11 offset:3712
  v_mfma_f32_16x16x32_bf16 v[76:79], a[80:83], a[56:59], v[76:79]
  ds_read_b64_tr_b16 a[32:33], v11 offset:7296
  v_mfma_f32_16x16x32_bf16 v[100:103], a[80:83], a[60:63], v[100:103]
  ds_read_b64_tr_b16 a[34:35], v11 offset:10880
  v_mfma_f32_16x16x32_bf16 v[20:23], a[68:71], a[48:51], v[20:23]
  ds_read_b64_tr_b16 a[20:21], v11 offset:160
  v_mfma_f32_16x16x32_bf16 v[44:47], a[68:71], a[52:55], v[44:47]
  ds_read_b64_tr_b16 a[22:23], v11 offset:3744
  v_mfma_f32_16x16x32_bf16 v[68:71], a[68:71], a[56:59], v[68:71]
  ds_read_b64_tr_b16 a[36:37], v11 offset:7328
  v_mfma_f32_16x16x32_bf16 v[92:95], a[68:71], a[60:63], v[92:95]
  ds_read_b64_tr_b16 a[38:39], v11 offset:10912
  v_mfma_f32_16x16x32_bf16 v[32:35], a[84:87], a[48:51], v[32:35]
  ds_read_b64_tr_b16 a[24:25], v11 offset:192
  s_add_u32 m0, s44, 64512
  s_nop 0
  buffer_load_dwordx4 v2, s[12:15], s29 offen offset:1024 lds
  v_mfma_f32_16x16x32_bf16 v[56:59], a[84:87], a[52:55], v[56:59]
  ds_read_b64_tr_b16 a[26:27], v11 offset:3776
  v_mfma_f32_16x16x32_bf16 v[80:83], a[84:87], a[56:59], v[80:83]
  ds_read_b64_tr_b16 a[40:41], v11 offset:7360
  v_mfma_f32_16x16x32_bf16 v[104:107], a[84:87], a[60:63], v[104:107]
  ds_read_b64_tr_b16 a[42:43], v11 offset:10944
  v_mfma_f32_16x16x32_bf16 v[24:27], a[72:75], a[48:51], v[24:27]
  v_mfma_f32_16x16x32_bf16 v[48:51], a[72:75], a[52:55], v[48:51]
  v_mfma_f32_16x16x32_bf16 v[72:75], a[72:75], a[56:59], v[72:75]
  v_mfma_f32_16x16x32_bf16 v[96:99], a[72:75], a[60:63], v[96:99]
  v_mfma_f32_16x16x32_bf16 v[36:39], a[88:91], a[48:51], v[36:39]
  s_add_u32 m0, s44, 65536
  s_nop 0
  buffer_load_dwordx4 v3, s[12:15], s29 offen offset:1024 lds
  v_mfma_f32_16x16x32_bf16 v[60:63], a[88:91], a[52:55], v[60:63]
  v_mfma_f32_16x16x32_bf16 v[84:87], a[88:91], a[56:59], v[84:87]
  v_mfma_f32_16x16x32_bf16 v[108:111], a[88:91], a[60:63], v[108:111]
  s_waitcnt vmcnt(10) lgkmcnt(0)
  s_barrier
  v_mfma_f32_16x16x32_bf16 v[16:19], a[16:19], a[0:3], v[16:19]
  ds_read_b128 a[48:51], v8 offset:0
  v_mfma_f32_16x16x32_bf16 v[40:43], a[16:19], a[4:7], v[40:43]
  ds_read_b128 a[52:55], v8 offset:2048
  v_mfma_f32_16x16x32_bf16 v[64:67], a[16:19], a[8:11], v[64:67]
  ds_read_b128 a[56:59], v8 offset:4096
  v_mfma_f32_16x16x32_bf16 v[88:91], a[16:19], a[12:15], v[88:91]
  ds_read_b128 a[60:63], v8 offset:6144
  s_mov_b64 exec, s[36:37]
  s_add_u32 m0, s45, 0
  s_add_u32 s40, s31, 3670016
  buffer_load_dwordx4 v6, s[16:19], s40 offen lds
  s_add_u32 m0, s45, 896
  s_add_u32 s40, s31, 3727360
  buffer_load_dwordx4 v6, s[16:19], s40 offen lds
  s_mov_b64 exec, -1
  v_mfma_f32_16x16x32_bf16 v[28:31], a[32:35], a[0:3], v[28:31]
  ds_read_b64_tr_b16 a[64:65], v11 offset:14464
  v_mfma_f32_16x16x32_bf16 v[52:55], a[32:35], a[4:7], v[52:55]
  ds_read_b64_tr_b16 a[66:67], v11 offset:18048
  v_mfma_f32_16x16x32_bf16 v[76:79], a[32:35], a[8:11], v[76:79]
  ds_read_b64_tr_b16 a[80:81], v11 offset:21632
  v_mfma_f32_16x16x32_bf16 v[100:103], a[32:35], a[12:15], v[100:103]
  ds_read_b64_tr_b16 a[82:83], v11 offset:25216
  v_mfma_f32_16x16x32_bf16 v[20:23], a[20:23], a[0:3], v[20:23]
  ds_read_b64_tr_b16 a[68:69], v11 offset:14496
  v_mfma_f32_16x16x32_bf16 v[44:47], a[20:23], a[4:7], v[44:47]
  ds_read_b64_tr_b16 a[70:71], v11 offset:18080
  v_mfma_f32_16x16x32_bf16 v[68:71], a[20:23], a[8:11], v[68:71]
  ds_read_b64_tr_b16 a[84:85], v11 offset:21664
  v_mfma_f32_16x16x32_bf16 v[92:95], a[20:23], a[12:15], v[92:95]
  ds_read_b64_tr_b16 a[86:87], v11 offset:25248
  v_mfma_f32_16x16x32_bf16 v[32:35], a[36:39], a[0:3], v[32:35]
  ds_read_b64_tr_b16 a[72:73], v11 offset:14528
  s_add_u32 m0, s44, 66560
  s_nop 0
  buffer_load_dwordx4 v4, s[12:15], s29 offen offset:1024 lds
  v_mfma_f32_16x16x32_bf16 v[56:59], a[36:39], a[4:7], v[56:59]
  ds_read_b64_tr_b16 a[74:75], v11 offset:18112
  v_mfma_f32_16x16x32_bf16 v[80:83], a[36:39], a[8:11], v[80:83]
  ds_read_b64_tr_b16 a[88:89], v11 offset:21696
  v_mfma_f32_16x16x32_bf16 v[104:107], a[36:39], a[12:15], v[104:107]
  ds_read_b64_tr_b16 a[90:91], v11 offset:25280
  v_mfma_f32_16x16x32_bf16 v[24:27], a[24:27], a[0:3], v[24:27]
  v_mfma_f32_16x16x32_bf16 v[48:51], a[24:27], a[4:7], v[48:51]
  v_mfma_f32_16x16x32_bf16 v[72:75], a[24:27], a[8:11], v[72:75]
  v_mfma_f32_16x16x32_bf16 v[96:99], a[24:27], a[12:15], v[96:99]
  v_mfma_f32_16x16x32_bf16 v[36:39], a[40:43], a[0:3], v[36:39]
  s_add_u32 m0, s44, 67584
  s_nop 0
  buffer_load_dwordx4 v5, s[12:15], s29 offen offset:1024 lds
  v_mfma_f32_16x16x32_bf16 v[60:63], a[40:43], a[4:7], v[60:63]
  v_mfma_f32_16x16x32_bf16 v[84:87], a[40:43], a[8:11], v[84:87]
  v_mfma_f32_16x16x32_bf16 v[108:111], a[40:43], a[12:15], v[108:111]
  s_waitcnt vmcnt(8) lgkmcnt(0)
  s_barrier
  v_mfma_f32_16x16x32_bf16 v[16:19], a[64:67], a[48:51], v[16:19]
  ds_read_b128 a[0:3], v7 offset:32768
  v_mfma_f32_16x16x32_bf16 v[40:43], a[64:67], a[52:55], v[40:43]
  ds_read_b128 a[4:7], v7 offset:34816
  v_mfma_f32_16x16x32_bf16 v[64:67], a[64:67], a[56:59], v[64:67]
  ds_read_b128 a[8:11], v7 offset:36864
  v_mfma_f32_16x16x32_bf16 v[88:91], a[64:67], a[60:63], v[88:91]
  ds_read_b128 a[12:15], v7 offset:38912
  s_mov_b64 exec, s[36:37]
  s_add_u32 m0, s45, 14336
  s_add_u32 s40, s31, 3899392
  buffer_load_dwordx4 v6, s[16:19], s40 offen lds
  s_add_u32 m0, s45, 15232
  s_add_u32 s40, s31, 3956736
  buffer_load_dwordx4 v6, s[16:19], s40 offen lds
  s_mov_b64 exec, -1
  v_mfma_f32_16x16x32_bf16 v[28:31], a[80:83], a[48:51], v[28:31]
  ds_read_b64_tr_b16 a[16:17], v11 offset:28800
  v_mfma_f32_16x16x32_bf16 v[52:55], a[80:83], a[52:55], v[52:55]
  ds_read_b64_tr_b16 a[18:19], v11 offset:32384
  v_mfma_f32_16x16x32_bf16 v[76:79], a[80:83], a[56:59], v[76:79]
  ds_read_b64_tr_b16 a[32:33], v11 offset:35968
  v_mfma_f32_16x16x32_bf16 v[100:103], a[80:83], a[60:63], v[100:103]
  ds_read_b64_tr_b16 a[34:35], v11 offset:39552
  v_mfma_f32_16x16x32_bf16 v[20:23], a[68:71], a[48:51], v[20:23]
  ds_read_b64_tr_b16 a[20:21], v11 offset:28832
  v_mfma_f32_16x16x32_bf16 v[44:47], a[68:71], a[52:55], v[44:47]
  ds_read_b64_tr_b16 a[22:23], v11 offset:32416
  v_mfma_f32_16x16x32_bf16 v[68:71], a[68:71], a[56:59], v[68:71]
  ds_read_b64_tr_b16 a[36:37], v11 offset:36000
  v_mfma_f32_16x16x32_bf16 v[92:95], a[68:71], a[60:63], v[92:95]
  ds_read_b64_tr_b16 a[38:39], v11 offset:39584
  v_mfma_f32_16x16x32_bf16 v[32:35], a[84:87], a[48:51], v[32:35]
  ds_read_b64_tr_b16 a[24:25], v11 offset:28864
  s_add_u32 m0, s44, 4294966144
  s_nop 0
  buffer_load_dwordx4 v2, s[12:15], s29 offen offset:1152 lds
  v_mfma_f32_16x16x32_bf16 v[56:59], a[84:87], a[52:55], v[56:59]
  ds_read_b64_tr_b16 a[26:27], v11 offset:32448
  v_mfma_f32_16x16x32_bf16 v[80:83], a[84:87], a[56:59], v[80:83]
  ds_read_b64_tr_b16 a[40:41], v11 offset:36032
  v_mfma_f32_16x16x32_bf16 v[104:107], a[84:87], a[60:63], v[104:107]
  ds_read_b64_tr_b16 a[42:43], v11 offset:39616
  v_mfma_f32_16x16x32_bf16 v[24:27], a[72:75], a[48:51], v[24:27]
  v_mfma_f32_16x16x32_bf16 v[48:51], a[72:75], a[52:55], v[48:51]
  v_mfma_f32_16x16x32_bf16 v[72:75], a[72:75], a[56:59], v[72:75]
  v_mfma_f32_16x16x32_bf16 v[96:99], a[72:75], a[60:63], v[96:99]
  v_mfma_f32_16x16x32_bf16 v[36:39], a[88:91], a[48:51], v[36:39]
  s_add_u32 m0, s44, 4294967168
  s_nop 0
  buffer_load_dwordx4 v3, s[12:15], s29 offen offset:1152 lds
  v_mfma_f32_16x16x32_bf16 v[60:63], a[88:91], a[52:55], v[60:63]
  v_mfma_f32_16x16x32_bf16 v[84:87], a[88:91], a[56:59], v[84:87]
  v_mfma_f32_16x16x32_bf16 v[108:111], a[88:91], a[60:63], v[108:111]
  s_waitcnt vmcnt(10) lgkmcnt(0)
  s_barrier
  v_mfma_f32_16x16x32_bf16 v[16:19], a[16:19], a[0:3], v[16:19]
  ds_read_b128 a[48:51], v8 offset:32768
  v_mfma_f32_16x16x32_bf16 v[40:43], a[16:19], a[4:7], v[40:43]
  ds_read_b128 a[52:55], v8 offset:34816
  v_mfma_f32_16x16x32_bf16 v[64:67], a[16:19], a[8:11], v[64:67]
  ds_read_b128 a[56:59], v8 offset:36864
  v_mfma_f32_16x16x32_bf16 v[88:91], a[16:19], a[12:15], v[88:91]
  ds_read_b128 a[60:63], v8 offset:38912
  s_mov_b64 exec, s[36:37]
  s_add_u32 m0, s45, 28672
  s_add_u32 s40, s31, 4128768
  buffer_load_dwordx4 v6, s[16:19], s40 offen lds
  s_add_u32 m0, s45, 29568
  s_add_u32 s40, s31, 4186112
  buffer_load_dwordx4 v6, s[16:19], s40 offen lds
  s_mov_b64 exec, -1
  v_mfma_f32_16x16x32_bf16 v[28:31], a[32:35], a[0:3], v[28:31]
  ds_read_b64_tr_b16 a[64:65], v11 offset:43136
  v_mfma_f32_16x16x32_bf16 v[52:55], a[32:35], a[4:7], v[52:55]
  ds_read_b64_tr_b16 a[66:67], v11 offset:46720
  v_mfma_f32_16x16x32_bf16 v[76:79], a[32:35], a[8:11], v[76:79]
  ds_read_b64_tr_b16 a[80:81], v11 offset:50304
  v_mfma_f32_16x16x32_bf16 v[100:103], a[32:35], a[12:15], v[100:103]
  ds_read_b64_tr_b16 a[82:83], v11 offset:53888
  v_mfma_f32_16x16x32_bf16 v[20:23], a[20:23], a[0:3], v[20:23]
  ds_read_b64_tr_b16 a[68:69], v11 offset:43168
  v_mfma_f32_16x16x32_bf16 v[44:47], a[20:23], a[4:7], v[44:47]
  ds_read_b64_tr_b16 a[70:71], v11 offset:46752
  v_mfma_f32_16x16x32_bf16 v[68:71], a[20:23], a[8:11], v[68:71]
  ds_read_b64_tr_b16 a[84:85], v11 offset:50336
  v_mfma_f32_16x16x32_bf16 v[92:95], a[20:23], a[12:15], v[92:95]
  ds_read_b64_tr_b16 a[86:87], v11 offset:53920
  v_mfma_f32_16x16x32_bf16 v[32:35], a[36:39], a[0:3], v[32:35]
  ds_read_b64_tr_b16 a[72:73], v11 offset:43200
  s_add_u32 m0, s44, 896
  s_nop 0
  buffer_load_dwordx4 v4, s[12:15], s29 offen offset:1152 lds
  v_mfma_f32_16x16x32_bf16 v[56:59], a[36:39], a[4:7], v[56:59]
  ds_read_b64_tr_b16 a[74:75], v11 offset:46784
  v_mfma_f32_16x16x32_bf16 v[80:83], a[36:39], a[8:11], v[80:83]
  ds_read_b64_tr_b16 a[88:89], v11 offset:50368
  v_mfma_f32_16x16x32_bf16 v[104:107], a[36:39], a[12:15], v[104:107]
  ds_read_b64_tr_b16 a[90:91], v11 offset:53952
  v_mfma_f32_16x16x32_bf16 v[24:27], a[24:27], a[0:3], v[24:27]
  v_mfma_f32_16x16x32_bf16 v[48:51], a[24:27], a[4:7], v[48:51]
  v_mfma_f32_16x16x32_bf16 v[72:75], a[24:27], a[8:11], v[72:75]
  v_mfma_f32_16x16x32_bf16 v[96:99], a[24:27], a[12:15], v[96:99]
  v_mfma_f32_16x16x32_bf16 v[36:39], a[40:43], a[0:3], v[36:39]
  s_add_u32 m0, s44, 1920
  s_nop 0
  buffer_load_dwordx4 v5, s[12:15], s29 offen offset:1152 lds
  v_mfma_f32_16x16x32_bf16 v[60:63], a[40:43], a[4:7], v[60:63]
  v_mfma_f32_16x16x32_bf16 v[84:87], a[40:43], a[8:11], v[84:87]
  v_mfma_f32_16x16x32_bf16 v[108:111], a[40:43], a[12:15], v[108:111]
  s_waitcnt vmcnt(8) lgkmcnt(0)
  s_barrier
  v_mfma_f32_16x16x32_bf16 v[16:19], a[64:67], a[48:51], v[16:19]
  ds_read_b128 a[0:3], v9 offset:0
  v_mfma_f32_16x16x32_bf16 v[40:43], a[64:67], a[52:55], v[40:43]
  ds_read_b128 a[4:7], v9 offset:2048
  v_mfma_f32_16x16x32_bf16 v[64:67], a[64:67], a[56:59], v[64:67]
  ds_read_b128 a[8:11], v9 offset:4096
  v_mfma_f32_16x16x32_bf16 v[88:91], a[64:67], a[60:63], v[88:91]
  ds_read_b128 a[12:15], v9 offset:6144
  s_mov_b64 exec, s[36:37]
  s_add_u32 m0, s45, 43008
  s_add_u32 s40, s31, 4358144
  buffer_load_dwordx4 v6, s[16:19], s40 offen lds
  s_add_u32 m0, s45, 43904
  s_add_u32 s40, s31, 4415488
  buffer_load_dwordx4 v6, s[16:19], s40 offen lds
  s_mov_b64 exec, -1
  v_mfma_f32_16x16x32_bf16 v[28:31], a[80:83], a[48:51], v[28:31]
  ds_read_b64_tr_b16 a[16:17], v11 offset:128
  v_mfma_f32_16x16x32_bf16 v[52:55], a[80:83], a[52:55], v[52:55]
  ds_read_b64_tr_b16 a[18:19], v11 offset:3712
  v_mfma_f32_16x16x32_bf16 v[76:79], a[80:83], a[56:59], v[76:79]
  ds_read_b64_tr_b16 a[32:33], v11 offset:7296
  v_mfma_f32_16x16x32_bf16 v[100:103], a[80:83], a[60:63], v[100:103]
  ds_read_b64_tr_b16 a[34:35], v11 offset:10880
  v_mfma_f32_16x16x32_bf16 v[20:23], a[68:71], a[48:51], v[20:23]
  ds_read_b64_tr_b16 a[20:21], v11 offset:160
  v_mfma_f32_16x16x32_bf16 v[44:47], a[68:71], a[52:55], v[44:47]
  ds_read_b64_tr_b16 a[22:23], v11 offset:3744
  v_mfma_f32_16x16x32_bf16 v[68:71], a[68:71], a[56:59], v[68:71]
  ds_read_b64_tr_b16 a[36:37], v11 offset:7328
  v_mfma_f32_16x16x32_bf16 v[92:95], a[68:71], a[60:63], v[92:95]
  ds_read_b64_tr_b16 a[38:39], v11 offset:10912
  v_mfma_f32_16x16x32_bf16 v[32:35], a[84:87], a[48:51], v[32:35]
  ds_read_b64_tr_b16 a[24:25], v11 offset:192
  s_add_u32 m0, s44, 31488
  s_nop 0
  buffer_load_dwordx4 v2, s[12:15], s29 offen offset:1280 lds
  v_mfma_f32_16x16x32_bf16 v[56:59], a[84:87], a[52:55], v[56:59]
  ds_read_b64_tr_b16 a[26:27], v11 offset:3776
  v_mfma_f32_16x16x32_bf16 v[80:83], a[84:87], a[56:59], v[80:83]
  ds_read_b64_tr_b16 a[40:41], v11 offset:7360
  v_mfma_f32_16x16x32_bf16 v[104:107], a[84:87], a[60:63], v[104:107]
  ds_read_b64_tr_b16 a[42:43], v11 offset:10944
  v_mfma_f32_16x16x32_bf16 v[24:27], a[72:75], a[48:51], v[24:27]
  v_mfma_f32_16x16x32_bf16 v[48:51], a[72:75], a[52:55], v[48:51]
  v_mfma_f32_16x16x32_bf16 v[72:75], a[72:75], a[56:59], v[72:75]
  v_mfma_f32_16x16x32_bf16 v[96:99], a[72:75], a[60:63], v[96:99]
  v_mfma_f32_16x16x32_bf16 v[36:39], a[88:91], a[48:51], v[36:39]
  s_add_u32 m0, s44, 32512
  s_nop 0
  buffer_load_dwordx4 v3, s[12:15], s29 offen offset:1280 lds
  v_mfma_f32_16x16x32_bf16 v[60:63], a[88:91], a[52:55], v[60:63]
  v_mfma_f32_16x16x32_bf16 v[84:87], a[88:91], a[56:59], v[84:87]
  v_mfma_f32_16x16x32_bf16 v[108:111], a[88:91], a[60:63], v[108:111]
  s_waitcnt vmcnt(10) lgkmcnt(0)
  s_barrier
  v_mfma_f32_16x16x32_bf16 v[16:19], a[16:19], a[0:3], v[16:19]
  ds_read_b128 a[48:51], v10 offset:0
  v_mfma_f32_16x16x32_bf16 v[40:43], a[16:19], a[4:7], v[40:43]
  ds_read_b128 a[52:55], v10 offset:2048
  v_mfma_f32_16x16x32_bf16 v[64:67], a[16:19], a[8:11], v[64:67]
  ds_read_b128 a[56:59], v10 offset:4096
  v_mfma_f32_16x16x32_bf16 v[88:91], a[16:19], a[12:15], v[88:91]
  ds_read_b128 a[60:63], v10 offset:6144
  s_mov_b64 exec, s[36:37]
  s_add_u32 m0, s45, 0
  s_add_u32 s40, s31, 4587520
  buffer_load_dwordx4 v6, s[16:19], s40 offen lds
  s_add_u32 m0, s45, 896
  s_add_u32 s40, s31, 4644864
  buffer_load_dwordx4 v6, s[16:19], s40 offen lds
  s_mov_b64 exec, -1
  v_mfma_f32_16x16x32_bf16 v[28:31], a[32:35], a[0:3], v[28:31]
  ds_read_b64_tr_b16 a[64:65], v11 offset:14464
  v_mfma_f32_16x16x32_bf16 v[52:55], a[32:35], a[4:7], v[52:55]
  ds_read_b64_tr_b16 a[66:67], v11 offset:18048
  v_mfma_f32_16x16x32_bf16 v[76:79], a[32:35], a[8:11], v[76:79]
  ds_read_b64_tr_b16 a[80:81], v11 offset:21632
  v_mfma_f32_16x16x32_bf16 v[100:103], a[32:35], a[12:15], v[100:103]
  ds_read_b64_tr_b16 a[82:83], v11 offset:25216
  v_mfma_f32_16x16x32_bf16 v[20:23], a[20:23], a[0:3], v[20:23]
  ds_read_b64_tr_b16 a[68:69], v11 offset:14496
  v_mfma_f32_16x16x32_bf16 v[44:47], a[20:23], a[4:7], v[44:47]
  ds_read_b64_tr_b16 a[70:71], v11 offset:18080
  v_mfma_f32_16x16x32_bf16 v[68:71], a[20:23], a[8:11], v[68:71]
  ds_read_b64_tr_b16 a[84:85], v11 offset:21664
  v_mfma_f32_16x16x32_bf16 v[92:95], a[20:23], a[12:15], v[92:95]
  ds_read_b64_tr_b16 a[86:87], v11 offset:25248
  v_mfma_f32_16x16x32_bf16 v[32:35], a[36:39], a[0:3], v[32:35]
  ds_read_b64_tr_b16 a[72:73], v11 offset:14528
  s_add_u32 m0, s44, 33536
  s_nop 0
  buffer_load_dwordx4 v4, s[12:15], s29 offen offset:1280 lds
  v_mfma_f32_16x16x32_bf16 v[56:59], a[36:39], a[4:7], v[56:59]
  ds_read_b64_tr_b16 a[74:75], v11 offset:18112
  v_mfma_f32_16x16x32_bf16 v[80:83], a[36:39], a[8:11], v[80:83]
  ds_read_b64_tr_b16 a[88:89], v11 offset:21696
  v_mfma_f32_16x16x32_bf16 v[104:107], a[36:39], a[12:15], v[104:107]
  ds_read_b64_tr_b16 a[90:91], v11 offset:25280
  v_mfma_f32_16x16x32_bf16 v[24:27], a[24:27], a[0:3], v[24:27]
  v_mfma_f32_16x16x32_bf16 v[48:51], a[24:27], a[4:7], v[48:51]
  v_mfma_f32_16x16x32_bf16 v[72:75], a[24:27], a[8:11], v[72:75]
  v_mfma_f32_16x16x32_bf16 v[96:99], a[24:27], a[12:15], v[96:99]
  v_mfma_f32_16x16x32_bf16 v[36:39], a[40:43], a[0:3], v[36:39]
  s_add_u32 m0, s44, 34560
  s_nop 0
  buffer_load_dwordx4 v5, s[12:15], s29 offen offset:1280 lds
  v_mfma_f32_16x16x32_bf16 v[60:63], a[40:43], a[4:7], v[60:63]
  v_mfma_f32_16x16x32_bf16 v[84:87], a[40:43], a[8:11], v[84:87]
  v_mfma_f32_16x16x32_bf16 v[108:111], a[40:43], a[12:15], v[108:111]
  s_waitcnt vmcnt(8) lgkmcnt(0)
  s_barrier
  v_mfma_f32_16x16x32_bf16 v[16:19], a[64:67], a[48:51], v[16:19]
  ds_read_b128 a[0:3], v7 offset:0
  v_mfma_f32_16x16x32_bf16 v[40:43], a[64:67], a[52:55], v[40:43]
  ds_read_b128 a[4:7], v7 offset:2048
  v_mfma_f32_16x16x32_bf16 v[64:67], a[64:67], a[56:59], v[64:67]
  ds_read_b128 a[8:11], v7 offset:4096
  v_mfma_f32_16x16x32_bf16 v[88:91], a[64:67], a[60:63], v[88:91]
  ds_read_b128 a[12:15], v7 offset:6144
  s_mov_b64 exec, s[36:37]
  s_add_u32 m0, s45, 14336
  s_add_u32 s40, s31, 4816896
  buffer_load_dwordx4 v6, s[16:19], s40 offen lds
  s_add_u32 m0, s45, 15232
  s_add_u32 s40, s31, 4874240
  buffer_load_dwordx4 v6, s[16:19], s40 offen lds
  s_mov_b64 exec, -1
  v_mfma_f32_16x16x32_bf16 v[28:31], a[80:83], a[48:51], v[28:31]
  ds_read_b64_tr_b16 a[16:17], v11 offset:28800
  v_mfma_f32_16x16x32_bf16 v[52:55], a[80:83], a[52:55], v[52:55]
  ds_read_b64_tr_b16 a[18:19], v11 offset:32384
  v_mfma_f32_16x16x32_bf16 v[76:79], a[80:83], a[56:59], v[76:79]
  ds_read_b64_tr_b16 a[32:33], v11 offset:35968
  v_mfma_f32_16x16x32_bf16 v[100:103], a[80:83], a[60:63], v[100:103]
  ds_read_b64_tr_b16 a[34:35], v11 offset:39552
  v_mfma_f32_16x16x32_bf16 v[20:23], a[68:71], a[48:51], v[20:23]
  ds_read_b64_tr_b16 a[20:21], v11 offset:28832
  v_mfma_f32_16x16x32_bf16 v[44:47], a[68:71], a[52:55], v[44:47]
  ds_read_b64_tr_b16 a[22:23], v11 offset:32416
  v_mfma_f32_16x16x32_bf16 v[68:71], a[68:71], a[56:59], v[68:71]
  ds_read_b64_tr_b16 a[36:37], v11 offset:36000
  v_mfma_f32_16x16x32_bf16 v[92:95], a[68:71], a[60:63], v[92:95]
  ds_read_b64_tr_b16 a[38:39], v11 offset:39584
  v_mfma_f32_16x16x32_bf16 v[32:35], a[84:87], a[48:51], v[32:35]
  ds_read_b64_tr_b16 a[24:25], v11 offset:28864
  s_add_u32 m0, s44, 64128
  s_nop 0
  buffer_load_dwordx4 v2, s[12:15], s29 offen offset:1408 lds
  v_mfma_f32_16x16x32_bf16 v[56:59], a[84:87], a[52:55], v[56:59]
  ds_read_b64_tr_b16 a[26:27], v11 offset:32448
  v_mfma_f32_16x16x32_bf16 v[80:83], a[84:87], a[56:59], v[80:83]
  ds_read_b64_tr_b16 a[40:41], v11 offset:36032
  v_mfma_f32_16x16x32_bf16 v[104:107], a[84:87], a[60:63], v[104:107]
  ds_read_b64_tr_b16 a[42:43], v11 offset:39616
  v_mfma_f32_16x16x32_bf16 v[24:27], a[72:75], a[48:51], v[24:27]
  v_mfma_f32_16x16x32_bf16 v[48:51], a[72:75], a[52:55], v[48:51]
  v_mfma_f32_16x16x32_bf16 v[72:75], a[72:75], a[56:59], v[72:75]
  v_mfma_f32_16x16x32_bf16 v[96:99], a[72:75], a[60:63], v[96:99]
  v_mfma_f32_16x16x32_bf16 v[36:39], a[88:91], a[48:51], v[36:39]
  s_add_u32 m0, s44, 65152
  s_nop 0
  buffer_load_dwordx4 v3, s[12:15], s29 offen offset:1408 lds
  v_mfma_f32_16x16x32_bf16 v[60:63], a[88:91], a[52:55], v[60:63]
  v_mfma_f32_16x16x32_bf16 v[84:87], a[88:91], a[56:59], v[84:87]
  v_mfma_f32_16x16x32_bf16 v[108:111], a[88:91], a[60:63], v[108:111]
  s_waitcnt vmcnt(10) lgkmcnt(0)
  s_barrier
  v_mfma_f32_16x16x32_bf16 v[16:19], a[16:19], a[0:3], v[16:19]
  ds_read_b128 a[48:51], v8 offset:0
  v_mfma_f32_16x16x32_bf16 v[40:43], a[16:19], a[4:7], v[40:43]
  ds_read_b128 a[52:55], v8 offset:2048
  v_mfma_f32_16x16x32_bf16 v[64:67], a[16:19], a[8:11], v[64:67]
  ds_read_b128 a[56:59], v8 offset:4096
  v_mfma_f32_16x16x32_bf16 v[88:91], a[16:19], a[12:15], v[88:91]
  ds_read_b128 a[60:63], v8 offset:6144
  s_mov_b64 exec, s[36:37]
  s_add_u32 m0, s45, 28672
  s_add_u32 s40, s31, 5046272
  buffer_load_dwordx4 v6, s[16:19], s40 offen lds
  s_add_u32 m0, s45, 29568
  s_add_u32 s40, s31, 5103616
  buffer_load_dwordx4 v6, s[16:19], s40 offen lds
  s_mov_b64 exec, -1
  v_mfma_f32_16x16x32_bf16 v[28:31], a[32:35], a[0:3], v[28:31]
  ds_read_b64_tr_b16 a[64:65], v11 offset:43136
  v_mfma_f32_16x16x32_bf16 v[52:55], a[32:35], a[4:7], v[52:55]
  ds_read_b64_tr_b16 a[66:67], v11 offset:46720
  v_mfma_f32_16x16x32_bf16 v[76:79], a[32:35], a[8:11], v[76:79]
  ds_read_b64_tr_b16 a[80:81], v11 offset:50304
  v_mfma_f32_16x16x32_bf16 v[100:103], a[32:35], a[12:15], v[100:103]
  ds_read_b64_tr_b16 a[82:83], v11 offset:53888
  v_mfma_f32_16x16x32_bf16 v[20:23], a[20:23], a[0:3], v[20:23]
  ds_read_b64_tr_b16 a[68:69], v11 offset:43168
  v_mfma_f32_16x16x32_bf16 v[44:47], a[20:23], a[4:7], v[44:47]
  ds_read_b64_tr_b16 a[70:71], v11 offset:46752
  v_mfma_f32_16x16x32_bf16 v[68:71], a[20:23], a[8:11], v[68:71]
  ds_read_b64_tr_b16 a[84:85], v11 offset:50336
  v_mfma_f32_16x16x32_bf16 v[92:95], a[20:23], a[12:15], v[92:95]
  ds_read_b64_tr_b16 a[86:87], v11 offset:53920
  v_mfma_f32_16x16x32_bf16 v[32:35], a[36:39], a[0:3], v[32:35]
  ds_read_b64_tr_b16 a[72:73], v11 offset:43200
  s_add_u32 m0, s44, 66176
  s_nop 0
  buffer_load_dwordx4 v4, s[12:15], s29 offen offset:1408 lds
  v_mfma_f32_16x16x32_bf16 v[56:59], a[36:39], a[4:7], v[56:59]
  ds_read_b64_tr_b16 a[74:75], v11 offset:46784
  v_mfma_f32_16x16x32_bf16 v[80:83], a[36:39], a[8:11], v[80:83]
  ds_read_b64_tr_b16 a[88:89], v11 offset:50368
  v_mfma_f32_16x16x32_bf16 v[104:107], a[36:39], a[12:15], v[104:107]
  ds_read_b64_tr_b16 a[90:91], v11 offset:53952
  v_mfma_f32_16x16x32_bf16 v[24:27], a[24:27], a[0:3], v[24:27]
  v_mfma_f32_16x16x32_bf16 v[48:51], a[24:27], a[4:7], v[48:51]
  v_mfma_f32_16x16x32_bf16 v[72:75], a[24:27], a[8:11], v[72:75]
  v_mfma_f32_16x16x32_bf16 v[96:99], a[24:27], a[12:15], v[96:99]
  v_mfma_f32_16x16x32_bf16 v[36:39], a[40:43], a[0:3], v[36:39]
  s_add_u32 m0, s44, 67200
  s_nop 0
  buffer_load_dwordx4 v5, s[12:15], s29 offen offset:1408 lds
  s_mul_i32 s62, s2, 28672
  s_mul_i32 s40, s27, 7168
  s_add_u32 s62, s62, s40
  s_add_u32 s63, s62, 4096
  buffer_load_dwordx4 v[112:115], v15, s[48:51], s62 offen offset:0
  buffer_load_dwordx4 v[116:119], v15, s[48:51], s62 offen offset:1024
  buffer_load_dwordx4 v[120:123], v15, s[48:51], s62 offen offset:2048
  buffer_load_dwordx4 v[124:127], v15, s[48:51], s62 offen offset:3072
  buffer_load_dwordx4 v[128:131], v15, s[48:51], s63 offen offset:0
  buffer_load_dwordx4 v[132:135], v15, s[48:51], s63 offen offset:1024
  buffer_load_dwordx4 v[136:139], v15, s[48:51], s63 offen offset:2048
  v_mfma_f32_16x16x32_bf16 v[60:63], a[40:43], a[4:7], v[60:63]
  v_mfma_f32_16x16x32_bf16 v[84:87], a[40:43], a[8:11], v[84:87]
  v_mfma_f32_16x16x32_bf16 v[108:111], a[40:43], a[12:15], v[108:111]
  s_waitcnt vmcnt(15) lgkmcnt(0)
  s_barrier
  v_mfma_f32_16x16x32_bf16 v[16:19], a[64:67], a[48:51], v[16:19]
  ds_read_b128 a[0:3], v7 offset:32768
  v_mfma_f32_16x16x32_bf16 v[40:43], a[64:67], a[52:55], v[40:43]
  ds_read_b128 a[4:7], v7 offset:34816
  v_mfma_f32_16x16x32_bf16 v[64:67], a[64:67], a[56:59], v[64:67]
  ds_read_b128 a[8:11], v7 offset:36864
  v_mfma_f32_16x16x32_bf16 v[88:91], a[64:67], a[60:63], v[88:91]
  ds_read_b128 a[12:15], v7 offset:38912
  s_mov_b64 exec, s[36:37]
  s_add_u32 m0, s45, 43008
  s_add_u32 s40, s31, 5275648
  buffer_load_dwordx4 v6, s[16:19], s40 offen lds
  s_add_u32 m0, s45, 43904
  s_add_u32 s40, s31, 5332992
  buffer_load_dwordx4 v6, s[16:19], s40 offen lds
  s_mov_b64 exec, -1
  v_mfma_f32_16x16x32_bf16 v[28:31], a[80:83], a[48:51], v[28:31]
  ds_read_b64_tr_b16 a[16:17], v11 offset:128
  v_mfma_f32_16x16x32_bf16 v[52:55], a[80:83], a[52:55], v[52:55]
  ds_read_b64_tr_b16 a[18:19], v11 offset:3712
  v_mfma_f32_16x16x32_bf16 v[76:79], a[80:83], a[56:59], v[76:79]
  ds_read_b64_tr_b16 a[32:33], v11 offset:7296
  v_mfma_f32_16x16x32_bf16 v[100:103], a[80:83], a[60:63], v[100:103]
  ds_read_b64_tr_b16 a[34:35], v11 offset:10880
  v_mfma_f32_16x16x32_bf16 v[20:23], a[68:71], a[48:51], v[20:23]
  ds_read_b64_tr_b16 a[20:21], v11 offset:160
  v_mfma_f32_16x16x32_bf16 v[44:47], a[68:71], a[52:55], v[44:47]
  ds_read_b64_tr_b16 a[22:23], v11 offset:3744
  v_mfma_f32_16x16x32_bf16 v[68:71], a[68:71], a[56:59], v[68:71]
  ds_read_b64_tr_b16 a[36:37], v11 offset:7328
  v_mfma_f32_16x16x32_bf16 v[92:95], a[68:71], a[60:63], v[92:95]
  ds_read_b64_tr_b16 a[38:39], v11 offset:10912
  v_mfma_f32_16x16x32_bf16 v[32:35], a[84:87], a[48:51], v[32:35]
  ds_read_b64_tr_b16 a[24:25], v11 offset:192
  s_add_u32 m0, s44, 4294965760
  s_nop 0
  buffer_load_dwordx4 v2, s[12:15], s29 offen offset:1536 lds
  v_mfma_f32_16x16x32_bf16 v[56:59], a[84:87], a[52:55], v[56:59]
  ds_read_b64_tr_b16 a[26:27], v11 offset:3776
  v_mfma_f32_16x16x32_bf16 v[80:83], a[84:87], a[56:59], v[80:83]
  ds_read_b64_tr_b16 a[40:41], v11 offset:7360
  v_mfma_f32_16x16x32_bf16 v[104:107], a[84:87], a[60:63], v[104:107]
  ds_read_b64_tr_b16 a[42:43], v11 offset:10944
  v_mfma_f32_16x16x32_bf16 v[24:27], a[72:75], a[48:51], v[24:27]
  v_mfma_f32_16x16x32_bf16 v[48:51], a[72:75], a[52:55], v[48:51]
  v_mfma_f32_16x16x32_bf16 v[72:75], a[72:75], a[56:59], v[72:75]
  v_mfma_f32_16x16x32_bf16 v[96:99], a[72:75], a[60:63], v[96:99]
  v_mfma_f32_16x16x32_bf16 v[36:39], a[88:91], a[48:51], v[36:39]
  s_add_u32 m0, s44, 4294966784
  s_nop 0
  buffer_load_dwordx4 v3, s[12:15], s29 offen offset:1536 lds
  v_mfma_f32_16x16x32_bf16 v[60:63], a[88:91], a[52:55], v[60:63]
  v_mfma_f32_16x16x32_bf16 v[84:87], a[88:91], a[56:59], v[84:87]
  v_mfma_f32_16x16x32_bf16 v[108:111], a[88:91], a[60:63], v[108:111]
  s_waitcnt vmcnt(17) lgkmcnt(0)
  s_barrier
  v_mfma_f32_16x16x32_bf16 v[16:19], a[16:19], a[0:3], v[16:19]
  ds_read_b128 a[48:51], v8 offset:32768
  v_mfma_f32_16x16x32_bf16 v[40:43], a[16:19], a[4:7], v[40:43]
  ds_read_b128 a[52:55], v8 offset:34816
  v_mfma_f32_16x16x32_bf16 v[64:67], a[16:19], a[8:11], v[64:67]
  ds_read_b128 a[56:59], v8 offset:36864
  v_mfma_f32_16x16x32_bf16 v[88:91], a[16:19], a[12:15], v[88:91]
  ds_read_b128 a[60:63], v8 offset:38912
  s_mov_b64 exec, s[36:37]
  s_add_u32 m0, s45, 0
  s_add_u32 s40, s31, 5505024
  buffer_load_dwordx4 v6, s[16:19], s40 offen lds
  s_add_u32 m0, s45, 896
  s_add_u32 s40, s31, 5562368
  buffer_load_dwordx4 v6, s[16:19], s40 offen lds
  s_mov_b64 exec, -1
  v_mfma_f32_16x16x32_bf16 v[28:31], a[32:35], a[0:3], v[28:31]
  ds_read_b64_tr_b16 a[64:65], v11 offset:14464
  v_mfma_f32_16x16x32_bf16 v[52:55], a[32:35], a[4:7], v[52:55]
  ds_read_b64_tr_b16 a[66:67], v11 offset:18048
  v_mfma_f32_16x16x32_bf16 v[76:79], a[32:35], a[8:11], v[76:79]
  ds_read_b64_tr_b16 a[80:81], v11 offset:21632
  v_mfma_f32_16x16x32_bf16 v[100:103], a[32:35], a[12:15], v[100:103]
  ds_read_b64_tr_b16 a[82:83], v11 offset:25216
  v_mfma_f32_16x16x32_bf16 v[20:23], a[20:23], a[0:3], v[20:23]
  ds_read_b64_tr_b16 a[68:69], v11 offset:14496
  v_mfma_f32_16x16x32_bf16 v[44:47], a[20:23], a[4:7], v[44:47]
  ds_read_b64_tr_b16 a[70:71], v11 offset:18080
  v_mfma_f32_16x16x32_bf16 v[68:71], a[20:23], a[8:11], v[68:71]
  ds_read_b64_tr_b16 a[84:85], v11 offset:21664
  v_mfma_f32_16x16x32_bf16 v[92:95], a[20:23], a[12:15], v[92:95]
  ds_read_b64_tr_b16 a[86:87], v11 offset:25248
  v_mfma_f32_16x16x32_bf16 v[32:35], a[36:39], a[0:3], v[32:35]
  ds_read_b64_tr_b16 a[72:73], v11 offset:14528
  s_add_u32 m0, s44, 512
  s_nop 0
  buffer_load_dwordx4 v4, s[12:15], s29 offen offset:1536 lds
  v_mfma_f32_16x16x32_bf16 v[56:59], a[36:39], a[4:7], v[56:59]
  ds_read_b64_tr_b16 a[74:75], v11 offset:18112
  v_mfma_f32_16x16x32_bf16 v[80:83], a[36:39], a[8:11], v[80:83]
  ds_read_b64_tr_b16 a[88:89], v11 offset:21696
  v_mfma_f32_16x16x32_bf16 v[104:107], a[36:39], a[12:15], v[104:107]
  ds_read_b64_tr_b16 a[90:91], v11 offset:25280
  v_mfma_f32_16x16x32_bf16 v[24:27], a[24:27], a[0:3], v[24:27]
  v_mfma_f32_16x16x32_bf16 v[48:51], a[24:27], a[4:7], v[48:51]
  v_mfma_f32_16x16x32_bf16 v[72:75], a[24:27], a[8:11], v[72:75]
  v_mfma_f32_16x16x32_bf16 v[96:99], a[24:27], a[12:15], v[96:99]
  v_mfma_f32_16x16x32_bf16 v[36:39], a[40:43], a[0:3], v[36:39]
  s_add_u32 m0, s44, 1536
  s_nop 0
  buffer_load_dwordx4 v5, s[12:15], s29 offen offset:1536 lds
  v_mfma_f32_16x16x32_bf16 v[60:63], a[40:43], a[4:7], v[60:63]
  v_mfma_f32_16x16x32_bf16 v[84:87], a[40:43], a[8:11], v[84:87]
  v_mfma_f32_16x16x32_bf16 v[108:111], a[40:43], a[12:15], v[108:111]
  s_waitcnt vmcnt(15) lgkmcnt(0)
  s_barrier
  v_mfma_f32_16x16x32_bf16 v[16:19], a[64:67], a[48:51], v[16:19]
  ds_read_b128 a[0:3], v9 offset:0
  v_mfma_f32_16x16x32_bf16 v[40:43], a[64:67], a[52:55], v[40:43]
  ds_read_b128 a[4:7], v9 offset:2048
  v_mfma_f32_16x16x32_bf16 v[64:67], a[64:67], a[56:59], v[64:67]
  ds_read_b128 a[8:11], v9 offset:4096
  v_mfma_f32_16x16x32_bf16 v[88:91], a[64:67], a[60:63], v[88:91]
  ds_read_b128 a[12:15], v9 offset:6144
  s_mov_b64 exec, s[36:37]
  s_add_u32 m0, s45, 14336
  s_add_u32 s40, s31, 5734400
  buffer_load_dwordx4 v6, s[16:19], s40 offen lds
  s_add_u32 m0, s45, 15232
  s_add_u32 s40, s31, 5791744
  buffer_load_dwordx4 v6, s[16:19], s40 offen lds
  s_mov_b64 exec, -1
  v_mfma_f32_16x16x32_bf16 v[28:31], a[80:83], a[48:51], v[28:31]
  ds_read_b64_tr_b16 a[16:17], v11 offset:28800
  v_mfma_f32_16x16x32_bf16 v[52:55], a[80:83], a[52:55], v[52:55]
  ds_read_b64_tr_b16 a[18:19], v11 offset:32384
  v_mfma_f32_16x16x32_bf16 v[76:79], a[80:83], a[56:59], v[76:79]
  ds_read_b64_tr_b16 a[32:33], v11 offset:35968
  v_mfma_f32_16x16x32_bf16 v[100:103], a[80:83], a[60:63], v[100:103]
  ds_read_b64_tr_b16 a[34:35], v11 offset:39552
  v_mfma_f32_16x16x32_bf16 v[20:23], a[68:71], a[48:51], v[20:23]
  ds_read_b64_tr_b16 a[20:21], v11 offset:28832
  v_mfma_f32_16x16x32_bf16 v[44:47], a[68:71], a[52:55], v[44:47]
  ds_read_b64_tr_b16 a[22:23], v11 offset:32416
  v_mfma_f32_16x16x32_bf16 v[68:71], a[68:71], a[56:59], v[68:71]
  ds_read_b64_tr_b16 a[36:37], v11 offset:36000
  v_mfma_f32_16x16x32_bf16 v[92:95], a[68:71], a[60:63], v[92:95]
  ds_read_b64_tr_b16 a[38:39], v11 offset:39584
  v_mfma_f32_16x16x32_bf16 v[32:35], a[84:87], a[48:51], v[32:35]
  ds_read_b64_tr_b16 a[24:25], v11 offset:28864
  s_add_u32 m0, s44, 31104
  s_nop 0
  buffer_load_dwordx4 v2, s[12:15], s29 offen offset:1664 lds
  v_mfma_f32_16x16x32_bf16 v[56:59], a[84:87], a[52:55], v[56:59]
  ds_read_b64_tr_b16 a[26:27], v11 offset:32448
  v_mfma_f32_16x16x32_bf16 v[80:83], a[84:87], a[56:59], v[80:83]
  ds_read_b64_tr_b16 a[40:41], v11 offset:36032
  v_mfma_f32_16x16x32_bf16 v[104:107], a[84:87], a[60:63], v[104:107]
  ds_read_b64_tr_b16 a[42:43], v11 offset:39616
  v_mfma_f32_16x16x32_bf16 v[24:27], a[72:75], a[48:51], v[24:27]
  v_mfma_f32_16x16x32_bf16 v[48:51], a[72:75], a[52:55], v[48:51]
  v_mfma_f32_16x16x32_bf16 v[72:75], a[72:75], a[56:59], v[72:75]
  v_mfma_f32_16x16x32_bf16 v[96:99], a[72:75], a[60:63], v[96:99]
  v_mfma_f32_16x16x32_bf16 v[36:39], a[88:91], a[48:51], v[36:39]
  s_add_u32 m0, s44, 32128
  s_nop 0
  buffer_load_dwordx4 v3, s[12:15], s29 offen offset:1664 lds
  v_mfma_f32_16x16x32_bf16 v[60:63], a[88:91], a[52:55], v[60:63]
  v_mfma_f32_16x16x32_bf16 v[84:87], a[88:91], a[56:59], v[84:87]
  v_mfma_f32_16x16x32_bf16 v[108:111], a[88:91], a[60:63], v[108:111]
  s_waitcnt vmcnt(10) lgkmcnt(0)
  s_barrier
  v_mfma_f32_16x16x32_bf16 v[16:19], a[16:19], a[0:3], v[16:19]
  ds_read_b128 a[48:51], v10 offset:0
  v_mfma_f32_16x16x32_bf16 v[40:43], a[16:19], a[4:7], v[40:43]
  ds_read_b128 a[52:55], v10 offset:2048
  v_mfma_f32_16x16x32_bf16 v[64:67], a[16:19], a[8:11], v[64:67]
  ds_read_b128 a[56:59], v10 offset:4096
  v_mfma_f32_16x16x32_bf16 v[88:91], a[16:19], a[12:15], v[88:91]
  ds_read_b128 a[60:63], v10 offset:6144
  s_mov_b64 exec, s[36:37]
  s_add_u32 m0, s45, 28672
  s_add_u32 s40, s31, 5963776
  buffer_load_dwordx4 v6, s[16:19], s40 offen lds
  s_add_u32 m0, s45, 29568
  s_add_u32 s40, s31, 6021120
  buffer_load_dwordx4 v6, s[16:19], s40 offen lds
  s_mov_b64 exec, -1
  v_mfma_f32_16x16x32_bf16 v[28:31], a[32:35], a[0:3], v[28:31]
  ds_read_b64_tr_b16 a[64:65], v11 offset:43136
  v_mfma_f32_16x16x32_bf16 v[52:55], a[32:35], a[4:7], v[52:55]
  ds_read_b64_tr_b16 a[66:67], v11 offset:46720
  v_mfma_f32_16x16x32_bf16 v[76:79], a[32:35], a[8:11], v[76:79]
  ds_read_b64_tr_b16 a[80:81], v11 offset:50304
  v_mfma_f32_16x16x32_bf16 v[100:103], a[32:35], a[12:15], v[100:103]
  ds_read_b64_tr_b16 a[82:83], v11 offset:53888
  v_mfma_f32_16x16x32_bf16 v[20:23], a[20:23], a[0:3], v[20:23]
  ds_read_b64_tr_b16 a[68:69], v11 offset:43168
  v_mfma_f32_16x16x32_bf16 v[44:47], a[20:23], a[4:7], v[44:47]
  ds_read_b64_tr_b16 a[70:71], v11 offset:46752
  v_mfma_f32_16x16x32_bf16 v[68:71], a[20:23], a[8:11], v[68:71]
  ds_read_b64_tr_b16 a[84:85], v11 offset:50336
  v_mfma_f32_16x16x32_bf16 v[92:95], a[20:23], a[12:15], v[92:95]
  ds_read_b64_tr_b16 a[86:87], v11 offset:53920
  v_mfma_f32_16x16x32_bf16 v[32:35], a[36:39], a[0:3], v[32:35]
  ds_read_b64_tr_b16 a[72:73], v11 offset:43200
  s_add_u32 m0, s44, 33152
  s_nop 0
  buffer_load_dwordx4 v4, s[12:15], s29 offen offset:1664 lds
  v_mfma_f32_16x16x32_bf16 v[56:59], a[36:39], a[4:7], v[56:59]
  ds_read_b64_tr_b16 a[74:75], v11 offset:46784
  v_mfma_f32_16x16x32_bf16 v[80:83], a[36:39], a[8:11], v[80:83]
  ds_read_b64_tr_b16 a[88:89], v11 offset:50368
  v_mfma_f32_16x16x32_bf16 v[104:107], a[36:39], a[12:15], v[104:107]
  ds_read_b64_tr_b16 a[90:91], v11 offset:53952
  v_mfma_f32_16x16x32_bf16 v[24:27], a[24:27], a[0:3], v[24:27]
  v_mfma_f32_16x16x32_bf16 v[48:51], a[24:27], a[4:7], v[48:51]
  v_mfma_f32_16x16x32_bf16 v[72:75], a[24:27], a[8:11], v[72:75]
  v_mfma_f32_16x16x32_bf16 v[96:99], a[24:27], a[12:15], v[96:99]
  v_mfma_f32_16x16x32_bf16 v[36:39], a[40:43], a[0:3], v[36:39]
  s_add_u32 m0, s44, 34176
  s_nop 0
  buffer_load_dwordx4 v5, s[12:15], s29 offen offset:1664 lds
  v_mfma_f32_16x16x32_bf16 v[60:63], a[40:43], a[4:7], v[60:63]
  v_mfma_f32_16x16x32_bf16 v[84:87], a[40:43], a[8:11], v[84:87]
  v_mfma_f32_16x16x32_bf16 v[108:111], a[40:43], a[12:15], v[108:111]
  s_waitcnt vmcnt(8) lgkmcnt(0)
  s_barrier
  v_mfma_f32_16x16x32_bf16 v[16:19], a[64:67], a[48:51], v[16:19]
  ds_read_b128 a[0:3], v7 offset:0
  v_mfma_f32_16x16x32_bf16 v[40:43], a[64:67], a[52:55], v[40:43]
  ds_read_b128 a[4:7], v7 offset:2048
  v_mfma_f32_16x16x32_bf16 v[64:67], a[64:67], a[56:59], v[64:67]
  ds_read_b128 a[8:11], v7 offset:4096
  v_mfma_f32_16x16x32_bf16 v[88:91], a[64:67], a[60:63], v[88:91]
  ds_read_b128 a[12:15], v7 offset:6144
  s_mov_b64 exec, s[36:37]
  s_add_u32 m0, s45, 43008
  s_add_u32 s40, s31, 6193152
  buffer_load_dwordx4 v6, s[16:19], s40 offen lds
  s_add_u32 m0, s45, 43904
  s_add_u32 s40, s31, 6250496
  buffer_load_dwordx4 v6, s[16:19], s40 offen lds
  s_mov_b64 exec, -1
  v_mfma_f32_16x16x32_bf16 v[28:31], a[80:83], a[48:51], v[28:31]
  ds_read_b64_tr_b16 a[16:17], v11 offset:128
  v_mfma_f32_16x16x32_bf16 v[52:55], a[80:83], a[52:55], v[52:55]
  ds_read_b64_tr_b16 a[18:19], v11 offset:3712
  v_mfma_f32_16x16x32_bf16 v[76:79], a[80:83], a[56:59], v[76:79]
  ds_read_b64_tr_b16 a[32:33], v11 offset:7296
  v_mfma_f32_16x16x32_bf16 v[100:103], a[80:83], a[60:63], v[100:103]
  ds_read_b64_tr_b16 a[34:35], v11 offset:10880
  v_mfma_f32_16x16x32_bf16 v[20:23], a[68:71], a[48:51], v[20:23]
  ds_read_b64_tr_b16 a[20:21], v11 offset:160
  v_mfma_f32_16x16x32_bf16 v[44:47], a[68:71], a[52:55], v[44:47]
  ds_read_b64_tr_b16 a[22:23], v11 offset:3744
  v_mfma_f32_16x16x32_bf16 v[68:71], a[68:71], a[56:59], v[68:71]
  ds_read_b64_tr_b16 a[36:37], v11 offset:7328
  v_mfma_f32_16x16x32_bf16 v[92:95], a[68:71], a[60:63], v[92:95]
  ds_read_b64_tr_b16 a[38:39], v11 offset:10912
  v_mfma_f32_16x16x32_bf16 v[32:35], a[84:87], a[48:51], v[32:35]
  ds_read_b64_tr_b16 a[24:25], v11 offset:192
  s_add_u32 m0, s44, 63744
  s_nop 0
  buffer_load_dwordx4 v2, s[12:15], s29 offen offset:1792 lds
  v_mfma_f32_16x16x32_bf16 v[56:59], a[84:87], a[52:55], v[56:59]
  ds_read_b64_tr_b16 a[26:27], v11 offset:3776
  v_mfma_f32_16x16x32_bf16 v[80:83], a[84:87], a[56:59], v[80:83]
  ds_read_b64_tr_b16 a[40:41], v11 offset:7360
  v_mfma_f32_16x16x32_bf16 v[104:107], a[84:87], a[60:63], v[104:107]
  ds_read_b64_tr_b16 a[42:43], v11 offset:10944
  v_mfma_f32_16x16x32_bf16 v[24:27], a[72:75], a[48:51], v[24:27]
  v_mfma_f32_16x16x32_bf16 v[48:51], a[72:75], a[52:55], v[48:51]
  v_mfma_f32_16x16x32_bf16 v[72:75], a[72:75], a[56:59], v[72:75]
  v_mfma_f32_16x16x32_bf16 v[96:99], a[72:75], a[60:63], v[96:99]
  v_mfma_f32_16x16x32_bf16 v[36:39], a[88:91], a[48:51], v[36:39]
  s_add_u32 m0, s44, 64768
  s_nop 0
  buffer_load_dwordx4 v3, s[12:15], s29 offen offset:1792 lds
  v_mfma_f32_16x16x32_bf16 v[60:63], a[88:91], a[52:55], v[60:63]
  v_mfma_f32_16x16x32_bf16 v[84:87], a[88:91], a[56:59], v[84:87]
  v_mfma_f32_16x16x32_bf16 v[108:111], a[88:91], a[60:63], v[108:111]
  s_waitcnt vmcnt(10) lgkmcnt(0)
  s_barrier
  v_mfma_f32_16x16x32_bf16 v[16:19], a[16:19], a[0:3], v[16:19]
  ds_read_b128 a[48:51], v8 offset:0
  v_mfma_f32_16x16x32_bf16 v[40:43], a[16:19], a[4:7], v[40:43]
  ds_read_b128 a[52:55], v8 offset:2048
  v_mfma_f32_16x16x32_bf16 v[64:67], a[16:19], a[8:11], v[64:67]
  ds_read_b128 a[56:59], v8 offset:4096
  v_mfma_f32_16x16x32_bf16 v[88:91], a[16:19], a[12:15], v[88:91]
  ds_read_b128 a[60:63], v8 offset:6144
  s_mov_b64 exec, s[36:37]
  s_add_u32 m0, s45, 0
  s_add_u32 s40, s31, 6422528
  buffer_load_dwordx4 v6, s[16:19], s40 offen lds
  s_add_u32 m0, s45, 896
  s_add_u32 s40, s31, 6479872
  buffer_load_dwordx4 v6, s[16:19], s40 offen lds
  s_mov_b64 exec, -1
  v_mfma_f32_16x16x32_bf16 v[28:31], a[32:35], a[0:3], v[28:31]
  ds_read_b64_tr_b16 a[64:65], v11 offset:14464
  v_mfma_f32_16x16x32_bf16 v[52:55], a[32:35], a[4:7], v[52:55]
  ds_read_b64_tr_b16 a[66:67], v11 offset:18048
  v_mfma_f32_16x16x32_bf16 v[76:79], a[32:35], a[8:11], v[76:79]
  ds_read_b64_tr_b16 a[80:81], v11 offset:21632
  v_mfma_f32_16x16x32_bf16 v[100:103], a[32:35], a[12:15], v[100:103]
  ds_read_b64_tr_b16 a[82:83], v11 offset:25216
  v_mfma_f32_16x16x32_bf16 v[20:23], a[20:23], a[0:3], v[20:23]
  ds_read_b64_tr_b16 a[68:69], v11 offset:14496
  v_mfma_f32_16x16x32_bf16 v[44:47], a[20:23], a[4:7], v[44:47]
  ds_read_b64_tr_b16 a[70:71], v11 offset:18080
  v_mfma_f32_16x16x32_bf16 v[68:71], a[20:23], a[8:11], v[68:71]
  ds_read_b64_tr_b16 a[84:85], v11 offset:21664
  v_mfma_f32_16x16x32_bf16 v[92:95], a[20:23], a[12:15], v[92:95]
  ds_read_b64_tr_b16 a[86:87], v11 offset:25248
  v_mfma_f32_16x16x32_bf16 v[32:35], a[36:39], a[0:3], v[32:35]
  ds_read_b64_tr_b16 a[72:73], v11 offset:14528
  s_add_u32 m0, s44, 65792
  s_nop 0
  buffer_load_dwordx4 v4, s[12:15], s29 offen offset:1792 lds
  v_mfma_f32_16x16x32_bf16 v[56:59], a[36:39], a[4:7], v[56:59]
  ds_read_b64_tr_b16 a[74:75], v11 offset:18112
  v_mfma_f32_16x16x32_bf16 v[80:83], a[36:39], a[8:11], v[80:83]
  ds_read_b64_tr_b16 a[88:89], v11 offset:21696
  v_mfma_f32_16x16x32_bf16 v[104:107], a[36:39], a[12:15], v[104:107]
  ds_read_b64_tr_b16 a[90:91], v11 offset:25280
  v_mfma_f32_16x16x32_bf16 v[24:27], a[24:27], a[0:3], v[24:27]
  v_mfma_f32_16x16x32_bf16 v[48:51], a[24:27], a[4:7], v[48:51]
  v_mfma_f32_16x16x32_bf16 v[72:75], a[24:27], a[8:11], v[72:75]
  v_mfma_f32_16x16x32_bf16 v[96:99], a[24:27], a[12:15], v[96:99]
  v_mfma_f32_16x16x32_bf16 v[36:39], a[40:43], a[0:3], v[36:39]
  s_add_u32 m0, s44, 66816
  s_nop 0
  buffer_load_dwordx4 v5, s[12:15], s29 offen offset:1792 lds
  s_waitcnt vmcnt(24)
  s_add_u32 s84, s20, 16777216
  s_addc_u32 s85, s21, 0
  s_mov_b32 s86, 7340032
  s_mov_b32 s87, 0x00020000
  v_lshrrev_b32 v12, 3, v1
  s_mov_b32 s40, 458752
  v_mul_lo_u32 v12, v12, s40
  v_and_b32 v13, 7, v1
  s_mul_i32 s41, s2, 14
  s_mul_i32 s63, s27, 7
  s_add_u32 s42, s63, 0
  s_and_b32 s62, s42, 1
  s_lshr_b32 s42, s42, 1
  s_add_u32 s43, s41, s42
  s_lshr_b32 s40, s43, 1
  s_and_b32 s40, s40, 3
  s_lshl_b32 s40, s40, 1
  v_xor_b32 v14, s40, v13
  v_lshl_add_u32 v0, v14, 4, v12
  s_lshl_b32 s43, s43, 7
  s_mul_i32 s62, s62, 3670016
  s_add_u32 s43, s43, s62
  buffer_store_dwordx4 v[112:115], v0, s[84:87], s43 offen
  s_add_u32 s42, s63, 1
  s_and_b32 s62, s42, 1
  s_lshr_b32 s42, s42, 1
  s_add_u32 s43, s41, s42
  s_lshr_b32 s40, s43, 1
  s_and_b32 s40, s40, 3
  s_lshl_b32 s40, s40, 1
  v_xor_b32 v14, s40, v13
  v_lshl_add_u32 v0, v14, 4, v12
  s_lshl_b32 s43, s43, 7
  s_mul_i32 s62, s62, 3670016
  s_add_u32 s43, s43, s62
  buffer_store_dwordx4 v[116:119], v0, s[84:87], s43 offen
  s_add_u32 s42, s63, 2
  s_and_b32 s62, s42, 1
  s_lshr_b32 s42, s42, 1
  s_add_u32 s43, s41, s42
  s_lshr_b32 s40, s43, 1
  s_and_b32 s40, s40, 3
  s_lshl_b32 s40, s40, 1
  v_xor_b32 v14, s40, v13
  v_lshl_add_u32 v0, v14, 4, v12
  s_lshl_b32 s43, s43, 7
  s_mul_i32 s62, s62, 3670016
  s_add_u32 s43, s43, s62
  buffer_store_dwordx4 v[120:123], v0, s[84:87], s43 offen
  s_add_u32 s42, s63, 3
  s_and_b32 s62, s42, 1
  s_lshr_b32 s42, s42, 1
  s_add_u32 s43, s41, s42
  s_lshr_b32 s40, s43, 1
  s_and_b32 s40, s40, 3
  s_lshl_b32 s40, s40, 1
  v_xor_b32 v14, s40, v13
  v_lshl_add_u32 v0, v14, 4, v12
  s_lshl_b32 s43, s43, 7
  s_mul_i32 s62, s62, 3670016
  s_add_u32 s43, s43, s62
  buffer_store_dwordx4 v[124:127], v0, s[84:87], s43 offen
  s_add_u32 s42, s63, 4
  s_and_b32 s62, s42, 1
  s_lshr_b32 s42, s42, 1
  s_add_u32 s43, s41, s42
  s_lshr_b32 s40, s43, 1
  s_and_b32 s40, s40, 3
  s_lshl_b32 s40, s40, 1
  v_xor_b32 v14, s40, v13
  v_lshl_add_u32 v0, v14, 4, v12
  s_lshl_b32 s43, s43, 7
  s_mul_i32 s62, s62, 3670016
  s_add_u32 s43, s43, s62
  buffer_store_dwordx4 v[128:131], v0, s[84:87], s43 offen
  s_add_u32 s42, s63, 5
  s_and_b32 s62, s42, 1
  s_lshr_b32 s42, s42, 1
  s_add_u32 s43, s41, s42
  s_lshr_b32 s40, s43, 1
  s_and_b32 s40, s40, 3
  s_lshl_b32 s40, s40, 1
  v_xor_b32 v14, s40, v13
  v_lshl_add_u32 v0, v14, 4, v12
  s_lshl_b32 s43, s43, 7
  s_mul_i32 s62, s62, 3670016
  s_add_u32 s43, s43, s62
  buffer_store_dwordx4 v[132:135], v0, s[84:87], s43 offen
  s_add_u32 s42, s63, 6
  s_and_b32 s62, s42, 1
  s_lshr_b32 s42, s42, 1
  s_add_u32 s43, s41, s42
  s_lshr_b32 s40, s43, 1
  s_and_b32 s40, s40, 3
  s_lshl_b32 s40, s40, 1
  v_xor_b32 v14, s40, v13
  v_lshl_add_u32 v0, v14, 4, v12
  s_lshl_b32 s43, s43, 7
  s_mul_i32 s62, s62, 3670016
  s_add_u32 s43, s43, s62
  buffer_store_dwordx4 v[136:139], v0, s[84:87], s43 offen
  v_mfma_f32_16x16x32_bf16 v[60:63], a[40:43], a[4:7], v[60:63]
  v_mfma_f32_16x16x32_bf16 v[84:87], a[40:43], a[8:11], v[84:87]
  v_mfma_f32_16x16x32_bf16 v[108:111], a[40:43], a[12:15], v[108:111]
  s_waitcnt vmcnt(15) lgkmcnt(0)
  s_barrier
  v_mfma_f32_16x16x32_bf16 v[16:19], a[64:67], a[48:51], v[16:19]
  ds_read_b128 a[0:3], v7 offset:32768
  v_mfma_f32_16x16x32_bf16 v[40:43], a[64:67], a[52:55], v[40:43]
  ds_read_b128 a[4:7], v7 offset:34816
  v_mfma_f32_16x16x32_bf16 v[64:67], a[64:67], a[56:59], v[64:67]
  ds_read_b128 a[8:11], v7 offset:36864
  v_mfma_f32_16x16x32_bf16 v[88:91], a[64:67], a[60:63], v[88:91]
  ds_read_b128 a[12:15], v7 offset:38912
  s_mov_b64 exec, s[36:37]
  s_add_u32 m0, s45, 14336
  s_add_u32 s40, s31, 6651904
  buffer_load_dwordx4 v6, s[16:19], s40 offen lds
  s_add_u32 m0, s45, 15232
  s_add_u32 s40, s31, 6709248
  buffer_load_dwordx4 v6, s[16:19], s40 offen lds
  s_mov_b64 exec, -1
  v_mfma_f32_16x16x32_bf16 v[28:31], a[80:83], a[48:51], v[28:31]
  ds_read_b64_tr_b16 a[16:17], v11 offset:28800
  v_mfma_f32_16x16x32_bf16 v[52:55], a[80:83], a[52:55], v[52:55]
  ds_read_b64_tr_b16 a[18:19], v11 offset:32384
  v_mfma_f32_16x16x32_bf16 v[76:79], a[80:83], a[56:59], v[76:79]
  ds_read_b64_tr_b16 a[32:33], v11 offset:35968
  v_mfma_f32_16x16x32_bf16 v[100:103], a[80:83], a[60:63], v[100:103]
  ds_read_b64_tr_b16 a[34:35], v11 offset:39552
  v_mfma_f32_16x16x32_bf16 v[20:23], a[68:71], a[48:51], v[20:23]
  ds_read_b64_tr_b16 a[20:21], v11 offset:28832
  v_mfma_f32_16x16x32_bf16 v[44:47], a[68:71], a[52:55], v[44:47]
  ds_read_b64_tr_b16 a[22:23], v11 offset:32416
  v_mfma_f32_16x16x32_bf16 v[68:71], a[68:71], a[56:59], v[68:71]
  ds_read_b64_tr_b16 a[36:37], v11 offset:36000
  v_mfma_f32_16x16x32_bf16 v[92:95], a[68:71], a[60:63], v[92:95]
  ds_read_b64_tr_b16 a[38:39], v11 offset:39584
  v_mfma_f32_16x16x32_bf16 v[32:35], a[84:87], a[48:51], v[32:35]
  ds_read_b64_tr_b16 a[24:25], v11 offset:28864
  s_add_u32 m0, s44, 4294965376
  s_nop 0
  buffer_load_dwordx4 v2, s[12:15], s29 offen offset:1920 lds
  v_mfma_f32_16x16x32_bf16 v[56:59], a[84:87], a[52:55], v[56:59]
  ds_read_b64_tr_b16 a[26:27], v11 offset:32448
  v_mfma_f32_16x16x32_bf16 v[80:83], a[84:87], a[56:59], v[80:83]
  ds_read_b64_tr_b16 a[40:41], v11 offset:36032
  v_mfma_f32_16x16x32_bf16 v[104:107], a[84:87], a[60:63], v[104:107]
  ds_read_b64_tr_b16 a[42:43], v11 offset:39616
  v_mfma_f32_16x16x32_bf16 v[24:27], a[72:75], a[48:51], v[24:27]
  v_mfma_f32_16x16x32_bf16 v[48:51], a[72:75], a[52:55], v[48:51]
  v_mfma_f32_16x16x32_bf16 v[72:75], a[72:75], a[56:59], v[72:75]
  v_mfma_f32_16x16x32_bf16 v[96:99], a[72:75], a[60:63], v[96:99]
  v_mfma_f32_16x16x32_bf16 v[36:39], a[88:91], a[48:51], v[36:39]
  s_add_u32 m0, s44, 4294966400
  s_nop 0
  buffer_load_dwordx4 v3, s[12:15], s29 offen offset:1920 lds
  v_mfma_f32_16x16x32_bf16 v[60:63], a[88:91], a[52:55], v[60:63]
  v_mfma_f32_16x16x32_bf16 v[84:87], a[88:91], a[56:59], v[84:87]
  v_mfma_f32_16x16x32_bf16 v[108:111], a[88:91], a[60:63], v[108:111]
  s_waitcnt vmcnt(17) lgkmcnt(0)
  s_barrier
  v_mfma_f32_16x16x32_bf16 v[16:19], a[16:19], a[0:3], v[16:19]
  ds_read_b128 a[48:51], v8 offset:32768
  v_mfma_f32_16x16x32_bf16 v[40:43], a[16:19], a[4:7], v[40:43]
  ds_read_b128 a[52:55], v8 offset:34816
  v_mfma_f32_16x16x32_bf16 v[64:67], a[16:19], a[8:11], v[64:67]
  ds_read_b128 a[56:59], v8 offset:36864
  v_mfma_f32_16x16x32_bf16 v[88:91], a[16:19], a[12:15], v[88:91]
  ds_read_b128 a[60:63], v8 offset:38912
  s_mov_b64 exec, s[36:37]
  s_add_u32 m0, s45, 28672
  s_add_u32 s40, s31, 6881280
  buffer_load_dwordx4 v6, s[16:19], s40 offen lds
  s_add_u32 m0, s45, 29568
  s_add_u32 s40, s31, 6938624
  buffer_load_dwordx4 v6, s[16:19], s40 offen lds
  s_mov_b64 exec, -1
  v_mfma_f32_16x16x32_bf16 v[28:31], a[32:35], a[0:3], v[28:31]
  ds_read_b64_tr_b16 a[64:65], v11 offset:43136
  v_mfma_f32_16x16x32_bf16 v[52:55], a[32:35], a[4:7], v[52:55]
  ds_read_b64_tr_b16 a[66:67], v11 offset:46720
  v_mfma_f32_16x16x32_bf16 v[76:79], a[32:35], a[8:11], v[76:79]
  ds_read_b64_tr_b16 a[80:81], v11 offset:50304
  v_mfma_f32_16x16x32_bf16 v[100:103], a[32:35], a[12:15], v[100:103]
  ds_read_b64_tr_b16 a[82:83], v11 offset:53888
  v_mfma_f32_16x16x32_bf16 v[20:23], a[20:23], a[0:3], v[20:23]
  ds_read_b64_tr_b16 a[68:69], v11 offset:43168
  v_mfma_f32_16x16x32_bf16 v[44:47], a[20:23], a[4:7], v[44:47]
  ds_read_b64_tr_b16 a[70:71], v11 offset:46752
  v_mfma_f32_16x16x32_bf16 v[68:71], a[20:23], a[8:11], v[68:71]
  ds_read_b64_tr_b16 a[84:85], v11 offset:50336
  v_mfma_f32_16x16x32_bf16 v[92:95], a[20:23], a[12:15], v[92:95]
  ds_read_b64_tr_b16 a[86:87], v11 offset:53920
  v_mfma_f32_16x16x32_bf16 v[32:35], a[36:39], a[0:3], v[32:35]
  ds_read_b64_tr_b16 a[72:73], v11 offset:43200
  s_add_u32 m0, s44, 128
  s_nop 0
  buffer_load_dwordx4 v4, s[12:15], s29 offen offset:1920 lds
  v_mfma_f32_16x16x32_bf16 v[56:59], a[36:39], a[4:7], v[56:59]
  ds_read_b64_tr_b16 a[74:75], v11 offset:46784
  v_mfma_f32_16x16x32_bf16 v[80:83], a[36:39], a[8:11], v[80:83]
  ds_read_b64_tr_b16 a[88:89], v11 offset:50368
  v_mfma_f32_16x16x32_bf16 v[104:107], a[36:39], a[12:15], v[104:107]
  ds_read_b64_tr_b16 a[90:91], v11 offset:53952
  v_mfma_f32_16x16x32_bf16 v[24:27], a[24:27], a[0:3], v[24:27]
  v_mfma_f32_16x16x32_bf16 v[48:51], a[24:27], a[4:7], v[48:51]
  v_mfma_f32_16x16x32_bf16 v[72:75], a[24:27], a[8:11], v[72:75]
  v_mfma_f32_16x16x32_bf16 v[96:99], a[24:27], a[12:15], v[96:99]
  v_mfma_f32_16x16x32_bf16 v[36:39], a[40:43], a[0:3], v[36:39]
  s_add_u32 m0, s44, 1152
  s_nop 0
  buffer_load_dwordx4 v5, s[12:15], s29 offen offset:1920 lds
  v_mfma_f32_16x16x32_bf16 v[60:63], a[40:43], a[4:7], v[60:63]
  v_mfma_f32_16x16x32_bf16 v[84:87], a[40:43], a[8:11], v[84:87]
  v_mfma_f32_16x16x32_bf16 v[108:111], a[40:43], a[12:15], v[108:111]
  s_waitcnt vmcnt(15) lgkmcnt(0)
  s_barrier
  v_mfma_f32_16x16x32_bf16 v[16:19], a[64:67], a[48:51], v[16:19]
  ds_read_b128 a[0:3], v9 offset:0
  v_mfma_f32_16x16x32_bf16 v[40:43], a[64:67], a[52:55], v[40:43]
  ds_read_b128 a[4:7], v9 offset:2048
  v_mfma_f32_16x16x32_bf16 v[64:67], a[64:67], a[56:59], v[64:67]
  ds_read_b128 a[8:11], v9 offset:4096
  v_mfma_f32_16x16x32_bf16 v[88:91], a[64:67], a[60:63], v[88:91]
  ds_read_b128 a[12:15], v9 offset:6144
  s_mov_b64 exec, s[36:37]
  s_add_u32 m0, s45, 43008
  s_add_u32 s40, s31, 7110656
  buffer_load_dwordx4 v6, s[16:19], s40 offen lds
  s_add_u32 m0, s45, 43904
  s_add_u32 s40, s31, 7168000
  buffer_load_dwordx4 v6, s[16:19], s40 offen lds
  s_mov_b64 exec, -1
  v_mfma_f32_16x16x32_bf16 v[28:31], a[80:83], a[48:51], v[28:31]
  ds_read_b64_tr_b16 a[16:17], v11 offset:128
  v_mfma_f32_16x16x32_bf16 v[52:55], a[80:83], a[52:55], v[52:55]
  ds_read_b64_tr_b16 a[18:19], v11 offset:3712
  v_mfma_f32_16x16x32_bf16 v[76:79], a[80:83], a[56:59], v[76:79]
  ds_read_b64_tr_b16 a[32:33], v11 offset:7296
  v_mfma_f32_16x16x32_bf16 v[100:103], a[80:83], a[60:63], v[100:103]
  ds_read_b64_tr_b16 a[34:35], v11 offset:10880
  v_mfma_f32_16x16x32_bf16 v[20:23], a[68:71], a[48:51], v[20:23]
  ds_read_b64_tr_b16 a[20:21], v11 offset:160
  v_mfma_f32_16x16x32_bf16 v[44:47], a[68:71], a[52:55], v[44:47]
  ds_read_b64_tr_b16 a[22:23], v11 offset:3744
  v_mfma_f32_16x16x32_bf16 v[68:71], a[68:71], a[56:59], v[68:71]
  ds_read_b64_tr_b16 a[36:37], v11 offset:7328
  v_mfma_f32_16x16x32_bf16 v[92:95], a[68:71], a[60:63], v[92:95]
  ds_read_b64_tr_b16 a[38:39], v11 offset:10912
  v_mfma_f32_16x16x32_bf16 v[32:35], a[84:87], a[48:51], v[32:35]
  ds_read_b64_tr_b16 a[24:25], v11 offset:192
  v_mfma_f32_16x16x32_bf16 v[56:59], a[84:87], a[52:55], v[56:59]
  ds_read_b64_tr_b16 a[26:27], v11 offset:3776
  v_mfma_f32_16x16x32_bf16 v[80:83], a[84:87], a[56:59], v[80:83]
  ds_read_b64_tr_b16 a[40:41], v11 offset:7360
  v_mfma_f32_16x16x32_bf16 v[104:107], a[84:87], a[60:63], v[104:107]
  ds_read_b64_tr_b16 a[42:43], v11 offset:10944
  v_mfma_f32_16x16x32_bf16 v[24:27], a[72:75], a[48:51], v[24:27]
  v_mfma_f32_16x16x32_bf16 v[48:51], a[72:75], a[52:55], v[48:51]
  v_mfma_f32_16x16x32_bf16 v[72:75], a[72:75], a[56:59], v[72:75]
  v_mfma_f32_16x16x32_bf16 v[96:99], a[72:75], a[60:63], v[96:99]
  v_mfma_f32_16x16x32_bf16 v[36:39], a[88:91], a[48:51], v[36:39]
  v_mfma_f32_16x16x32_bf16 v[60:63], a[88:91], a[52:55], v[60:63]
  v_mfma_f32_16x16x32_bf16 v[84:87], a[88:91], a[56:59], v[84:87]
  v_mfma_f32_16x16x32_bf16 v[108:111], a[88:91], a[60:63], v[108:111]
  s_waitcnt vmcnt(8) lgkmcnt(0)
  s_barrier
  v_mfma_f32_16x16x32_bf16 v[16:19], a[16:19], a[0:3], v[16:19]
  ds_read_b128 a[48:51], v10 offset:0
  v_mfma_f32_16x16x32_bf16 v[40:43], a[16:19], a[4:7], v[40:43]
  ds_read_b128 a[52:55], v10 offset:2048
  v_mfma_f32_16x16x32_bf16 v[64:67], a[16:19], a[8:11], v[64:67]
  ds_read_b128 a[56:59], v10 offset:4096
  v_mfma_f32_16x16x32_bf16 v[88:91], a[16:19], a[12:15], v[88:91]
  ds_read_b128 a[60:63], v10 offset:6144
  v_mfma_f32_16x16x32_bf16 v[28:31], a[32:35], a[0:3], v[28:31]
  ds_read_b64_tr_b16 a[64:65], v11 offset:14464
  v_mfma_f32_16x16x32_bf16 v[52:55], a[32:35], a[4:7], v[52:55]
  ds_read_b64_tr_b16 a[66:67], v11 offset:18048
  v_mfma_f32_16x16x32_bf16 v[76:79], a[32:35], a[8:11], v[76:79]
  ds_read_b64_tr_b16 a[80:81], v11 offset:21632
  v_mfma_f32_16x16x32_bf16 v[100:103], a[32:35], a[12:15], v[100:103]
  ds_read_b64_tr_b16 a[82:83], v11 offset:25216
  v_mfma_f32_16x16x32_bf16 v[20:23], a[20:23], a[0:3], v[20:23]
  ds_read_b64_tr_b16 a[68:69], v11 offset:14496
  v_mfma_f32_16x16x32_bf16 v[44:47], a[20:23], a[4:7], v[44:47]
  ds_read_b64_tr_b16 a[70:71], v11 offset:18080
  v_mfma_f32_16x16x32_bf16 v[68:71], a[20:23], a[8:11], v[68:71]
  ds_read_b64_tr_b16 a[84:85], v11 offset:21664
  v_mfma_f32_16x16x32_bf16 v[92:95], a[20:23], a[12:15], v[92:95]
  ds_read_b64_tr_b16 a[86:87], v11 offset:25248
  v_mfma_f32_16x16x32_bf16 v[32:35], a[36:39], a[0:3], v[32:35]
  ds_read_b64_tr_b16 a[72:73], v11 offset:14528
  v_mfma_f32_16x16x32_bf16 v[56:59], a[36:39], a[4:7], v[56:59]
  ds_read_b64_tr_b16 a[74:75], v11 offset:18112
  v_mfma_f32_16x16x32_bf16 v[80:83], a[36:39], a[8:11], v[80:83]
  ds_read_b64_tr_b16 a[88:89], v11 offset:21696
  v_mfma_f32_16x16x32_bf16 v[104:107], a[36:39], a[12:15], v[104:107]
  ds_read_b64_tr_b16 a[90:91], v11 offset:25280
  v_mfma_f32_16x16x32_bf16 v[24:27], a[24:27], a[0:3], v[24:27]
  v_mfma_f32_16x16x32_bf16 v[48:51], a[24:27], a[4:7], v[48:51]
  v_mfma_f32_16x16x32_bf16 v[72:75], a[24:27], a[8:11], v[72:75]
  v_mfma_f32_16x16x32_bf16 v[96:99], a[24:27], a[12:15], v[96:99]
  v_mfma_f32_16x16x32_bf16 v[36:39], a[40:43], a[0:3], v[36:39]
  v_mfma_f32_16x16x32_bf16 v[60:63], a[40:43], a[4:7], v[60:63]
  v_mfma_f32_16x16x32_bf16 v[84:87], a[40:43], a[8:11], v[84:87]
  v_mfma_f32_16x16x32_bf16 v[108:111], a[40:43], a[12:15], v[108:111]
  s_waitcnt vmcnt(2) lgkmcnt(0)
  s_barrier
  v_mfma_f32_16x16x32_bf16 v[16:19], a[64:67], a[48:51], v[16:19]
  ds_read_b128 a[0:3], v7 offset:0
  v_mfma_f32_16x16x32_bf16 v[40:43], a[64:67], a[52:55], v[40:43]
  ds_read_b128 a[4:7], v7 offset:2048
  v_mfma_f32_16x16x32_bf16 v[64:67], a[64:67], a[56:59], v[64:67]
  ds_read_b128 a[8:11], v7 offset:4096
  v_mfma_f32_16x16x32_bf16 v[88:91], a[64:67], a[60:63], v[88:91]
  ds_read_b128 a[12:15], v7 offset:6144
  v_mfma_f32_16x16x32_bf16 v[28:31], a[80:83], a[48:51], v[28:31]
  ds_read_b64_tr_b16 a[16:17], v11 offset:28800
  v_mfma_f32_16x16x32_bf16 v[52:55], a[80:83], a[52:55], v[52:55]
  ds_read_b64_tr_b16 a[18:19], v11 offset:32384
  v_mfma_f32_16x16x32_bf16 v[76:79], a[80:83], a[56:59], v[76:79]
  ds_read_b64_tr_b16 a[32:33], v11 offset:35968
  v_mfma_f32_16x16x32_bf16 v[100:103], a[80:83], a[60:63], v[100:103]
  ds_read_b64_tr_b16 a[34:35], v11 offset:39552
  v_mfma_f32_16x16x32_bf16 v[20:23], a[68:71], a[48:51], v[20:23]
  ds_read_b64_tr_b16 a[20:21], v11 offset:28832
  v_mfma_f32_16x16x32_bf16 v[44:47], a[68:71], a[52:55], v[44:47]
  ds_read_b64_tr_b16 a[22:23], v11 offset:32416
  v_mfma_f32_16x16x32_bf16 v[68:71], a[68:71], a[56:59], v[68:71]
  ds_read_b64_tr_b16 a[36:37], v11 offset:36000
  v_mfma_f32_16x16x32_bf16 v[92:95], a[68:71], a[60:63], v[92:95]
  ds_read_b64_tr_b16 a[38:39], v11 offset:39584
  v_mfma_f32_16x16x32_bf16 v[32:35], a[84:87], a[48:51], v[32:35]
  ds_read_b64_tr_b16 a[24:25], v11 offset:28864
  v_mfma_f32_16x16x32_bf16 v[56:59], a[84:87], a[52:55], v[56:59]
  ds_read_b64_tr_b16 a[26:27], v11 offset:32448
  v_mfma_f32_16x16x32_bf16 v[80:83], a[84:87], a[56:59], v[80:83]
  ds_read_b64_tr_b16 a[40:41], v11 offset:36032
  v_mfma_f32_16x16x32_bf16 v[104:107], a[84:87], a[60:63], v[104:107]
  ds_read_b64_tr_b16 a[42:43], v11 offset:39616
  v_mfma_f32_16x16x32_bf16 v[24:27], a[72:75], a[48:51], v[24:27]
  v_mfma_f32_16x16x32_bf16 v[48:51], a[72:75], a[52:55], v[48:51]
  v_mfma_f32_16x16x32_bf16 v[72:75], a[72:75], a[56:59], v[72:75]
  v_mfma_f32_16x16x32_bf16 v[96:99], a[72:75], a[60:63], v[96:99]
  v_mfma_f32_16x16x32_bf16 v[36:39], a[88:91], a[48:51], v[36:39]
  v_mfma_f32_16x16x32_bf16 v[60:63], a[88:91], a[52:55], v[60:63]
  v_mfma_f32_16x16x32_bf16 v[84:87], a[88:91], a[56:59], v[84:87]
  v_mfma_f32_16x16x32_bf16 v[108:111], a[88:91], a[60:63], v[108:111]
  s_waitcnt vmcnt(0) lgkmcnt(0)
  s_barrier
  v_mfma_f32_16x16x32_bf16 v[16:19], a[16:19], a[0:3], v[16:19]
  ds_read_b128 a[48:51], v8 offset:0
  v_mfma_f32_16x16x32_bf16 v[40:43], a[16:19], a[4:7], v[40:43]
  ds_read_b128 a[52:55], v8 offset:2048
  v_mfma_f32_16x16x32_bf16 v[64:67], a[16:19], a[8:11], v[64:67]
  ds_read_b128 a[56:59], v8 offset:4096
  v_mfma_f32_16x16x32_bf16 v[88:91], a[16:19], a[12:15], v[88:91]
  ds_read_b128 a[60:63], v8 offset:6144
  v_mfma_f32_16x16x32_bf16 v[28:31], a[32:35], a[0:3], v[28:31]
  ds_read_b64_tr_b16 a[64:65], v11 offset:43136
  v_mfma_f32_16x16x32_bf16 v[52:55], a[32:35], a[4:7], v[52:55]
  ds_read_b64_tr_b16 a[66:67], v11 offset:46720
  v_mfma_f32_16x16x32_bf16 v[76:79], a[32:35], a[8:11], v[76:79]
  ds_read_b64_tr_b16 a[80:81], v11 offset:50304
  v_mfma_f32_16x16x32_bf16 v[100:103], a[32:35], a[12:15], v[100:103]
  ds_read_b64_tr_b16 a[82:83], v11 offset:53888
  v_mfma_f32_16x16x32_bf16 v[20:23], a[20:23], a[0:3], v[20:23]
  ds_read_b64_tr_b16 a[68:69], v11 offset:43168
  v_mfma_f32_16x16x32_bf16 v[44:47], a[20:23], a[4:7], v[44:47]
  ds_read_b64_tr_b16 a[70:71], v11 offset:46752
  v_mfma_f32_16x16x32_bf16 v[68:71], a[20:23], a[8:11], v[68:71]
  ds_read_b64_tr_b16 a[84:85], v11 offset:50336
  v_mfma_f32_16x16x32_bf16 v[92:95], a[20:23], a[12:15], v[92:95]
  ds_read_b64_tr_b16 a[86:87], v11 offset:53920
  v_mfma_f32_16x16x32_bf16 v[32:35], a[36:39], a[0:3], v[32:35]
  ds_read_b64_tr_b16 a[72:73], v11 offset:43200
  v_mfma_f32_16x16x32_bf16 v[56:59], a[36:39], a[4:7], v[56:59]
  ds_read_b64_tr_b16 a[74:75], v11 offset:46784
  v_mfma_f32_16x16x32_bf16 v[80:83], a[36:39], a[8:11], v[80:83]
  ds_read_b64_tr_b16 a[88:89], v11 offset:50368
  v_mfma_f32_16x16x32_bf16 v[104:107], a[36:39], a[12:15], v[104:107]
  ds_read_b64_tr_b16 a[90:91], v11 offset:53952
  v_mfma_f32_16x16x32_bf16 v[24:27], a[24:27], a[0:3], v[24:27]
  v_mfma_f32_16x16x32_bf16 v[48:51], a[24:27], a[4:7], v[48:51]
  v_mfma_f32_16x16x32_bf16 v[72:75], a[24:27], a[8:11], v[72:75]
  v_mfma_f32_16x16x32_bf16 v[96:99], a[24:27], a[12:15], v[96:99]
  v_mfma_f32_16x16x32_bf16 v[36:39], a[40:43], a[0:3], v[36:39]
  v_mfma_f32_16x16x32_bf16 v[60:63], a[40:43], a[4:7], v[60:63]
  v_mfma_f32_16x16x32_bf16 v[84:87], a[40:43], a[8:11], v[84:87]
  v_mfma_f32_16x16x32_bf16 v[108:111], a[40:43], a[12:15], v[108:111]
  s_waitcnt lgkmcnt(0)
  v_mfma_f32_16x16x32_bf16 v[16:19], a[64:67], a[48:51], v[16:19]
  v_mfma_f32_16x16x32_bf16 v[40:43], a[64:67], a[52:55], v[40:43]
  v_mfma_f32_16x16x32_bf16 v[64:67], a[64:67], a[56:59], v[64:67]
  v_mfma_f32_16x16x32_bf16 v[88:91], a[64:67], a[60:63], v[88:91]
  v_mfma_f32_16x16x32_bf16 v[28:31], a[80:83], a[48:51], v[28:31]
  v_mfma_f32_16x16x32_bf16 v[52:55], a[80:83], a[52:55], v[52:55]
  v_mfma_f32_16x16x32_bf16 v[76:79], a[80:83], a[56:59], v[76:79]
  v_mfma_f32_16x16x32_bf16 v[100:103], a[80:83], a[60:63], v[100:103]
  v_mfma_f32_16x16x32_bf16 v[20:23], a[68:71], a[48:51], v[20:23]
  v_mfma_f32_16x16x32_bf16 v[44:47], a[68:71], a[52:55], v[44:47]
  v_mfma_f32_16x16x32_bf16 v[68:71], a[68:71], a[56:59], v[68:71]
  v_mfma_f32_16x16x32_bf16 v[92:95], a[68:71], a[60:63], v[92:95]
  v_mfma_f32_16x16x32_bf16 v[32:35], a[84:87], a[48:51], v[32:35]
  v_mfma_f32_16x16x32_bf16 v[56:59], a[84:87], a[52:55], v[56:59]
  v_mfma_f32_16x16x32_bf16 v[80:83], a[84:87], a[56:59], v[80:83]
  v_mfma_f32_16x16x32_bf16 v[104:107], a[84:87], a[60:63], v[104:107]
  v_mfma_f32_16x16x32_bf16 v[24:27], a[72:75], a[48:51], v[24:27]
  v_mfma_f32_16x16x32_bf16 v[48:51], a[72:75], a[52:55], v[48:51]
  v_mfma_f32_16x16x32_bf16 v[72:75], a[72:75], a[56:59], v[72:75]
  v_mfma_f32_16x16x32_bf16 v[96:99], a[72:75], a[60:63], v[96:99]
  v_mfma_f32_16x16x32_bf16 v[36:39], a[88:91], a[48:51], v[36:39]
  v_mfma_f32_16x16x32_bf16 v[60:63], a[88:91], a[52:55], v[60:63]
  v_mfma_f32_16x16x32_bf16 v[84:87], a[88:91], a[56:59], v[84:87]
  v_mfma_f32_16x16x32_bf16 v[108:111], a[88:91], a[60:63], v[108:111]
  v_mov_b32 v144, 0xbdd2d3e8
  v_mov_b32 v145, 0xbdd2d3e8
  v_mov_b32 v146, 0xc0135761
  v_mov_b32 v147, 0xc0135761
  v_mov_b32 v148, 1.0
  v_mov_b32 v149, 1.0
  v_lshlrev_b32 v12, 4, v1
  s_lshl_b32 s40, s24, 4
  s_lshl_b32 s41, s27, 2
  s_add_u32 s40, s40, s41
  s_mul_i32 s40, s40, 114688
  s_mul_i32 s41, s25, 7
  s_lshr_b32 s42, s41, 1
  s_lshl_b32 s42, s42, 10
  s_add_u32 s52, s40, s42
  s_add_u32 s53, s52, 114688
  s_add_u32 s54, s53, 114688
  s_add_u32 s55, s54, 114688
  s_and_b32 s56, s25, 1
  s_nop 7
  v_pk_mul_f32 v[152:153], v[16:17], v[16:17]
  v_pk_mul_f32 v[154:155], v[18:19], v[18:19]
  v_pk_mul_f32 v[156:157], v[40:41], v[40:41]
  v_pk_mul_f32 v[158:159], v[42:43], v[42:43]
  v_pk_fma_f32 v[152:153], v[152:153], v[144:145], v[146:147]
  v_pk_fma_f32 v[154:155], v[154:155], v[144:145], v[146:147]
  v_pk_fma_f32 v[156:157], v[156:157], v[144:145], v[146:147]
  v_pk_fma_f32 v[158:159], v[158:159], v[144:145], v[146:147]
  v_pk_mul_f32 v[152:153], v[152:153], v[16:17]
  v_pk_mul_f32 v[154:155], v[154:155], v[18:19]
  v_pk_mul_f32 v[156:157], v[156:157], v[40:41]
  v_pk_mul_f32 v[158:159], v[158:159], v[42:43]
  v_exp_f32 v152, v152
  v_exp_f32 v153, v153
  v_exp_f32 v154, v154
  v_exp_f32 v155, v155
  v_exp_f32 v156, v156
  v_exp_f32 v157, v157
  v_exp_f32 v158, v158
  v_exp_f32 v159, v159
  v_pk_mul_f32 v[28:29], v[16:17], v[28:29]
  v_pk_mul_f32 v[30:31], v[18:19], v[30:31]
  v_pk_mul_f32 v[52:53], v[40:41], v[52:53]
  v_pk_mul_f32 v[54:55], v[42:43], v[54:55]
  v_pk_add_f32 v[152:153], v[152:153], v[148:149]
  v_pk_add_f32 v[154:155], v[154:155], v[148:149]
  v_pk_add_f32 v[156:157], v[156:157], v[148:149]
  v_pk_add_f32 v[158:159], v[158:159], v[148:149]
  v_rcp_f32 v152, v152
  v_rcp_f32 v153, v153
  v_rcp_f32 v154, v154
  v_rcp_f32 v155, v155
  v_rcp_f32 v156, v156
  v_rcp_f32 v157, v157
  v_rcp_f32 v158, v158
  v_rcp_f32 v159, v159
  s_nop 0
  v_pk_mul_f32 v[152:153], v[152:153], v[28:29]
  v_pk_mul_f32 v[154:155], v[154:155], v[30:31]
  v_pk_mul_f32 v[156:157], v[156:157], v[52:53]
  v_pk_mul_f32 v[158:159], v[158:159], v[54:55]
  v_cvt_pk_bf16_f32 v16, v152, v153
  v_cvt_pk_bf16_f32 v17, v154, v155
  v_cvt_pk_bf16_f32 v40, v156, v157
  v_cvt_pk_bf16_f32 v41, v158, v159
  v_pk_mul_f32 v[152:153], v[64:65], v[64:65]
  v_pk_mul_f32 v[154:155], v[66:67], v[66:67]
  v_pk_mul_f32 v[156:157], v[88:89], v[88:89]
  v_pk_mul_f32 v[158:159], v[90:91], v[90:91]
  v_pk_fma_f32 v[152:153], v[152:153], v[144:145], v[146:147]
  v_pk_fma_f32 v[154:155], v[154:155], v[144:145], v[146:147]
  v_pk_fma_f32 v[156:157], v[156:157], v[144:145], v[146:147]
  v_pk_fma_f32 v[158:159], v[158:159], v[144:145], v[146:147]
  v_pk_mul_f32 v[152:153], v[152:153], v[64:65]
  v_pk_mul_f32 v[154:155], v[154:155], v[66:67]
  v_pk_mul_f32 v[156:157], v[156:157], v[88:89]
  v_pk_mul_f32 v[158:159], v[158:159], v[90:91]
  v_exp_f32 v152, v152
  v_exp_f32 v153, v153
  v_exp_f32 v154, v154
  v_exp_f32 v155, v155
  v_exp_f32 v156, v156
  v_exp_f32 v157, v157
  v_exp_f32 v158, v158
  v_exp_f32 v159, v159
  v_pk_mul_f32 v[76:77], v[64:65], v[76:77]
  v_pk_mul_f32 v[78:79], v[66:67], v[78:79]
  v_pk_mul_f32 v[100:101], v[88:89], v[100:101]
  v_pk_mul_f32 v[102:103], v[90:91], v[102:103]
  v_pk_add_f32 v[152:153], v[152:153], v[148:149]
  v_pk_add_f32 v[154:155], v[154:155], v[148:149]
  v_pk_add_f32 v[156:157], v[156:157], v[148:149]
  v_pk_add_f32 v[158:159], v[158:159], v[148:149]
  v_rcp_f32 v152, v152
  v_rcp_f32 v153, v153
  v_rcp_f32 v154, v154
  v_rcp_f32 v155, v155
  v_rcp_f32 v156, v156
  v_rcp_f32 v157, v157
  v_rcp_f32 v158, v158
  v_rcp_f32 v159, v159
  s_nop 0
  v_pk_mul_f32 v[152:153], v[152:153], v[76:77]
  v_pk_mul_f32 v[154:155], v[154:155], v[78:79]
  v_pk_mul_f32 v[156:157], v[156:157], v[100:101]
  v_pk_mul_f32 v[158:159], v[158:159], v[102:103]
  v_cvt_pk_bf16_f32 v64, v152, v153
  v_cvt_pk_bf16_f32 v65, v154, v155
  v_cvt_pk_bf16_f32 v88, v156, v157
  v_cvt_pk_bf16_f32 v89, v158, v159
  v_pk_mul_f32 v[152:153], v[20:21], v[20:21]
  v_pk_mul_f32 v[154:155], v[22:23], v[22:23]
  v_pk_mul_f32 v[156:157], v[44:45], v[44:45]
  v_pk_mul_f32 v[158:159], v[46:47], v[46:47]
  v_pk_fma_f32 v[152:153], v[152:153], v[144:145], v[146:147]
  v_pk_fma_f32 v[154:155], v[154:155], v[144:145], v[146:147]
  v_pk_fma_f32 v[156:157], v[156:157], v[144:145], v[146:147]
  v_pk_fma_f32 v[158:159], v[158:159], v[144:145], v[146:147]
  v_pk_mul_f32 v[152:153], v[152:153], v[20:21]
  v_pk_mul_f32 v[154:155], v[154:155], v[22:23]
  v_pk_mul_f32 v[156:157], v[156:157], v[44:45]
  v_pk_mul_f32 v[158:159], v[158:159], v[46:47]
  v_exp_f32 v152, v152
  v_exp_f32 v153, v153
  v_exp_f32 v154, v154
  v_exp_f32 v155, v155
  v_exp_f32 v156, v156
  v_exp_f32 v157, v157
  v_exp_f32 v158, v158
  v_exp_f32 v159, v159
  v_pk_mul_f32 v[32:33], v[20:21], v[32:33]
  v_pk_mul_f32 v[34:35], v[22:23], v[34:35]
  v_pk_mul_f32 v[56:57], v[44:45], v[56:57]
  v_pk_mul_f32 v[58:59], v[46:47], v[58:59]
  v_pk_add_f32 v[152:153], v[152:153], v[148:149]
  v_pk_add_f32 v[154:155], v[154:155], v[148:149]
  v_pk_add_f32 v[156:157], v[156:157], v[148:149]
  v_pk_add_f32 v[158:159], v[158:159], v[148:149]
  v_rcp_f32 v152, v152
  v_rcp_f32 v153, v153
  v_rcp_f32 v154, v154
  v_rcp_f32 v155, v155
  v_rcp_f32 v156, v156
  v_rcp_f32 v157, v157
  v_rcp_f32 v158, v158
  v_rcp_f32 v159, v159
  s_nop 0
  v_pk_mul_f32 v[152:153], v[152:153], v[32:33]
  v_pk_mul_f32 v[154:155], v[154:155], v[34:35]
  v_pk_mul_f32 v[156:157], v[156:157], v[56:57]
  v_pk_mul_f32 v[158:159], v[158:159], v[58:59]
  v_cvt_pk_bf16_f32 v18, v152, v153
  v_cvt_pk_bf16_f32 v19, v154, v155
  v_cvt_pk_bf16_f32 v42, v156, v157
  v_cvt_pk_bf16_f32 v43, v158, v159
  v_pk_mul_f32 v[152:153], v[68:69], v[68:69]
  v_pk_mul_f32 v[154:155], v[70:71], v[70:71]
  v_pk_mul_f32 v[156:157], v[92:93], v[92:93]
  v_pk_mul_f32 v[158:159], v[94:95], v[94:95]
  v_pk_fma_f32 v[152:153], v[152:153], v[144:145], v[146:147]
  v_pk_fma_f32 v[154:155], v[154:155], v[144:145], v[146:147]
  v_pk_fma_f32 v[156:157], v[156:157], v[144:145], v[146:147]
  v_pk_fma_f32 v[158:159], v[158:159], v[144:145], v[146:147]
  v_pk_mul_f32 v[152:153], v[152:153], v[68:69]
  v_pk_mul_f32 v[154:155], v[154:155], v[70:71]
  v_pk_mul_f32 v[156:157], v[156:157], v[92:93]
  v_pk_mul_f32 v[158:159], v[158:159], v[94:95]
  v_exp_f32 v152, v152
  v_exp_f32 v153, v153
  v_exp_f32 v154, v154
  v_exp_f32 v155, v155
  v_exp_f32 v156, v156
  v_exp_f32 v157, v157
  v_exp_f32 v158, v158
  v_exp_f32 v159, v159
  v_pk_mul_f32 v[80:81], v[68:69], v[80:81]
  v_pk_mul_f32 v[82:83], v[70:71], v[82:83]
  v_pk_mul_f32 v[104:105], v[92:93], v[104:105]
  v_pk_mul_f32 v[106:107], v[94:95], v[106:107]
  v_pk_add_f32 v[152:153], v[152:153], v[148:149]
  v_pk_add_f32 v[154:155], v[154:155], v[148:149]
  v_pk_add_f32 v[156:157], v[156:157], v[148:149]
  v_pk_add_f32 v[158:159], v[158:159], v[148:149]
  v_rcp_f32 v152, v152
  v_rcp_f32 v153, v153
  v_rcp_f32 v154, v154
  v_rcp_f32 v155, v155
  v_rcp_f32 v156, v156
  v_rcp_f32 v157, v157
  v_rcp_f32 v158, v158
  v_rcp_f32 v159, v159
  s_nop 0
  v_pk_mul_f32 v[152:153], v[152:153], v[80:81]
  v_pk_mul_f32 v[154:155], v[154:155], v[82:83]
  v_pk_mul_f32 v[156:157], v[156:157], v[104:105]
  v_pk_mul_f32 v[158:159], v[158:159], v[106:107]
  v_cvt_pk_bf16_f32 v66, v152, v153
  v_cvt_pk_bf16_f32 v67, v154, v155
  v_cvt_pk_bf16_f32 v90, v156, v157
  v_cvt_pk_bf16_f32 v91, v158, v159
  v_pk_mul_f32 v[152:153], v[24:25], v[24:25]
  v_pk_mul_f32 v[154:155], v[26:27], v[26:27]
  v_pk_mul_f32 v[156:157], v[48:49], v[48:49]
  v_pk_mul_f32 v[158:159], v[50:51], v[50:51]
  v_pk_fma_f32 v[152:153], v[152:153], v[144:145], v[146:147]
  v_pk_fma_f32 v[154:155], v[154:155], v[144:145], v[146:147]
  v_pk_fma_f32 v[156:157], v[156:157], v[144:145], v[146:147]
  v_pk_fma_f32 v[158:159], v[158:159], v[144:145], v[146:147]
  v_pk_mul_f32 v[152:153], v[152:153], v[24:25]
  v_pk_mul_f32 v[154:155], v[154:155], v[26:27]
  v_pk_mul_f32 v[156:157], v[156:157], v[48:49]
  v_pk_mul_f32 v[158:159], v[158:159], v[50:51]
  v_exp_f32 v152, v152
  v_exp_f32 v153, v153
  v_exp_f32 v154, v154
  v_exp_f32 v155, v155
  v_exp_f32 v156, v156
  v_exp_f32 v157, v157
  v_exp_f32 v158, v158
  v_exp_f32 v159, v159
  v_pk_mul_f32 v[36:37], v[24:25], v[36:37]
  v_pk_mul_f32 v[38:39], v[26:27], v[38:39]
  v_pk_mul_f32 v[60:61], v[48:49], v[60:61]
  v_pk_mul_f32 v[62:63], v[50:51], v[62:63]
  v_pk_add_f32 v[152:153], v[152:153], v[148:149]
  v_pk_add_f32 v[154:155], v[154:155], v[148:149]
  v_pk_add_f32 v[156:157], v[156:157], v[148:149]
  v_pk_add_f32 v[158:159], v[158:159], v[148:149]
  v_rcp_f32 v152, v152
  v_rcp_f32 v153, v153
  v_rcp_f32 v154, v154
  v_rcp_f32 v155, v155
  v_rcp_f32 v156, v156
  v_rcp_f32 v157, v157
  v_rcp_f32 v158, v158
  v_rcp_f32 v159, v159
  s_nop 0
  v_pk_mul_f32 v[152:153], v[152:153], v[36:37]
  v_pk_mul_f32 v[154:155], v[154:155], v[38:39]
  v_pk_mul_f32 v[156:157], v[156:157], v[60:61]
  v_pk_mul_f32 v[158:159], v[158:159], v[62:63]
  v_cvt_pk_bf16_f32 v20, v152, v153
  v_cvt_pk_bf16_f32 v21, v154, v155
  v_cvt_pk_bf16_f32 v44, v156, v157
  v_cvt_pk_bf16_f32 v45, v158, v159
  v_pk_mul_f32 v[152:153], v[72:73], v[72:73]
  v_pk_mul_f32 v[154:155], v[74:75], v[74:75]
  v_pk_mul_f32 v[156:157], v[96:97], v[96:97]
  v_pk_mul_f32 v[158:159], v[98:99], v[98:99]
  v_pk_fma_f32 v[152:153], v[152:153], v[144:145], v[146:147]
  v_pk_fma_f32 v[154:155], v[154:155], v[144:145], v[146:147]
  v_pk_fma_f32 v[156:157], v[156:157], v[144:145], v[146:147]
  v_pk_fma_f32 v[158:159], v[158:159], v[144:145], v[146:147]
  v_pk_mul_f32 v[152:153], v[152:153], v[72:73]
  v_pk_mul_f32 v[154:155], v[154:155], v[74:75]
  v_pk_mul_f32 v[156:157], v[156:157], v[96:97]
  v_pk_mul_f32 v[158:159], v[158:159], v[98:99]
  v_exp_f32 v152, v152
  v_exp_f32 v153, v153
  v_exp_f32 v154, v154
  v_exp_f32 v155, v155
  v_exp_f32 v156, v156
  v_exp_f32 v157, v157
  v_exp_f32 v158, v158
  v_exp_f32 v159, v159
  v_pk_mul_f32 v[84:85], v[72:73], v[84:85]
  v_pk_mul_f32 v[86:87], v[74:75], v[86:87]
  v_pk_mul_f32 v[108:109], v[96:97], v[108:109]
  v_pk_mul_f32 v[110:111], v[98:99], v[110:111]
  v_pk_add_f32 v[152:153], v[152:153], v[148:149]
  v_pk_add_f32 v[154:155], v[154:155], v[148:149]
  v_pk_add_f32 v[156:157], v[156:157], v[148:149]
  v_pk_add_f32 v[158:159], v[158:159], v[148:149]
  v_rcp_f32 v152, v152
  v_rcp_f32 v153, v153
  v_rcp_f32 v154, v154
  v_rcp_f32 v155, v155
  v_rcp_f32 v156, v156
  v_rcp_f32 v157, v157
  v_rcp_f32 v158, v158
  v_rcp_f32 v159, v159
  s_nop 0
  v_pk_mul_f32 v[152:153], v[152:153], v[84:85]
  v_pk_mul_f32 v[154:155], v[154:155], v[86:87]
  v_pk_mul_f32 v[156:157], v[156:157], v[108:109]
  v_pk_mul_f32 v[158:159], v[158:159], v[110:111]
  v_cvt_pk_bf16_f32 v68, v152, v153
  v_cvt_pk_bf16_f32 v69, v154, v155
  v_cvt_pk_bf16_f32 v92, v156, v157
  v_cvt_pk_bf16_f32 v93, v158, v159
  s_cmp_eq_u32 s56, 0
  s_cbranch_scc0 G1_ODD1
  buffer_store_dwordx4 v[16:19], v12, s[20:23], s52 offen offset:2048
  buffer_store_dwordx2 v[20:21], v12, s[20:23], s52 offen offset:3072
  buffer_store_dwordx4 v[40:43], v12, s[20:23], s53 offen offset:2048
  buffer_store_dwordx2 v[44:45], v12, s[20:23], s53 offen offset:3072
  buffer_store_dwordx4 v[64:67], v12, s[20:23], s54 offen offset:2048
  buffer_store_dwordx2 v[68:69], v12, s[20:23], s54 offen offset:3072
  buffer_store_dwordx4 v[88:91], v12, s[20:23], s55 offen offset:2048
  buffer_store_dwordx2 v[92:93], v12, s[20:23], s55 offen offset:3072
  s_branch G1_END
G1_ODD1:
  buffer_store_dwordx2 v[16:17], v12, s[20:23], s52 offen offset:2056
  buffer_store_dwordx4 v[18:21], v12, s[20:23], s52 offen offset:3072
  buffer_store_dwordx2 v[40:41], v12, s[20:23], s53 offen offset:2056
  buffer_store_dwordx4 v[42:45], v12, s[20:23], s53 offen offset:3072
  buffer_store_dwordx2 v[64:65], v12, s[20:23], s54 offen offset:2056
  buffer_store_dwordx4 v[66:69], v12, s[20:23], s54 offen offset:3072
  buffer_store_dwordx2 v[88:89], v12, s[20:23], s55 offen offset:2056
  buffer_store_dwordx4 v[90:93], v12, s[20:23], s55 offen offset:3072
  s_branch G1_END
G1_END:
G1_EXIT:
  s_endpgm
.globl gemm2_kernel
.p2align 8
.type gemm2_kernel,@function
gemm2_kernel:
  s_cmp_ge_u32 s2, 256
  s_cbranch_scc1 G2_EXIT
  s_load_dwordx2 s[6:7], s[0:1], 32
  s_load_dwordx2 s[10:11], s[0:1], 48
  v_lshrrev_b32 v5, 6, v0
  v_and_b32 v1, 63, v0
  s_and_b32 s40, s2, 7
  v_readfirstlane_b32 s26, v5
  s_lshr_b32 s41, s2, 3
  s_and_b32 s42, s40, 3
  s_lshl_b32 s42, s42, 2
  s_and_b32 s43, s41, 3
  s_add_u32 s24, s42, s43
  s_lshr_b32 s42, s40, 2
  s_lshl_b32 s42, s42, 3
  s_lshr_b32 s43, s41, 2
  s_add_u32 s25, s42, s43
  s_and_b32 s27, s26, 3
  s_lshr_b32 s28, s26, 2
  v_lshlrev_b32 v2, 4, v1
  v_lshlrev_b32 v3, 4, v1
  v_add_u32 v4, 114688, v3
  s_lshl_b32 s44, s26, 12
  s_mul_i32 s41, s25, 458752
  s_add_u32 s29, s44, s41
  s_lshl_b32 s40, s24, 3
  s_lshl_b32 s41, s27, 1
  s_add_u32 s40, s40, s41
  s_mul_i32 s40, s40, 114688
  s_lshl_b32 s41, s28, 10
  s_add_u32 s30, s40, s41
  s_mov_b32 s14, 7340032
  s_mov_b32 s15, 0x00020000
  s_mov_b32 s18, 14680064
  s_mov_b32 s19, 0x00020000
  s_waitcnt lgkmcnt(0)
  s_mov_b32 s16, s10
  s_and_b32 s17, s11, 0xffff
  s_add_u32 s12, s16, 16777216
  s_addc_u32 s13, s17, 0
  s_add_u32 m0, s44, 0
  s_add_u32 s40, s29, 0
  buffer_load_dwordx4 v2, s[12:15], s40 offen offset:0 lds
  buffer_load_dwordx4 v2, s[12:15], s40 offen offset:1024 lds
  buffer_load_dwordx4 v2, s[12:15], s40 offen offset:2048 lds
  buffer_load_dwordx4 v2, s[12:15], s40 offen offset:3072 lds
  s_add_u32 s31, s30, 0
  buffer_load_dwordx4 a[0:3], v3, s[16:19], s31 offen offset:0
  buffer_load_dwordx4 a[4:7], v4, s[16:19], s31 offen offset:0
  buffer_load_dwordx4 a[8:11], v3, s[16:19], s31 offen offset:2048
  buffer_load_dwordx4 a[12:15], v4, s[16:19], s31 offen offset:2048
  s_add_u32 s31, s30, 4096
  buffer_load_dwordx4 a[16:19], v3, s[16:19], s31 offen offset:0
  buffer_load_dwordx4 a[20:23], v4, s[16:19], s31 offen offset:0
  buffer_load_dwordx4 a[24:27], v3, s[16:19], s31 offen offset:2048
  buffer_load_dwordx4 a[28:31], v4, s[16:19], s31 offen offset:2048
  s_add_u32 m0, s44, 32768
  s_add_u32 s40, s29, 32768
  buffer_load_dwordx4 v2, s[12:15], s40 offen offset:0 lds
  buffer_load_dwordx4 v2, s[12:15], s40 offen offset:1024 lds
  buffer_load_dwordx4 v2, s[12:15], s40 offen offset:2048 lds
  buffer_load_dwordx4 v2, s[12:15], s40 offen offset:3072 lds
  s_add_u32 s31, s30, 8192
  buffer_load_dwordx4 a[32:35], v3, s[16:19], s31 offen offset:0
  buffer_load_dwordx4 a[36:39], v4, s[16:19], s31 offen offset:0
  buffer_load_dwordx4 a[40:43], v3, s[16:19], s31 offen offset:2048
  buffer_load_dwordx4 a[44:47], v4, s[16:19], s31 offen offset:2048
  s_add_u32 s31, s30, 12288
  buffer_load_dwordx4 a[48:51], v3, s[16:19], s31 offen offset:0
  buffer_load_dwordx4 a[52:55], v4, s[16:19], s31 offen offset:0
  s_add_u32 m0, s44, 65536
  s_add_u32 s40, s29, 65536
  buffer_load_dwordx4 v2, s[12:15], s40 offen offset:0 lds
  buffer_load_dwordx4 v2, s[12:15], s40 offen offset:1024 lds
  buffer_load_dwordx4 v2, s[12:15], s40 offen offset:2048 lds
  buffer_load_dwordx4 v2, s[12:15], s40 offen offset:3072 lds
  s_add_u32 m0, s44, 98304
  s_add_u32 s40, s29, 98304
  buffer_load_dwordx4 v2, s[12:15], s40 offen offset:0 lds
  buffer_load_dwordx4 v2, s[12:15], s40 offen offset:1024 lds
  buffer_load_dwordx4 v2, s[12:15], s40 offen offset:2048 lds
  buffer_load_dwordx4 v2, s[12:15], s40 offen offset:3072 lds
  v_lshrrev_b32 v5, 3, v1
  v_and_b32 v5, 3, v5
  v_lshlrev_b32 v5, 1, v5
  v_lshrrev_b32 v6, 2, v1
  v_lshlrev_b32 v6, 7, v6
  v_and_b32 v7, 3, v1
  v_lshl_add_u32 v6, v7, 3, v6
  s_lshl_b32 s40, s28, 12
  v_add_u32 v6, s40, v6
  v_xor_b32 v7, 0, v5
  v_lshl_add_u32 v48, v7, 4, v6
  v_add_u32 v52, 65536, v48
  v_xor_b32 v7, 2, v5
  v_lshl_add_u32 v49, v7, 4, v6
  v_add_u32 v53, 65536, v49
  v_xor_b32 v7, 4, v5
  v_lshl_add_u32 v50, v7, 4, v6
  v_add_u32 v54, 65536, v50
  v_xor_b32 v7, 6, v5
  v_lshl_add_u32 v51, v7, 4, v6
  v_add_u32 v55, 65536, v51
  s_mov_b32 s20, s6
  s_and_b32 s21, s7, 0xffff
  s_mov_b32 s22, 4194304
  s_mov_b32 s23, 0x00020000
  v_mov_b32 v16, 0
  v_mov_b32 v17, 0
  v_mov_b32 v18, 0
  v_mov_b32 v19, 0
  v_mov_b32 v20, 0
  v_mov_b32 v21, 0
  v_mov_b32 v22, 0
  v_mov_b32 v23, 0
  v_mov_b32 v24, 0
  v_mov_b32 v25, 0
  v_mov_b32 v26, 0
  v_mov_b32 v27, 0
  v_mov_b32 v28, 0
  v_mov_b32 v29, 0
  v_mov_b32 v30, 0
  v_mov_b32 v31, 0
  v_mov_b32 v32, 0
  v_mov_b32 v33, 0
  v_mov_b32 v34, 0
  v_mov_b32 v35, 0
  v_mov_b32 v36, 0
  v_mov_b32 v37, 0
  v_mov_b32 v38, 0
  v_mov_b32 v39, 0
  v_mov_b32 v40, 0
  v_mov_b32 v41, 0
  v_mov_b32 v42, 0
  v_mov_b32 v43, 0
  v_mov_b32 v44, 0
  v_mov_b32 v45, 0
  v_mov_b32 v46, 0
  v_mov_b32 v47, 0
  s_waitcnt vmcnt(26)
  s_barrier
  ds_read_b64_tr_b16 a[64:65], v48 offset:0
  ds_read_b64_tr_b16 a[66:67], v48 offset:2048
  ds_read_b64_tr_b16 a[68:69], v49 offset:0
  ds_read_b64_tr_b16 a[70:71], v49 offset:2048
  ds_read_b64_tr_b16 a[72:73], v50 offset:0
  ds_read_b64_tr_b16 a[74:75], v50 offset:2048
  ds_read_b64_tr_b16 a[76:77], v51 offset:0
  ds_read_b64_tr_b16 a[78:79], v51 offset:2048
  s_waitcnt vmcnt(24) lgkmcnt(0)
  v_mfma_f32_16x16x32_bf16 v[16:19], a[64:67], a[0:3], v[16:19]
  ds_read_b64_tr_b16 a[80:81], v48 offset:8192
  ds_read_b64_tr_b16 a[82:83], v48 offset:10240
  v_mfma_f32_16x16x32_bf16 v[32:35], a[64:67], a[4:7], v[32:35]
  ds_read_b64_tr_b16 a[84:85], v49 offset:8192
  ds_read_b64_tr_b16 a[86:87], v49 offset:10240
  v_mfma_f32_16x16x32_bf16 v[20:23], a[68:71], a[0:3], v[20:23]
  ds_read_b64_tr_b16 a[88:89], v50 offset:8192
  ds_read_b64_tr_b16 a[90:91], v50 offset:10240
  v_mfma_f32_16x16x32_bf16 v[36:39], a[68:71], a[4:7], v[36:39]
  ds_read_b64_tr_b16 a[92:93], v51 offset:8192
  ds_read_b64_tr_b16 a[94:95], v51 offset:10240
  v_mfma_f32_16x16x32_bf16 v[24:27], a[72:75], a[0:3], v[24:27]
  buffer_load_dwordx4 a[56:59], v3, s[16:19], s31 offen offset:2048
  v_mfma_f32_16x16x32_bf16 v[40:43], a[72:75], a[4:7], v[40:43]
  v_mfma_f32_16x16x32_bf16 v[28:31], a[76:79], a[0:3], v[28:31]
  buffer_load_dwordx4 a[60:63], v4, s[16:19], s31 offen offset:2048
  v_mfma_f32_16x16x32_bf16 v[44:47], a[76:79], a[4:7], v[44:47]
  s_waitcnt vmcnt(24) lgkmcnt(0)
  v_mfma_f32_16x16x32_bf16 v[16:19], a[80:83], a[8:11], v[16:19]
  ds_read_b64_tr_b16 a[64:65], v48 offset:16384
  ds_read_b64_tr_b16 a[66:67], v48 offset:18432
  v_mfma_f32_16x16x32_bf16 v[32:35], a[80:83], a[12:15], v[32:35]
  ds_read_b64_tr_b16 a[68:69], v49 offset:16384
  ds_read_b64_tr_b16 a[70:71], v49 offset:18432
  v_mfma_f32_16x16x32_bf16 v[20:23], a[84:87], a[8:11], v[20:23]
  ds_read_b64_tr_b16 a[72:73], v50 offset:16384
  ds_read_b64_tr_b16 a[74:75], v50 offset:18432
  v_mfma_f32_16x16x32_bf16 v[36:39], a[84:87], a[12:15], v[36:39]
  ds_read_b64_tr_b16 a[76:77], v51 offset:16384
  ds_read_b64_tr_b16 a[78:79], v51 offset:18432
  v_mfma_f32_16x16x32_bf16 v[24:27], a[88:91], a[8:11], v[24:27]
  s_add_u32 s31, s30, 16384
  buffer_load_dwordx4 a[0:3], v3, s[16:19], s31 offen offset:0
  v_mfma_f32_16x16x32_bf16 v[40:43], a[88:91], a[12:15], v[40:43]
  v_mfma_f32_16x16x32_bf16 v[28:31], a[92:95], a[8:11], v[28:31]
  buffer_load_dwordx4 a[4:7], v4, s[16:19], s31 offen offset:0
  v_mfma_f32_16x16x32_bf16 v[44:47], a[92:95], a[12:15], v[44:47]
  s_waitcnt vmcnt(24) lgkmcnt(0)
  v_mfma_f32_16x16x32_bf16 v[16:19], a[64:67], a[16:19], v[16:19]
  ds_read_b64_tr_b16 a[80:81], v48 offset:24576
  ds_read_b64_tr_b16 a[82:83], v48 offset:26624
  v_mfma_f32_16x16x32_bf16 v[32:35], a[64:67], a[20:23], v[32:35]
  ds_read_b64_tr_b16 a[84:85], v49 offset:24576
  ds_read_b64_tr_b16 a[86:87], v49 offset:26624
  v_mfma_f32_16x16x32_bf16 v[20:23], a[68:71], a[16:19], v[20:23]
  ds_read_b64_tr_b16 a[88:89], v50 offset:24576
  ds_read_b64_tr_b16 a[90:91], v50 offset:26624
  v_mfma_f32_16x16x32_bf16 v[36:39], a[68:71], a[20:23], v[36:39]
  ds_read_b64_tr_b16 a[92:93], v51 offset:24576
  ds_read_b64_tr_b16 a[94:95], v51 offset:26624
  v_mfma_f32_16x16x32_bf16 v[24:27], a[72:75], a[16:19], v[24:27]
  buffer_load_dwordx4 a[8:11], v3, s[16:19], s31 offen offset:2048
  v_mfma_f32_16x16x32_bf16 v[40:43], a[72:75], a[20:23], v[40:43]
  v_mfma_f32_16x16x32_bf16 v[28:31], a[76:79], a[16:19], v[28:31]
  buffer_load_dwordx4 a[12:15], v4, s[16:19], s31 offen offset:2048
  v_mfma_f32_16x16x32_bf16 v[44:47], a[76:79], a[20:23], v[44:47]
  s_waitcnt vmcnt(20) lgkmcnt(0)
  s_barrier
  v_mfma_f32_16x16x32_bf16 v[16:19], a[80:83], a[24:27], v[16:19]
  ds_read_b64_tr_b16 a[64:65], v48 offset:32768
  ds_read_b64_tr_b16 a[66:67], v48 offset:34816
  v_mfma_f32_16x16x32_bf16 v[32:35], a[80:83], a[28:31], v[32:35]
  ds_read_b64_tr_b16 a[68:69], v49 offset:32768
  ds_read_b64_tr_b16 a[70:71], v49 offset:34816
  v_mfma_f32_16x16x32_bf16 v[20:23], a[84:87], a[24:27], v[20:23]
  ds_read_b64_tr_b16 a[72:73], v50 offset:32768
  ds_read_b64_tr_b16 a[74:75], v50 offset:34816
  v_mfma_f32_16x16x32_bf16 v[36:39], a[84:87], a[28:31], v[36:39]
  ds_read_b64_tr_b16 a[76:77], v51 offset:32768
  ds_read_b64_tr_b16 a[78:79], v51 offset:34816
  v_mfma_f32_16x16x32_bf16 v[24:27], a[88:91], a[24:27], v[24:27]
  s_add_u32 s31, s30, 20480
  buffer_load_dwordx4 a[16:19], v3, s[16:19], s31 offen offset:0
  v_mfma_f32_16x16x32_bf16 v[40:43], a[88:91], a[28:31], v[40:43]
  v_mfma_f32_16x16x32_bf16 v[28:31], a[92:95], a[24:27], v[28:31]
  buffer_load_dwordx4 a[20:23], v4, s[16:19], s31 offen offset:0
  v_mfma_f32_16x16x32_bf16 v[44:47], a[92:95], a[28:31], v[44:47]
  s_add_u32 m0, s44, 0
  s_add_u32 s40, s29, 131072
  buffer_load_dwordx4 v2, s[12:15], s40 offen offset:0 lds
  buffer_load_dwordx4 v2, s[12:15], s40 offen offset:1024 lds
  buffer_load_dwordx4 v2, s[12:15], s40 offen offset:2048 lds
  buffer_load_dwordx4 v2, s[12:15], s40 offen offset:3072 lds
  s_waitcnt vmcnt(24) lgkmcnt(0)
  v_mfma_f32_16x16x32_bf16 v[16:19], a[64:67], a[32:35], v[16:19]
  ds_read_b64_tr_b16 a[80:81], v48 offset:40960
  ds_read_b64_tr_b16 a[82:83], v48 offset:43008
  v_mfma_f32_16x16x32_bf16 v[32:35], a[64:67], a[36:39], v[32:35]
  ds_read_b64_tr_b16 a[84:85], v49 offset:40960
  ds_read_b64_tr_b16 a[86:87], v49 offset:43008
  v_mfma_f32_16x16x32_bf16 v[20:23], a[68:71], a[32:35], v[20:23]
  ds_read_b64_tr_b16 a[88:89], v50 offset:40960
  ds_read_b64_tr_b16 a[90:91], v50 offset:43008
  v_mfma_f32_16x16x32_bf16 v[36:39], a[68:71], a[36:39], v[36:39]
  ds_read_b64_tr_b16 a[92:93], v51 offset:40960
  ds_read_b64_tr_b16 a[94:95], v51 offset:43008
  v_mfma_f32_16x16x32_bf16 v[24:27], a[72:75], a[32:35], v[24:27]
  buffer_load_dwordx4 a[24:27], v3, s[16:19], s31 offen offset:2048
  v_mfma_f32_16x16x32_bf16 v[40:43], a[72:75], a[36:39], v[40:43]
  v_mfma_f32_16x16x32_bf16 v[28:31], a[76:79], a[32:35], v[28:31]
  buffer_load_dwordx4 a[28:31], v4, s[16:19], s31 offen offset:2048
  v_mfma_f32_16x16x32_bf16 v[44:47], a[76:79], a[36:39], v[44:47]
  s_waitcnt vmcnt(24) lgkmcnt(0)
  v_mfma_f32_16x16x32_bf16 v[16:19], a[80:83], a[40:43], v[16:19]
  ds_read_b64_tr_b16 a[64:65], v48 offset:49152
  ds_read_b64_tr_b16 a[66:67], v48 offset:51200
  v_mfma_f32_16x16x32_bf16 v[32:35], a[80:83], a[44:47], v[32:35]
  ds_read_b64_tr_b16 a[68:69], v49 offset:49152
  ds_read_b64_tr_b16 a[70:71], v49 offset:51200
  v_mfma_f32_16x16x32_bf16 v[20:23], a[84:87], a[40:43], v[20:23]
  ds_read_b64_tr_b16 a[72:73], v50 offset:49152
  ds_read_b64_tr_b16 a[74:75], v50 offset:51200
  v_mfma_f32_16x16x32_bf16 v[36:39], a[84:87], a[44:47], v[36:39]
  ds_read_b64_tr_b16 a[76:77], v51 offset:49152
  ds_read_b64_tr_b16 a[78:79], v51 offset:51200
  v_mfma_f32_16x16x32_bf16 v[24:27], a[88:91], a[40:43], v[24:27]
  s_add_u32 s31, s30, 24576
  buffer_load_dwordx4 a[32:35], v3, s[16:19], s31 offen offset:0
  v_mfma_f32_16x16x32_bf16 v[40:43], a[88:91], a[44:47], v[40:43]
  v_mfma_f32_16x16x32_bf16 v[28:31], a[92:95], a[40:43], v[28:31]
  buffer_load_dwordx4 a[36:39], v4, s[16:19], s31 offen offset:0
  v_mfma_f32_16x16x32_bf16 v[44:47], a[92:95], a[44:47], v[44:47]
  s_waitcnt vmcnt(24) lgkmcnt(0)
  v_mfma_f32_16x16x32_bf16 v[16:19], a[64:67], a[48:51], v[16:19]
  ds_read_b64_tr_b16 a[80:81], v48 offset:57344
  ds_read_b64_tr_b16 a[82:83], v48 offset:59392
  v_mfma_f32_16x16x32_bf16 v[32:35], a[64:67], a[52:55], v[32:35]
  ds_read_b64_tr_b16 a[84:85], v49 offset:57344
  ds_read_b64_tr_b16 a[86:87], v49 offset:59392
  v_mfma_f32_16x16x32_bf16 v[20:23], a[68:71], a[48:51], v[20:23]
  ds_read_b64_tr_b16 a[88:89], v50 offset:57344
  ds_read_b64_tr_b16 a[90:91], v50 offset:59392
  v_mfma_f32_16x16x32_bf16 v[36:39], a[68:71], a[52:55], v[36:39]
  ds_read_b64_tr_b16 a[92:93], v51 offset:57344
  ds_read_b64_tr_b16 a[94:95], v51 offset:59392
  v_mfma_f32_16x16x32_bf16 v[24:27], a[72:75], a[48:51], v[24:27]
  buffer_load_dwordx4 a[40:43], v3, s[16:19], s31 offen offset:2048
  v_mfma_f32_16x16x32_bf16 v[40:43], a[72:75], a[52:55], v[40:43]
  v_mfma_f32_16x16x32_bf16 v[28:31], a[76:79], a[48:51], v[28:31]
  buffer_load_dwordx4 a[44:47], v4, s[16:19], s31 offen offset:2048
  v_mfma_f32_16x16x32_bf16 v[44:47], a[76:79], a[52:55], v[44:47]
  s_waitcnt vmcnt(16) lgkmcnt(0)
  s_barrier
  v_mfma_f32_16x16x32_bf16 v[16:19], a[80:83], a[56:59], v[16:19]
  ds_read_b64_tr_b16 a[64:65], v52 offset:0
  ds_read_b64_tr_b16 a[66:67], v52 offset:2048
  v_mfma_f32_16x16x32_bf16 v[32:35], a[80:83], a[60:63], v[32:35]
  ds_read_b64_tr_b16 a[68:69], v53 offset:0
  ds_read_b64_tr_b16 a[70:71], v53 offset:2048
  v_mfma_f32_16x16x32_bf16 v[20:23], a[84:87], a[56:59], v[20:23]
  ds_read_b64_tr_b16 a[72:73], v54 offset:0
  ds_read_b64_tr_b16 a[74:75], v54 offset:2048
  v_mfma_f32_16x16x32_bf16 v[36:39], a[84:87], a[60:63], v[36:39]
  ds_read_b64_tr_b16 a[76:77], v55 offset:0
  ds_read_b64_tr_b16 a[78:79], v55 offset:2048
  v_mfma_f32_16x16x32_bf16 v[24:27], a[88:91], a[56:59], v[24:27]
  s_add_u32 s31, s30, 28672
  buffer_load_dwordx4 a[48:51], v3, s[16:19], s31 offen offset:0
  v_mfma_f32_16x16x32_bf16 v[40:43], a[88:91], a[60:63], v[40:43]
  v_mfma_f32_16x16x32_bf16 v[28:31], a[92:95], a[56:59], v[28:31]
  buffer_load_dwordx4 a[52:55], v4, s[16:19], s31 offen offset:0
  v_mfma_f32_16x16x32_bf16 v[44:47], a[92:95], a[60:63], v[44:47]
  s_add_u32 m0, s44, 32768
  s_add_u32 s40, s29, 163840
  buffer_load_dwordx4 v2, s[12:15], s40 offen offset:0 lds
  buffer_load_dwordx4 v2, s[12:15], s40 offen offset:1024 lds
  buffer_load_dwordx4 v2, s[12:15], s40 offen offset:2048 lds
  buffer_load_dwordx4 v2, s[12:15], s40 offen offset:3072 lds
  s_waitcnt vmcnt(20) lgkmcnt(0)
  v_mfma_f32_16x16x32_bf16 v[16:19], a[64:67], a[0:3], v[16:19]
  ds_read_b64_tr_b16 a[80:81], v52 offset:8192
  ds_read_b64_tr_b16 a[82:83], v52 offset:10240
  v_mfma_f32_16x16x32_bf16 v[32:35], a[64:67], a[4:7], v[32:35]
  ds_read_b64_tr_b16 a[84:85], v53 offset:8192
  ds_read_b64_tr_b16 a[86:87], v53 offset:10240
  v_mfma_f32_16x16x32_bf16 v[20:23], a[68:71], a[0:3], v[20:23]
  ds_read_b64_tr_b16 a[88:89], v54 offset:8192
  ds_read_b64_tr_b16 a[90:91], v54 offset:10240
  v_mfma_f32_16x16x32_bf16 v[36:39], a[68:71], a[4:7], v[36:39]
  ds_read_b64_tr_b16 a[92:93], v55 offset:8192
  ds_read_b64_tr_b16 a[94:95], v55 offset:10240
  v_mfma_f32_16x16x32_bf16 v[24:27], a[72:75], a[0:3], v[24:27]
  buffer_load_dwordx4 a[56:59], v3, s[16:19], s31 offen offset:2048
  v_mfma_f32_16x16x32_bf16 v[40:43], a[72:75], a[4:7], v[40:43]
  v_mfma_f32_16x16x32_bf16 v[28:31], a[76:79], a[0:3], v[28:31]
  buffer_load_dwordx4 a[60:63], v4, s[16:19], s31 offen offset:2048
  v_mfma_f32_16x16x32_bf16 v[44:47], a[76:79], a[4:7], v[44:47]
  s_waitcnt vmcnt(20) lgkmcnt(0)
  v_mfma_f32_16x16x32_bf16 v[16:19], a[80:83], a[8:11], v[16:19]
  ds_read_b64_tr_b16 a[64:65], v52 offset:16384
  ds_read_b64_tr_b16 a[66:67], v52 offset:18432
  v_mfma_f32_16x16x32_bf16 v[32:35], a[80:83], a[12:15], v[32:35]
  ds_read_b64_tr_b16 a[68:69], v53 offset:16384
  ds_read_b64_tr_b16 a[70:71], v53 offset:18432
  v_mfma_f32_16x16x32_bf16 v[20:23], a[84:87], a[8:11], v[20:23]
  ds_read_b64_tr_b16 a[72:73], v54 offset:16384
  ds_read_b64_tr_b16 a[74:75], v54 offset:18432
  v_mfma_f32_16x16x32_bf16 v[36:39], a[84:87], a[12:15], v[36:39]
  ds_read_b64_tr_b16 a[76:77], v55 offset:16384
  ds_read_b64_tr_b16 a[78:79], v55 offset:18432
  v_mfma_f32_16x16x32_bf16 v[24:27], a[88:91], a[8:11], v[24:27]
  s_add_u32 s31, s30, 32768
  buffer_load_dwordx4 a[0:3], v3, s[16:19], s31 offen offset:0
  v_mfma_f32_16x16x32_bf16 v[40:43], a[88:91], a[12:15], v[40:43]
  v_mfma_f32_16x16x32_bf16 v[28:31], a[92:95], a[8:11], v[28:31]
  buffer_load_dwordx4 a[4:7], v4, s[16:19], s31 offen offset:0
  v_mfma_f32_16x16x32_bf16 v[44:47], a[92:95], a[12:15], v[44:47]
  s_waitcnt vmcnt(20) lgkmcnt(0)
  v_mfma_f32_16x16x32_bf16 v[16:19], a[64:67], a[16:19], v[16:19]
  ds_read_b64_tr_b16 a[80:81], v52 offset:24576
  ds_read_b64_tr_b16 a[82:83], v52 offset:26624
  v_mfma_f32_16x16x32_bf16 v[32:35], a[64:67], a[20:23], v[32:35]
  ds_read_b64_tr_b16 a[84:85], v53 offset:24576
  ds_read_b64_tr_b16 a[86:87], v53 offset:26624
  v_mfma_f32_16x16x32_bf16 v[20:23], a[68:71], a[16:19], v[20:23]
  ds_read_b64_tr_b16 a[88:89], v54 offset:24576
  ds_read_b64_tr_b16 a[90:91], v54 offset:26624
  v_mfma_f32_16x16x32_bf16 v[36:39], a[68:71], a[20:23], v[36:39]
  ds_read_b64_tr_b16 a[92:93], v55 offset:24576
  ds_read_b64_tr_b16 a[94:95], v55 offset:26624
  v_mfma_f32_16x16x32_bf16 v[24:27], a[72:75], a[16:19], v[24:27]
  buffer_load_dwordx4 a[8:11], v3, s[16:19], s31 offen offset:2048
  v_mfma_f32_16x16x32_bf16 v[40:43], a[72:75], a[20:23], v[40:43]
  v_mfma_f32_16x16x32_bf16 v[28:31], a[76:79], a[16:19], v[28:31]
  buffer_load_dwordx4 a[12:15], v4, s[16:19], s31 offen offset:2048
  v_mfma_f32_16x16x32_bf16 v[44:47], a[76:79], a[20:23], v[44:47]
  s_waitcnt vmcnt(16) lgkmcnt(0)
  s_barrier
  v_mfma_f32_16x16x32_bf16 v[16:19], a[80:83], a[24:27], v[16:19]
  ds_read_b64_tr_b16 a[64:65], v52 offset:32768
  ds_read_b64_tr_b16 a[66:67], v52 offset:34816
  v_mfma_f32_16x16x32_bf16 v[32:35], a[80:83], a[28:31], v[32:35]
  ds_read_b64_tr_b16 a[68:69], v53 offset:32768
  ds_read_b64_tr_b16 a[70:71], v53 offset:34816
  v_mfma_f32_16x16x32_bf16 v[20:23], a[84:87], a[24:27], v[20:23]
  ds_read_b64_tr_b16 a[72:73], v54 offset:32768
  ds_read_b64_tr_b16 a[74:75], v54 offset:34816
  v_mfma_f32_16x16x32_bf16 v[36:39], a[84:87], a[28:31], v[36:39]
  ds_read_b64_tr_b16 a[76:77], v55 offset:32768
  ds_read_b64_tr_b16 a[78:79], v55 offset:34816
  v_mfma_f32_16x16x32_bf16 v[24:27], a[88:91], a[24:27], v[24:27]
  s_add_u32 s31, s30, 36864
  buffer_load_dwordx4 a[16:19], v3, s[16:19], s31 offen offset:0
  v_mfma_f32_16x16x32_bf16 v[40:43], a[88:91], a[28:31], v[40:43]
  v_mfma_f32_16x16x32_bf16 v[28:31], a[92:95], a[24:27], v[28:31]
  buffer_load_dwordx4 a[20:23], v4, s[16:19], s31 offen offset:0
  v_mfma_f32_16x16x32_bf16 v[44:47], a[92:95], a[28:31], v[44:47]
  s_add_u32 m0, s44, 65536
  s_add_u32 s40, s29, 196608
  buffer_load_dwordx4 v2, s[12:15], s40 offen offset:0 lds
  buffer_load_dwordx4 v2, s[12:15], s40 offen offset:1024 lds
  buffer_load_dwordx4 v2, s[12:15], s40 offen offset:2048 lds
  buffer_load_dwordx4 v2, s[12:15], s40 offen offset:3072 lds
  s_waitcnt vmcnt(20) lgkmcnt(0)
  v_mfma_f32_16x16x32_bf16 v[16:19], a[64:67], a[32:35], v[16:19]
  ds_read_b64_tr_b16 a[80:81], v52 offset:40960
  ds_read_b64_tr_b16 a[82:83], v52 offset:43008
  v_mfma_f32_16x16x32_bf16 v[32:35], a[64:67], a[36:39], v[32:35]
  ds_read_b64_tr_b16 a[84:85], v53 offset:40960
  ds_read_b64_tr_b16 a[86:87], v53 offset:43008
  v_mfma_f32_16x16x32_bf16 v[20:23], a[68:71], a[32:35], v[20:23]
  ds_read_b64_tr_b16 a[88:89], v54 offset:40960
  ds_read_b64_tr_b16 a[90:91], v54 offset:43008
  v_mfma_f32_16x16x32_bf16 v[36:39], a[68:71], a[36:39], v[36:39]
  ds_read_b64_tr_b16 a[92:93], v55 offset:40960
  ds_read_b64_tr_b16 a[94:95], v55 offset:43008
  v_mfma_f32_16x16x32_bf16 v[24:27], a[72:75], a[32:35], v[24:27]
  buffer_load_dwordx4 a[24:27], v3, s[16:19], s31 offen offset:2048
  v_mfma_f32_16x16x32_bf16 v[40:43], a[72:75], a[36:39], v[40:43]
  v_mfma_f32_16x16x32_bf16 v[28:31], a[76:79], a[32:35], v[28:31]
  buffer_load_dwordx4 a[28:31], v4, s[16:19], s31 offen offset:2048
  v_mfma_f32_16x16x32_bf16 v[44:47], a[76:79], a[36:39], v[44:47]
  s_waitcnt vmcnt(20) lgkmcnt(0)
  v_mfma_f32_16x16x32_bf16 v[16:19], a[80:83], a[40:43], v[16:19]
  ds_read_b64_tr_b16 a[64:65], v52 offset:49152
  ds_read_b64_tr_b16 a[66:67], v52 offset:51200
  v_mfma_f32_16x16x32_bf16 v[32:35], a[80:83], a[44:47], v[32:35]
  ds_read_b64_tr_b16 a[68:69], v53 offset:49152
  ds_read_b64_tr_b16 a[70:71], v53 offset:51200
  v_mfma_f32_16x16x32_bf16 v[20:23], a[84:87], a[40:43], v[20:23]
  ds_read_b64_tr_b16 a[72:73], v54 offset:49152
  ds_read_b64_tr_b16 a[74:75], v54 offset:51200
  v_mfma_f32_16x16x32_bf16 v[36:39], a[84:87], a[44:47], v[36:39]
  ds_read_b64_tr_b16 a[76:77], v55 offset:49152
  ds_read_b64_tr_b16 a[78:79], v55 offset:51200
  v_mfma_f32_16x16x32_bf16 v[24:27], a[88:91], a[40:43], v[24:27]
  s_add_u32 s31, s30, 40960
  buffer_load_dwordx4 a[32:35], v3, s[16:19], s31 offen offset:0
  v_mfma_f32_16x16x32_bf16 v[40:43], a[88:91], a[44:47], v[40:43]
  v_mfma_f32_16x16x32_bf16 v[28:31], a[92:95], a[40:43], v[28:31]
  buffer_load_dwordx4 a[36:39], v4, s[16:19], s31 offen offset:0
  v_mfma_f32_16x16x32_bf16 v[44:47], a[92:95], a[44:47], v[44:47]
  s_waitcnt vmcnt(20) lgkmcnt(0)
  v_mfma_f32_16x16x32_bf16 v[16:19], a[64:67], a[48:51], v[16:19]
  ds_read_b64_tr_b16 a[80:81], v52 offset:57344
  ds_read_b64_tr_b16 a[82:83], v52 offset:59392
  v_mfma_f32_16x16x32_bf16 v[32:35], a[64:67], a[52:55], v[32:35]
  ds_read_b64_tr_b16 a[84:85], v53 offset:57344
  ds_read_b64_tr_b16 a[86:87], v53 offset:59392
  v_mfma_f32_16x16x32_bf16 v[20:23], a[68:71], a[48:51], v[20:23]
  ds_read_b64_tr_b16 a[88:89], v54 offset:57344
  ds_read_b64_tr_b16 a[90:91], v54 offset:59392
  v_mfma_f32_16x16x32_bf16 v[36:39], a[68:71], a[52:55], v[36:39]
  ds_read_b64_tr_b16 a[92:93], v55 offset:57344
  ds_read_b64_tr_b16 a[94:95], v55 offset:59392
  v_mfma_f32_16x16x32_bf16 v[24:27], a[72:75], a[48:51], v[24:27]
  buffer_load_dwordx4 a[40:43], v3, s[16:19], s31 offen offset:2048
  v_mfma_f32_16x16x32_bf16 v[40:43], a[72:75], a[52:55], v[40:43]
  v_mfma_f32_16x16x32_bf16 v[28:31], a[76:79], a[48:51], v[28:31]
  buffer_load_dwordx4 a[44:47], v4, s[16:19], s31 offen offset:2048
  v_mfma_f32_16x16x32_bf16 v[44:47], a[76:79], a[52:55], v[44:47]
  s_waitcnt vmcnt(16) lgkmcnt(0)
  s_barrier
  v_mfma_f32_16x16x32_bf16 v[16:19], a[80:83], a[56:59], v[16:19]
  ds_read_b64_tr_b16 a[64:65], v48 offset:0
  ds_read_b64_tr_b16 a[66:67], v48 offset:2048
  v_mfma_f32_16x16x32_bf16 v[32:35], a[80:83], a[60:63], v[32:35]
  ds_read_b64_tr_b16 a[68:69], v49 offset:0
  ds_read_b64_tr_b16 a[70:71], v49 offset:2048
  v_mfma_f32_16x16x32_bf16 v[20:23], a[84:87], a[56:59], v[20:23]
  ds_read_b64_tr_b16 a[72:73], v50 offset:0
  ds_read_b64_tr_b16 a[74:75], v50 offset:2048
  v_mfma_f32_16x16x32_bf16 v[36:39], a[84:87], a[60:63], v[36:39]
  ds_read_b64_tr_b16 a[76:77], v51 offset:0
  ds_read_b64_tr_b16 a[78:79], v51 offset:2048
  v_mfma_f32_16x16x32_bf16 v[24:27], a[88:91], a[56:59], v[24:27]
  s_add_u32 s31, s30, 45056
  buffer_load_dwordx4 a[48:51], v3, s[16:19], s31 offen offset:0
  v_mfma_f32_16x16x32_bf16 v[40:43], a[88:91], a[60:63], v[40:43]
  v_mfma_f32_16x16x32_bf16 v[28:31], a[92:95], a[56:59], v[28:31]
  buffer_load_dwordx4 a[52:55], v4, s[16:19], s31 offen offset:0
  v_mfma_f32_16x16x32_bf16 v[44:47], a[92:95], a[60:63], v[44:47]
  s_add_u32 m0, s44, 98304
  s_add_u32 s40, s29, 229376
  buffer_load_dwordx4 v2, s[12:15], s40 offen offset:0 lds
  buffer_load_dwordx4 v2, s[12:15], s40 offen offset:1024 lds
  buffer_load_dwordx4 v2, s[12:15], s40 offen offset:2048 lds
  buffer_load_dwordx4 v2, s[12:15], s40 offen offset:3072 lds
  s_waitcnt vmcnt(20) lgkmcnt(0)
  v_mfma_f32_16x16x32_bf16 v[16:19], a[64:67], a[0:3], v[16:19]
  ds_read_b64_tr_b16 a[80:81], v48 offset:8192
  ds_read_b64_tr_b16 a[82:83], v48 offset:10240
  v_mfma_f32_16x16x32_bf16 v[32:35], a[64:67], a[4:7], v[32:35]
  ds_read_b64_tr_b16 a[84:85], v49 offset:8192
  ds_read_b64_tr_b16 a[86:87], v49 offset:10240
  v_mfma_f32_16x16x32_bf16 v[20:23], a[68:71], a[0:3], v[20:23]
  ds_read_b64_tr_b16 a[88:89], v50 offset:8192
  ds_read_b64_tr_b16 a[90:91], v50 offset:10240
  v_mfma_f32_16x16x32_bf16 v[36:39], a[68:71], a[4:7], v[36:39]
  ds_read_b64_tr_b16 a[92:93], v51 offset:8192
  ds_read_b64_tr_b16 a[94:95], v51 offset:10240
  v_mfma_f32_16x16x32_bf16 v[24:27], a[72:75], a[0:3], v[24:27]
  buffer_load_dwordx4 a[56:59], v3, s[16:19], s31 offen offset:2048
  v_mfma_f32_16x16x32_bf16 v[40:43], a[72:75], a[4:7], v[40:43]
  v_mfma_f32_16x16x32_bf16 v[28:31], a[76:79], a[0:3], v[28:31]
  buffer_load_dwordx4 a[60:63], v4, s[16:19], s31 offen offset:2048
  v_mfma_f32_16x16x32_bf16 v[44:47], a[76:79], a[4:7], v[44:47]
  s_waitcnt vmcnt(20) lgkmcnt(0)
  v_mfma_f32_16x16x32_bf16 v[16:19], a[80:83], a[8:11], v[16:19]
  ds_read_b64_tr_b16 a[64:65], v48 offset:16384
  ds_read_b64_tr_b16 a[66:67], v48 offset:18432
  v_mfma_f32_16x16x32_bf16 v[32:35], a[80:83], a[12:15], v[32:35]
  ds_read_b64_tr_b16 a[68:69], v49 offset:16384
  ds_read_b64_tr_b16 a[70:71], v49 offset:18432
  v_mfma_f32_16x16x32_bf16 v[20:23], a[84:87], a[8:11], v[20:23]
  ds_read_b64_tr_b16 a[72:73], v50 offset:16384
  ds_read_b64_tr_b16 a[74:75], v50 offset:18432
  v_mfma_f32_16x16x32_bf16 v[36:39], a[84:87], a[12:15], v[36:39]
  ds_read_b64_tr_b16 a[76:77], v51 offset:16384
  ds_read_b64_tr_b16 a[78:79], v51 offset:18432
  v_mfma_f32_16x16x32_bf16 v[24:27], a[88:91], a[8:11], v[24:27]
  s_add_u32 s31, s30, 49152
  buffer_load_dwordx4 a[0:3], v3, s[16:19], s31 offen offset:0
  v_mfma_f32_16x16x32_bf16 v[40:43], a[88:91], a[12:15], v[40:43]
  v_mfma_f32_16x16x32_bf16 v[28:31], a[92:95], a[8:11], v[28:31]
  buffer_load_dwordx4 a[4:7], v4, s[16:19], s31 offen offset:0
  v_mfma_f32_16x16x32_bf16 v[44:47], a[92:95], a[12:15], v[44:47]
  s_waitcnt vmcnt(20) lgkmcnt(0)
  v_mfma_f32_16x16x32_bf16 v[16:19], a[64:67], a[16:19], v[16:19]
  ds_read_b64_tr_b16 a[80:81], v48 offset:24576
  ds_read_b64_tr_b16 a[82:83], v48 offset:26624
  v_mfma_f32_16x16x32_bf16 v[32:35], a[64:67], a[20:23], v[32:35]
  ds_read_b64_tr_b16 a[84:85], v49 offset:24576
  ds_read_b64_tr_b16 a[86:87], v49 offset:26624
  v_mfma_f32_16x16x32_bf16 v[20:23], a[68:71], a[16:19], v[20:23]
  ds_read_b64_tr_b16 a[88:89], v50 offset:24576
  ds_read_b64_tr_b16 a[90:91], v50 offset:26624
  v_mfma_f32_16x16x32_bf16 v[36:39], a[68:71], a[20:23], v[36:39]
  ds_read_b64_tr_b16 a[92:93], v51 offset:24576
  ds_read_b64_tr_b16 a[94:95], v51 offset:26624
  v_mfma_f32_16x16x32_bf16 v[24:27], a[72:75], a[16:19], v[24:27]
  buffer_load_dwordx4 a[8:11], v3, s[16:19], s31 offen offset:2048
  v_mfma_f32_16x16x32_bf16 v[40:43], a[72:75], a[20:23], v[40:43]
  v_mfma_f32_16x16x32_bf16 v[28:31], a[76:79], a[16:19], v[28:31]
  buffer_load_dwordx4 a[12:15], v4, s[16:19], s31 offen offset:2048
  v_mfma_f32_16x16x32_bf16 v[44:47], a[76:79], a[20:23], v[44:47]
  s_waitcnt vmcnt(16) lgkmcnt(0)
  s_barrier
  v_mfma_f32_16x16x32_bf16 v[16:19], a[80:83], a[24:27], v[16:19]
  ds_read_b64_tr_b16 a[64:65], v48 offset:32768
  ds_read_b64_tr_b16 a[66:67], v48 offset:34816
  v_mfma_f32_16x16x32_bf16 v[32:35], a[80:83], a[28:31], v[32:35]
  ds_read_b64_tr_b16 a[68:69], v49 offset:32768
  ds_read_b64_tr_b16 a[70:71], v49 offset:34816
  v_mfma_f32_16x16x32_bf16 v[20:23], a[84:87], a[24:27], v[20:23]
  ds_read_b64_tr_b16 a[72:73], v50 offset:32768
  ds_read_b64_tr_b16 a[74:75], v50 offset:34816
  v_mfma_f32_16x16x32_bf16 v[36:39], a[84:87], a[28:31], v[36:39]
  ds_read_b64_tr_b16 a[76:77], v51 offset:32768
  ds_read_b64_tr_b16 a[78:79], v51 offset:34816
  v_mfma_f32_16x16x32_bf16 v[24:27], a[88:91], a[24:27], v[24:27]
  s_add_u32 s31, s30, 53248
  buffer_load_dwordx4 a[16:19], v3, s[16:19], s31 offen offset:0
  v_mfma_f32_16x16x32_bf16 v[40:43], a[88:91], a[28:31], v[40:43]
  v_mfma_f32_16x16x32_bf16 v[28:31], a[92:95], a[24:27], v[28:31]
  buffer_load_dwordx4 a[20:23], v4, s[16:19], s31 offen offset:0
  v_mfma_f32_16x16x32_bf16 v[44:47], a[92:95], a[28:31], v[44:47]
  s_add_u32 m0, s44, 0
  s_add_u32 s40, s29, 262144
  buffer_load_dwordx4 v2, s[12:15], s40 offen offset:0 lds
  buffer_load_dwordx4 v2, s[12:15], s40 offen offset:1024 lds
  buffer_load_dwordx4 v2, s[12:15], s40 offen offset:2048 lds
  buffer_load_dwordx4 v2, s[12:15], s40 offen offset:3072 lds
  s_waitcnt vmcnt(20) lgkmcnt(0)
  v_mfma_f32_16x16x32_bf16 v[16:19], a[64:67], a[32:35], v[16:19]
  ds_read_b64_tr_b16 a[80:81], v48 offset:40960
  ds_read_b64_tr_b16 a[82:83], v48 offset:43008
  v_mfma_f32_16x16x32_bf16 v[32:35], a[64:67], a[36:39], v[32:35]
  ds_read_b64_tr_b16 a[84:85], v49 offset:40960
  ds_read_b64_tr_b16 a[86:87], v49 offset:43008
  v_mfma_f32_16x16x32_bf16 v[20:23], a[68:71], a[32:35], v[20:23]
  ds_read_b64_tr_b16 a[88:89], v50 offset:40960
  ds_read_b64_tr_b16 a[90:91], v50 offset:43008
  v_mfma_f32_16x16x32_bf16 v[36:39], a[68:71], a[36:39], v[36:39]
  ds_read_b64_tr_b16 a[92:93], v51 offset:40960
  ds_read_b64_tr_b16 a[94:95], v51 offset:43008
  v_mfma_f32_16x16x32_bf16 v[24:27], a[72:75], a[32:35], v[24:27]
  buffer_load_dwordx4 a[24:27], v3, s[16:19], s31 offen offset:2048
  v_mfma_f32_16x16x32_bf16 v[40:43], a[72:75], a[36:39], v[40:43]
  v_mfma_f32_16x16x32_bf16 v[28:31], a[76:79], a[32:35], v[28:31]
  buffer_load_dwordx4 a[28:31], v4, s[16:19], s31 offen offset:2048
  v_mfma_f32_16x16x32_bf16 v[44:47], a[76:79], a[36:39], v[44:47]
  s_waitcnt vmcnt(20) lgkmcnt(0)
  v_mfma_f32_16x16x32_bf16 v[16:19], a[80:83], a[40:43], v[16:19]
  ds_read_b64_tr_b16 a[64:65], v48 offset:49152
  ds_read_b64_tr_b16 a[66:67], v48 offset:51200
  v_mfma_f32_16x16x32_bf16 v[32:35], a[80:83], a[44:47], v[32:35]
  ds_read_b64_tr_b16 a[68:69], v49 offset:49152
  ds_read_b64_tr_b16 a[70:71], v49 offset:51200
  v_mfma_f32_16x16x32_bf16 v[20:23], a[84:87], a[40:43], v[20:23]
  ds_read_b64_tr_b16 a[72:73], v50 offset:49152
  ds_read_b64_tr_b16 a[74:75], v50 offset:51200
  v_mfma_f32_16x16x32_bf16 v[36:39], a[84:87], a[44:47], v[36:39]
  ds_read_b64_tr_b16 a[76:77], v51 offset:49152
  ds_read_b64_tr_b16 a[78:79], v51 offset:51200
  v_mfma_f32_16x16x32_bf16 v[24:27], a[88:91], a[40:43], v[24:27]
  s_add_u32 s31, s30, 57344
  buffer_load_dwordx4 a[32:35], v3, s[16:19], s31 offen offset:0
  v_mfma_f32_16x16x32_bf16 v[40:43], a[88:91], a[44:47], v[40:43]
  v_mfma_f32_16x16x32_bf16 v[28:31], a[92:95], a[40:43], v[28:31]
  buffer_load_dwordx4 a[36:39], v4, s[16:19], s31 offen offset:0
  v_mfma_f32_16x16x32_bf16 v[44:47], a[92:95], a[44:47], v[44:47]
  s_waitcnt vmcnt(20) lgkmcnt(0)
  v_mfma_f32_16x16x32_bf16 v[16:19], a[64:67], a[48:51], v[16:19]
  ds_read_b64_tr_b16 a[80:81], v48 offset:57344
  ds_read_b64_tr_b16 a[82:83], v48 offset:59392
  v_mfma_f32_16x16x32_bf16 v[32:35], a[64:67], a[52:55], v[32:35]
  ds_read_b64_tr_b16 a[84:85], v49 offset:57344
  ds_read_b64_tr_b16 a[86:87], v49 offset:59392
  v_mfma_f32_16x16x32_bf16 v[20:23], a[68:71], a[48:51], v[20:23]
  ds_read_b64_tr_b16 a[88:89], v50 offset:57344
  ds_read_b64_tr_b16 a[90:91], v50 offset:59392
  v_mfma_f32_16x16x32_bf16 v[36:39], a[68:71], a[52:55], v[36:39]
  ds_read_b64_tr_b16 a[92:93], v51 offset:57344
  ds_read_b64_tr_b16 a[94:95], v51 offset:59392
  v_mfma_f32_16x16x32_bf16 v[24:27], a[72:75], a[48:51], v[24:27]
  buffer_load_dwordx4 a[40:43], v3, s[16:19], s31 offen offset:2048
  v_mfma_f32_16x16x32_bf16 v[40:43], a[72:75], a[52:55], v[40:43]
  v_mfma_f32_16x16x32_bf16 v[28:31], a[76:79], a[48:51], v[28:31]
  buffer_load_dwordx4 a[44:47], v4, s[16:19], s31 offen offset:2048
  v_mfma_f32_16x16x32_bf16 v[44:47], a[76:79], a[52:55], v[44:47]
  s_waitcnt vmcnt(16) lgkmcnt(0)
  s_barrier
  v_mfma_f32_16x16x32_bf16 v[16:19], a[80:83], a[56:59], v[16:19]
  ds_read_b64_tr_b16 a[64:65], v52 offset:0
  ds_read_b64_tr_b16 a[66:67], v52 offset:2048
  v_mfma_f32_16x16x32_bf16 v[32:35], a[80:83], a[60:63], v[32:35]
  ds_read_b64_tr_b16 a[68:69], v53 offset:0
  ds_read_b64_tr_b16 a[70:71], v53 offset:2048
  v_mfma_f32_16x16x32_bf16 v[20:23], a[84:87], a[56:59], v[20:23]
  ds_read_b64_tr_b16 a[72:73], v54 offset:0
  ds_read_b64_tr_b16 a[74:75], v54 offset:2048
  v_mfma_f32_16x16x32_bf16 v[36:39], a[84:87], a[60:63], v[36:39]
  ds_read_b64_tr_b16 a[76:77], v55 offset:0
  ds_read_b64_tr_b16 a[78:79], v55 offset:2048
  v_mfma_f32_16x16x32_bf16 v[24:27], a[88:91], a[56:59], v[24:27]
  s_add_u32 s31, s30, 61440
  buffer_load_dwordx4 a[48:51], v3, s[16:19], s31 offen offset:0
  v_mfma_f32_16x16x32_bf16 v[40:43], a[88:91], a[60:63], v[40:43]
  v_mfma_f32_16x16x32_bf16 v[28:31], a[92:95], a[56:59], v[28:31]
  buffer_load_dwordx4 a[52:55], v4, s[16:19], s31 offen offset:0
  v_mfma_f32_16x16x32_bf16 v[44:47], a[92:95], a[60:63], v[44:47]
  s_add_u32 m0, s44, 32768
  s_add_u32 s40, s29, 294912
  buffer_load_dwordx4 v2, s[12:15], s40 offen offset:0 lds
  buffer_load_dwordx4 v2, s[12:15], s40 offen offset:1024 lds
  buffer_load_dwordx4 v2, s[12:15], s40 offen offset:2048 lds
  buffer_load_dwordx4 v2, s[12:15], s40 offen offset:3072 lds
  s_waitcnt vmcnt(20) lgkmcnt(0)
  v_mfma_f32_16x16x32_bf16 v[16:19], a[64:67], a[0:3], v[16:19]
  ds_read_b64_tr_b16 a[80:81], v52 offset:8192
  ds_read_b64_tr_b16 a[82:83], v52 offset:10240
  v_mfma_f32_16x16x32_bf16 v[32:35], a[64:67], a[4:7], v[32:35]
  ds_read_b64_tr_b16 a[84:85], v53 offset:8192
  ds_read_b64_tr_b16 a[86:87], v53 offset:10240
  v_mfma_f32_16x16x32_bf16 v[20:23], a[68:71], a[0:3], v[20:23]
  ds_read_b64_tr_b16 a[88:89], v54 offset:8192
  ds_read_b64_tr_b16 a[90:91], v54 offset:10240
  v_mfma_f32_16x16x32_bf16 v[36:39], a[68:71], a[4:7], v[36:39]
  ds_read_b64_tr_b16 a[92:93], v55 offset:8192
  ds_read_b64_tr_b16 a[94:95], v55 offset:10240
  v_mfma_f32_16x16x32_bf16 v[24:27], a[72:75], a[0:3], v[24:27]
  buffer_load_dwordx4 a[56:59], v3, s[16:19], s31 offen offset:2048
  v_mfma_f32_16x16x32_bf16 v[40:43], a[72:75], a[4:7], v[40:43]
  v_mfma_f32_16x16x32_bf16 v[28:31], a[76:79], a[0:3], v[28:31]
  buffer_load_dwordx4 a[60:63], v4, s[16:19], s31 offen offset:2048
  v_mfma_f32_16x16x32_bf16 v[44:47], a[76:79], a[4:7], v[44:47]
  s_waitcnt vmcnt(20) lgkmcnt(0)
  v_mfma_f32_16x16x32_bf16 v[16:19], a[80:83], a[8:11], v[16:19]
  ds_read_b64_tr_b16 a[64:65], v52 offset:16384
  ds_read_b64_tr_b16 a[66:67], v52 offset:18432
  v_mfma_f32_16x16x32_bf16 v[32:35], a[80:83], a[12:15], v[32:35]
  ds_read_b64_tr_b16 a[68:69], v53 offset:16384
  ds_read_b64_tr_b16 a[70:71], v53 offset:18432
  v_mfma_f32_16x16x32_bf16 v[20:23], a[84:87], a[8:11], v[20:23]
  ds_read_b64_tr_b16 a[72:73], v54 offset:16384
  ds_read_b64_tr_b16 a[74:75], v54 offset:18432
  v_mfma_f32_16x16x32_bf16 v[36:39], a[84:87], a[12:15], v[36:39]
  ds_read_b64_tr_b16 a[76:77], v55 offset:16384
  ds_read_b64_tr_b16 a[78:79], v55 offset:18432
  v_mfma_f32_16x16x32_bf16 v[24:27], a[88:91], a[8:11], v[24:27]
  s_add_u32 s31, s30, 65536
  buffer_load_dwordx4 a[0:3], v3, s[16:19], s31 offen offset:0
  v_mfma_f32_16x16x32_bf16 v[40:43], a[88:91], a[12:15], v[40:43]
  v_mfma_f32_16x16x32_bf16 v[28:31], a[92:95], a[8:11], v[28:31]
  buffer_load_dwordx4 a[4:7], v4, s[16:19], s31 offen offset:0
  v_mfma_f32_16x16x32_bf16 v[44:47], a[92:95], a[12:15], v[44:47]
  s_waitcnt vmcnt(20) lgkmcnt(0)
  v_mfma_f32_16x16x32_bf16 v[16:19], a[64:67], a[16:19], v[16:19]
  ds_read_b64_tr_b16 a[80:81], v52 offset:24576
  ds_read_b64_tr_b16 a[82:83], v52 offset:26624
  v_mfma_f32_16x16x32_bf16 v[32:35], a[64:67], a[20:23], v[32:35]
  ds_read_b64_tr_b16 a[84:85], v53 offset:24576
  ds_read_b64_tr_b16 a[86:87], v53 offset:26624
  v_mfma_f32_16x16x32_bf16 v[20:23], a[68:71], a[16:19], v[20:23]
  ds_read_b64_tr_b16 a[88:89], v54 offset:24576
  ds_read_b64_tr_b16 a[90:91], v54 offset:26624
  v_mfma_f32_16x16x32_bf16 v[36:39], a[68:71], a[20:23], v[36:39]
  ds_read_b64_tr_b16 a[92:93], v55 offset:24576
  ds_read_b64_tr_b16 a[94:95], v55 offset:26624
  v_mfma_f32_16x16x32_bf16 v[24:27], a[72:75], a[16:19], v[24:27]
  buffer_load_dwordx4 a[8:11], v3, s[16:19], s31 offen offset:2048
  v_mfma_f32_16x16x32_bf16 v[40:43], a[72:75], a[20:23], v[40:43]
  v_mfma_f32_16x16x32_bf16 v[28:31], a[76:79], a[16:19], v[28:31]
  buffer_load_dwordx4 a[12:15], v4, s[16:19], s31 offen offset:2048
  v_mfma_f32_16x16x32_bf16 v[44:47], a[76:79], a[20:23], v[44:47]
  s_waitcnt vmcnt(16) lgkmcnt(0)
  s_barrier
  v_mfma_f32_16x16x32_bf16 v[16:19], a[80:83], a[24:27], v[16:19]
  ds_read_b64_tr_b16 a[64:65], v52 offset:32768
  ds_read_b64_tr_b16 a[66:67], v52 offset:34816
  v_mfma_f32_16x16x32_bf16 v[32:35], a[80:83], a[28:31], v[32:35]
  ds_read_b64_tr_b16 a[68:69], v53 offset:32768
  ds_read_b64_tr_b16 a[70:71], v53 offset:34816
  v_mfma_f32_16x16x32_bf16 v[20:23], a[84:87], a[24:27], v[20:23]
  ds_read_b64_tr_b16 a[72:73], v54 offset:32768
  ds_read_b64_tr_b16 a[74:75], v54 offset:34816
  v_mfma_f32_16x16x32_bf16 v[36:39], a[84:87], a[28:31], v[36:39]
  ds_read_b64_tr_b16 a[76:77], v55 offset:32768
  ds_read_b64_tr_b16 a[78:79], v55 offset:34816
  v_mfma_f32_16x16x32_bf16 v[24:27], a[88:91], a[24:27], v[24:27]
  s_add_u32 s31, s30, 69632
  buffer_load_dwordx4 a[16:19], v3, s[16:19], s31 offen offset:0
  v_mfma_f32_16x16x32_bf16 v[40:43], a[88:91], a[28:31], v[40:43]
  v_mfma_f32_16x16x32_bf16 v[28:31], a[92:95], a[24:27], v[28:31]
  buffer_load_dwordx4 a[20:23], v4, s[16:19], s31 offen offset:0
  v_mfma_f32_16x16x32_bf16 v[44:47], a[92:95], a[28:31], v[44:47]
  s_add_u32 m0, s44, 65536
  s_add_u32 s40, s29, 327680
  buffer_load_dwordx4 v2, s[12:15], s40 offen offset:0 lds
  buffer_load_dwordx4 v2, s[12:15], s40 offen offset:1024 lds
  buffer_load_dwordx4 v2, s[12:15], s40 offen offset:2048 lds
  buffer_load_dwordx4 v2, s[12:15], s40 offen offset:3072 lds
  s_waitcnt vmcnt(20) lgkmcnt(0)
  v_mfma_f32_16x16x32_bf16 v[16:19], a[64:67], a[32:35], v[16:19]
  ds_read_b64_tr_b16 a[80:81], v52 offset:40960
  ds_read_b64_tr_b16 a[82:83], v52 offset:43008
  v_mfma_f32_16x16x32_bf16 v[32:35], a[64:67], a[36:39], v[32:35]
  ds_read_b64_tr_b16 a[84:85], v53 offset:40960
  ds_read_b64_tr_b16 a[86:87], v53 offset:43008
  v_mfma_f32_16x16x32_bf16 v[20:23], a[68:71], a[32:35], v[20:23]
  ds_read_b64_tr_b16 a[88:89], v54 offset:40960
  ds_read_b64_tr_b16 a[90:91], v54 offset:43008
  v_mfma_f32_16x16x32_bf16 v[36:39], a[68:71], a[36:39], v[36:39]
  ds_read_b64_tr_b16 a[92:93], v55 offset:40960
  ds_read_b64_tr_b16 a[94:95], v55 offset:43008
  v_mfma_f32_16x16x32_bf16 v[24:27], a[72:75], a[32:35], v[24:27]
  buffer_load_dwordx4 a[24:27], v3, s[16:19], s31 offen offset:2048
  v_mfma_f32_16x16x32_bf16 v[40:43], a[72:75], a[36:39], v[40:43]
  v_mfma_f32_16x16x32_bf16 v[28:31], a[76:79], a[32:35], v[28:31]
  buffer_load_dwordx4 a[28:31], v4, s[16:19], s31 offen offset:2048
  v_mfma_f32_16x16x32_bf16 v[44:47], a[76:79], a[36:39], v[44:47]
  s_waitcnt vmcnt(20) lgkmcnt(0)
  v_mfma_f32_16x16x32_bf16 v[16:19], a[80:83], a[40:43], v[16:19]
  ds_read_b64_tr_b16 a[64:65], v52 offset:49152
  ds_read_b64_tr_b16 a[66:67], v52 offset:51200
  v_mfma_f32_16x16x32_bf16 v[32:35], a[80:83], a[44:47], v[32:35]
  ds_read_b64_tr_b16 a[68:69], v53 offset:49152
  ds_read_b64_tr_b16 a[70:71], v53 offset:51200
  v_mfma_f32_16x16x32_bf16 v[20:23], a[84:87], a[40:43], v[20:23]
  ds_read_b64_tr_b16 a[72:73], v54 offset:49152
  ds_read_b64_tr_b16 a[74:75], v54 offset:51200
  v_mfma_f32_16x16x32_bf16 v[36:39], a[84:87], a[44:47], v[36:39]
  ds_read_b64_tr_b16 a[76:77], v55 offset:49152
  ds_read_b64_tr_b16 a[78:79], v55 offset:51200
  v_mfma_f32_16x16x32_bf16 v[24:27], a[88:91], a[40:43], v[24:27]
  s_add_u32 s31, s30, 73728
  buffer_load_dwordx4 a[32:35], v3, s[16:19], s31 offen offset:0
  v_mfma_f32_16x16x32_bf16 v[40:43], a[88:91], a[44:47], v[40:43]
  v_mfma_f32_16x16x32_bf16 v[28:31], a[92:95], a[40:43], v[28:31]
  buffer_load_dwordx4 a[36:39], v4, s[16:19], s31 offen offset:0
  v_mfma_f32_16x16x32_bf16 v[44:47], a[92:95], a[44:47], v[44:47]
  s_waitcnt vmcnt(20) lgkmcnt(0)
  v_mfma_f32_16x16x32_bf16 v[16:19], a[64:67], a[48:51], v[16:19]
  ds_read_b64_tr_b16 a[80:81], v52 offset:57344
  ds_read_b64_tr_b16 a[82:83], v52 offset:59392
  v_mfma_f32_16x16x32_bf16 v[32:35], a[64:67], a[52:55], v[32:35]
  ds_read_b64_tr_b16 a[84:85], v53 offset:57344
  ds_read_b64_tr_b16 a[86:87], v53 offset:59392
  v_mfma_f32_16x16x32_bf16 v[20:23], a[68:71], a[48:51], v[20:23]
  ds_read_b64_tr_b16 a[88:89], v54 offset:57344
  ds_read_b64_tr_b16 a[90:91], v54 offset:59392
  v_mfma_f32_16x16x32_bf16 v[36:39], a[68:71], a[52:55], v[36:39]
  ds_read_b64_tr_b16 a[92:93], v55 offset:57344
  ds_read_b64_tr_b16 a[94:95], v55 offset:59392
  v_mfma_f32_16x16x32_bf16 v[24:27], a[72:75], a[48:51], v[24:27]
  buffer_load_dwordx4 a[40:43], v3, s[16:19], s31 offen offset:2048
  v_mfma_f32_16x16x32_bf16 v[40:43], a[72:75], a[52:55], v[40:43]
  v_mfma_f32_16x16x32_bf16 v[28:31], a[76:79], a[48:51], v[28:31]
  buffer_load_dwordx4 a[44:47], v4, s[16:19], s31 offen offset:2048
  v_mfma_f32_16x16x32_bf16 v[44:47], a[76:79], a[52:55], v[44:47]
  s_waitcnt vmcnt(16) lgkmcnt(0)
  s_barrier
  v_mfma_f32_16x16x32_bf16 v[16:19], a[80:83], a[56:59], v[16:19]
  ds_read_b64_tr_b16 a[64:65], v48 offset:0
  ds_read_b64_tr_b16 a[66:67], v48 offset:2048
  v_mfma_f32_16x16x32_bf16 v[32:35], a[80:83], a[60:63], v[32:35]
  ds_read_b64_tr_b16 a[68:69], v49 offset:0
  ds_read_b64_tr_b16 a[70:71], v49 offset:2048
  v_mfma_f32_16x16x32_bf16 v[20:23], a[84:87], a[56:59], v[20:23]
  ds_read_b64_tr_b16 a[72:73], v50 offset:0
  ds_read_b64_tr_b16 a[74:75], v50 offset:2048
  v_mfma_f32_16x16x32_bf16 v[36:39], a[84:87], a[60:63], v[36:39]
  ds_read_b64_tr_b16 a[76:77], v51 offset:0
  ds_read_b64_tr_b16 a[78:79], v51 offset:2048
  v_mfma_f32_16x16x32_bf16 v[24:27], a[88:91], a[56:59], v[24:27]
  s_add_u32 s31, s30, 77824
  buffer_load_dwordx4 a[48:51], v3, s[16:19], s31 offen offset:0
  v_mfma_f32_16x16x32_bf16 v[40:43], a[88:91], a[60:63], v[40:43]
  v_mfma_f32_16x16x32_bf16 v[28:31], a[92:95], a[56:59], v[28:31]
  buffer_load_dwordx4 a[52:55], v4, s[16:19], s31 offen offset:0
  v_mfma_f32_16x16x32_bf16 v[44:47], a[92:95], a[60:63], v[44:47]
  s_add_u32 m0, s44, 98304
  s_add_u32 s40, s29, 360448
  buffer_load_dwordx4 v2, s[12:15], s40 offen offset:0 lds
  buffer_load_dwordx4 v2, s[12:15], s40 offen offset:1024 lds
  buffer_load_dwordx4 v2, s[12:15], s40 offen offset:2048 lds
  buffer_load_dwordx4 v2, s[12:15], s40 offen offset:3072 lds
  s_waitcnt vmcnt(20) lgkmcnt(0)
  v_mfma_f32_16x16x32_bf16 v[16:19], a[64:67], a[0:3], v[16:19]
  ds_read_b64_tr_b16 a[80:81], v48 offset:8192
  ds_read_b64_tr_b16 a[82:83], v48 offset:10240
  v_mfma_f32_16x16x32_bf16 v[32:35], a[64:67], a[4:7], v[32:35]
  ds_read_b64_tr_b16 a[84:85], v49 offset:8192
  ds_read_b64_tr_b16 a[86:87], v49 offset:10240
  v_mfma_f32_16x16x32_bf16 v[20:23], a[68:71], a[0:3], v[20:23]
  ds_read_b64_tr_b16 a[88:89], v50 offset:8192
  ds_read_b64_tr_b16 a[90:91], v50 offset:10240
  v_mfma_f32_16x16x32_bf16 v[36:39], a[68:71], a[4:7], v[36:39]
  ds_read_b64_tr_b16 a[92:93], v51 offset:8192
  ds_read_b64_tr_b16 a[94:95], v51 offset:10240
  v_mfma_f32_16x16x32_bf16 v[24:27], a[72:75], a[0:3], v[24:27]
  buffer_load_dwordx4 a[56:59], v3, s[16:19], s31 offen offset:2048
  v_mfma_f32_16x16x32_bf16 v[40:43], a[72:75], a[4:7], v[40:43]
  v_mfma_f32_16x16x32_bf16 v[28:31], a[76:79], a[0:3], v[28:31]
  buffer_load_dwordx4 a[60:63], v4, s[16:19], s31 offen offset:2048
  v_mfma_f32_16x16x32_bf16 v[44:47], a[76:79], a[4:7], v[44:47]
  s_waitcnt vmcnt(20) lgkmcnt(0)
  v_mfma_f32_16x16x32_bf16 v[16:19], a[80:83], a[8:11], v[16:19]
  ds_read_b64_tr_b16 a[64:65], v48 offset:16384
  ds_read_b64_tr_b16 a[66:67], v48 offset:18432
  v_mfma_f32_16x16x32_bf16 v[32:35], a[80:83], a[12:15], v[32:35]
  ds_read_b64_tr_b16 a[68:69], v49 offset:16384
  ds_read_b64_tr_b16 a[70:71], v49 offset:18432
  v_mfma_f32_16x16x32_bf16 v[20:23], a[84:87], a[8:11], v[20:23]
  ds_read_b64_tr_b16 a[72:73], v50 offset:16384
  ds_read_b64_tr_b16 a[74:75], v50 offset:18432
  v_mfma_f32_16x16x32_bf16 v[36:39], a[84:87], a[12:15], v[36:39]
  ds_read_b64_tr_b16 a[76:77], v51 offset:16384
  ds_read_b64_tr_b16 a[78:79], v51 offset:18432
  v_mfma_f32_16x16x32_bf16 v[24:27], a[88:91], a[8:11], v[24:27]
  s_add_u32 s31, s30, 81920
  buffer_load_dwordx4 a[0:3], v3, s[16:19], s31 offen offset:0
  v_mfma_f32_16x16x32_bf16 v[40:43], a[88:91], a[12:15], v[40:43]
  v_mfma_f32_16x16x32_bf16 v[28:31], a[92:95], a[8:11], v[28:31]
  buffer_load_dwordx4 a[4:7], v4, s[16:19], s31 offen offset:0
  v_mfma_f32_16x16x32_bf16 v[44:47], a[92:95], a[12:15], v[44:47]
  s_waitcnt vmcnt(20) lgkmcnt(0)
  v_mfma_f32_16x16x32_bf16 v[16:19], a[64:67], a[16:19], v[16:19]
  ds_read_b64_tr_b16 a[80:81], v48 offset:24576
  ds_read_b64_tr_b16 a[82:83], v48 offset:26624
  v_mfma_f32_16x16x32_bf16 v[32:35], a[64:67], a[20:23], v[32:35]
  ds_read_b64_tr_b16 a[84:85], v49 offset:24576
  ds_read_b64_tr_b16 a[86:87], v49 offset:26624
  v_mfma_f32_16x16x32_bf16 v[20:23], a[68:71], a[16:19], v[20:23]
  ds_read_b64_tr_b16 a[88:89], v50 offset:24576
  ds_read_b64_tr_b16 a[90:91], v50 offset:26624
  v_mfma_f32_16x16x32_bf16 v[36:39], a[68:71], a[20:23], v[36:39]
  ds_read_b64_tr_b16 a[92:93], v51 offset:24576
  ds_read_b64_tr_b16 a[94:95], v51 offset:26624
  v_mfma_f32_16x16x32_bf16 v[24:27], a[72:75], a[16:19], v[24:27]
  buffer_load_dwordx4 a[8:11], v3, s[16:19], s31 offen offset:2048
  v_mfma_f32_16x16x32_bf16 v[40:43], a[72:75], a[20:23], v[40:43]
  v_mfma_f32_16x16x32_bf16 v[28:31], a[76:79], a[16:19], v[28:31]
  buffer_load_dwordx4 a[12:15], v4, s[16:19], s31 offen offset:2048
  v_mfma_f32_16x16x32_bf16 v[44:47], a[76:79], a[20:23], v[44:47]
  s_waitcnt vmcnt(16) lgkmcnt(0)
  s_barrier
  v_mfma_f32_16x16x32_bf16 v[16:19], a[80:83], a[24:27], v[16:19]
  ds_read_b64_tr_b16 a[64:65], v48 offset:32768
  ds_read_b64_tr_b16 a[66:67], v48 offset:34816
  v_mfma_f32_16x16x32_bf16 v[32:35], a[80:83], a[28:31], v[32:35]
  ds_read_b64_tr_b16 a[68:69], v49 offset:32768
  ds_read_b64_tr_b16 a[70:71], v49 offset:34816
  v_mfma_f32_16x16x32_bf16 v[20:23], a[84:87], a[24:27], v[20:23]
  ds_read_b64_tr_b16 a[72:73], v50 offset:32768
  ds_read_b64_tr_b16 a[74:75], v50 offset:34816
  v_mfma_f32_16x16x32_bf16 v[36:39], a[84:87], a[28:31], v[36:39]
  ds_read_b64_tr_b16 a[76:77], v51 offset:32768
  ds_read_b64_tr_b16 a[78:79], v51 offset:34816
  v_mfma_f32_16x16x32_bf16 v[24:27], a[88:91], a[24:27], v[24:27]
  s_add_u32 s31, s30, 86016
  buffer_load_dwordx4 a[16:19], v3, s[16:19], s31 offen offset:0
  v_mfma_f32_16x16x32_bf16 v[40:43], a[88:91], a[28:31], v[40:43]
  v_mfma_f32_16x16x32_bf16 v[28:31], a[92:95], a[24:27], v[28:31]
  buffer_load_dwordx4 a[20:23], v4, s[16:19], s31 offen offset:0
  v_mfma_f32_16x16x32_bf16 v[44:47], a[92:95], a[28:31], v[44:47]
  s_add_u32 m0, s44, 0
  s_add_u32 s40, s29, 393216
  buffer_load_dwordx4 v2, s[12:15], s40 offen offset:0 lds
  buffer_load_dwordx4 v2, s[12:15], s40 offen offset:1024 lds
  buffer_load_dwordx4 v2, s[12:15], s40 offen offset:2048 lds
  buffer_load_dwordx4 v2, s[12:15], s40 offen offset:3072 lds
  s_waitcnt vmcnt(20) lgkmcnt(0)
  v_mfma_f32_16x16x32_bf16 v[16:19], a[64:67], a[32:35], v[16:19]
  ds_read_b64_tr_b16 a[80:81], v48 offset:40960
  ds_read_b64_tr_b16 a[82:83], v48 offset:43008
  v_mfma_f32_16x16x32_bf16 v[32:35], a[64:67], a[36:39], v[32:35]
  ds_read_b64_tr_b16 a[84:85], v49 offset:40960
  ds_read_b64_tr_b16 a[86:87], v49 offset:43008
  v_mfma_f32_16x16x32_bf16 v[20:23], a[68:71], a[32:35], v[20:23]
  ds_read_b64_tr_b16 a[88:89], v50 offset:40960
  ds_read_b64_tr_b16 a[90:91], v50 offset:43008
  v_mfma_f32_16x16x32_bf16 v[36:39], a[68:71], a[36:39], v[36:39]
  ds_read_b64_tr_b16 a[92:93], v51 offset:40960
  ds_read_b64_tr_b16 a[94:95], v51 offset:43008
  v_mfma_f32_16x16x32_bf16 v[24:27], a[72:75], a[32:35], v[24:27]
  buffer_load_dwordx4 a[24:27], v3, s[16:19], s31 offen offset:2048
  v_mfma_f32_16x16x32_bf16 v[40:43], a[72:75], a[36:39], v[40:43]
  v_mfma_f32_16x16x32_bf16 v[28:31], a[76:79], a[32:35], v[28:31]
  buffer_load_dwordx4 a[28:31], v4, s[16:19], s31 offen offset:2048
  v_mfma_f32_16x16x32_bf16 v[44:47], a[76:79], a[36:39], v[44:47]
  s_waitcnt vmcnt(20) lgkmcnt(0)
  v_mfma_f32_16x16x32_bf16 v[16:19], a[80:83], a[40:43], v[16:19]
  ds_read_b64_tr_b16 a[64:65], v48 offset:49152
  ds_read_b64_tr_b16 a[66:67], v48 offset:51200
  v_mfma_f32_16x16x32_bf16 v[32:35], a[80:83], a[44:47], v[32:35]
  ds_read_b64_tr_b16 a[68:69], v49 offset:49152
  ds_read_b64_tr_b16 a[70:71], v49 offset:51200
  v_mfma_f32_16x16x32_bf16 v[20:23], a[84:87], a[40:43], v[20:23]
  ds_read_b64_tr_b16 a[72:73], v50 offset:49152
  ds_read_b64_tr_b16 a[74:75], v50 offset:51200
  v_mfma_f32_16x16x32_bf16 v[36:39], a[84:87], a[44:47], v[36:39]
  ds_read_b64_tr_b16 a[76:77], v51 offset:49152
  ds_read_b64_tr_b16 a[78:79], v51 offset:51200
  v_mfma_f32_16x16x32_bf16 v[24:27], a[88:91], a[40:43], v[24:27]
  s_add_u32 s31, s30, 90112
  buffer_load_dwordx4 a[32:35], v3, s[16:19], s31 offen offset:0
  v_mfma_f32_16x16x32_bf16 v[40:43], a[88:91], a[44:47], v[40:43]
  v_mfma_f32_16x16x32_bf16 v[28:31], a[92:95], a[40:43], v[28:31]
  buffer_load_dwordx4 a[36:39], v4, s[16:19], s31 offen offset:0
  v_mfma_f32_16x16x32_bf16 v[44:47], a[92:95], a[44:47], v[44:47]
  s_waitcnt vmcnt(20) lgkmcnt(0)
  v_mfma_f32_16x16x32_bf16 v[16:19], a[64:67], a[48:51], v[16:19]
  ds_read_b64_tr_b16 a[80:81], v48 offset:57344
  ds_read_b64_tr_b16 a[82:83], v48 offset:59392
  v_mfma_f32_16x16x32_bf16 v[32:35], a[64:67], a[52:55], v[32:35]
  ds_read_b64_tr_b16 a[84:85], v49 offset:57344
  ds_read_b64_tr_b16 a[86:87], v49 offset:59392
  v_mfma_f32_16x16x32_bf16 v[20:23], a[68:71], a[48:51], v[20:23]
  ds_read_b64_tr_b16 a[88:89], v50 offset:57344
  ds_read_b64_tr_b16 a[90:91], v50 offset:59392
  v_mfma_f32_16x16x32_bf16 v[36:39], a[68:71], a[52:55], v[36:39]
  ds_read_b64_tr_b16 a[92:93], v51 offset:57344
  ds_read_b64_tr_b16 a[94:95], v51 offset:59392
  v_mfma_f32_16x16x32_bf16 v[24:27], a[72:75], a[48:51], v[24:27]
  buffer_load_dwordx4 a[40:43], v3, s[16:19], s31 offen offset:2048
  v_mfma_f32_16x16x32_bf16 v[40:43], a[72:75], a[52:55], v[40:43]
  v_mfma_f32_16x16x32_bf16 v[28:31], a[76:79], a[48:51], v[28:31]
  buffer_load_dwordx4 a[44:47], v4, s[16:19], s31 offen offset:2048
  v_mfma_f32_16x16x32_bf16 v[44:47], a[76:79], a[52:55], v[44:47]
  s_waitcnt vmcnt(16) lgkmcnt(0)
  s_barrier
  v_mfma_f32_16x16x32_bf16 v[16:19], a[80:83], a[56:59], v[16:19]
  ds_read_b64_tr_b16 a[64:65], v52 offset:0
  ds_read_b64_tr_b16 a[66:67], v52 offset:2048
  v_mfma_f32_16x16x32_bf16 v[32:35], a[80:83], a[60:63], v[32:35]
  ds_read_b64_tr_b16 a[68:69], v53 offset:0
  ds_read_b64_tr_b16 a[70:71], v53 offset:2048
  v_mfma_f32_16x16x32_bf16 v[20:23], a[84:87], a[56:59], v[20:23]
  ds_read_b64_tr_b16 a[72:73], v54 offset:0
  ds_read_b64_tr_b16 a[74:75], v54 offset:2048
  v_mfma_f32_16x16x32_bf16 v[36:39], a[84:87], a[60:63], v[36:39]
  ds_read_b64_tr_b16 a[76:77], v55 offset:0
  ds_read_b64_tr_b16 a[78:79], v55 offset:2048
  v_mfma_f32_16x16x32_bf16 v[24:27], a[88:91], a[56:59], v[24:27]
  s_add_u32 s31, s30, 94208
  buffer_load_dwordx4 a[48:51], v3, s[16:19], s31 offen offset:0
  v_mfma_f32_16x16x32_bf16 v[40:43], a[88:91], a[60:63], v[40:43]
  v_mfma_f32_16x16x32_bf16 v[28:31], a[92:95], a[56:59], v[28:31]
  buffer_load_dwordx4 a[52:55], v4, s[16:19], s31 offen offset:0
  v_mfma_f32_16x16x32_bf16 v[44:47], a[92:95], a[60:63], v[44:47]
  s_add_u32 m0, s44, 32768
  s_add_u32 s40, s29, 425984
  buffer_load_dwordx4 v2, s[12:15], s40 offen offset:0 lds
  buffer_load_dwordx4 v2, s[12:15], s40 offen offset:1024 lds
  buffer_load_dwordx4 v2, s[12:15], s40 offen offset:2048 lds
  buffer_load_dwordx4 v2, s[12:15], s40 offen offset:3072 lds
  s_waitcnt vmcnt(20) lgkmcnt(0)
  v_mfma_f32_16x16x32_bf16 v[16:19], a[64:67], a[0:3], v[16:19]
  ds_read_b64_tr_b16 a[80:81], v52 offset:8192
  ds_read_b64_tr_b16 a[82:83], v52 offset:10240
  v_mfma_f32_16x16x32_bf16 v[32:35], a[64:67], a[4:7], v[32:35]
  ds_read_b64_tr_b16 a[84:85], v53 offset:8192
  ds_read_b64_tr_b16 a[86:87], v53 offset:10240
  v_mfma_f32_16x16x32_bf16 v[20:23], a[68:71], a[0:3], v[20:23]
  ds_read_b64_tr_b16 a[88:89], v54 offset:8192
  ds_read_b64_tr_b16 a[90:91], v54 offset:10240
  v_mfma_f32_16x16x32_bf16 v[36:39], a[68:71], a[4:7], v[36:39]
  ds_read_b64_tr_b16 a[92:93], v55 offset:8192
  ds_read_b64_tr_b16 a[94:95], v55 offset:10240
  v_mfma_f32_16x16x32_bf16 v[24:27], a[72:75], a[0:3], v[24:27]
  buffer_load_dwordx4 a[56:59], v3, s[16:19], s31 offen offset:2048
  v_mfma_f32_16x16x32_bf16 v[40:43], a[72:75], a[4:7], v[40:43]
  v_mfma_f32_16x16x32_bf16 v[28:31], a[76:79], a[0:3], v[28:31]
  buffer_load_dwordx4 a[60:63], v4, s[16:19], s31 offen offset:2048
  v_mfma_f32_16x16x32_bf16 v[44:47], a[76:79], a[4:7], v[44:47]
  s_waitcnt vmcnt(20) lgkmcnt(0)
  v_mfma_f32_16x16x32_bf16 v[16:19], a[80:83], a[8:11], v[16:19]
  ds_read_b64_tr_b16 a[64:65], v52 offset:16384
  ds_read_b64_tr_b16 a[66:67], v52 offset:18432
  v_mfma_f32_16x16x32_bf16 v[32:35], a[80:83], a[12:15], v[32:35]
  ds_read_b64_tr_b16 a[68:69], v53 offset:16384
  ds_read_b64_tr_b16 a[70:71], v53 offset:18432
  v_mfma_f32_16x16x32_bf16 v[20:23], a[84:87], a[8:11], v[20:23]
  ds_read_b64_tr_b16 a[72:73], v54 offset:16384
  ds_read_b64_tr_b16 a[74:75], v54 offset:18432
  v_mfma_f32_16x16x32_bf16 v[36:39], a[84:87], a[12:15], v[36:39]
  ds_read_b64_tr_b16 a[76:77], v55 offset:16384
  ds_read_b64_tr_b16 a[78:79], v55 offset:18432
  v_mfma_f32_16x16x32_bf16 v[24:27], a[88:91], a[8:11], v[24:27]
  s_add_u32 s31, s30, 98304
  buffer_load_dwordx4 a[0:3], v3, s[16:19], s31 offen offset:0
  v_mfma_f32_16x16x32_bf16 v[40:43], a[88:91], a[12:15], v[40:43]
  v_mfma_f32_16x16x32_bf16 v[28:31], a[92:95], a[8:11], v[28:31]
  buffer_load_dwordx4 a[4:7], v4, s[16:19], s31 offen offset:0
  v_mfma_f32_16x16x32_bf16 v[44:47], a[92:95], a[12:15], v[44:47]
  s_waitcnt vmcnt(20) lgkmcnt(0)
  v_mfma_f32_16x16x32_bf16 v[16:19], a[64:67], a[16:19], v[16:19]
  ds_read_b64_tr_b16 a[80:81], v52 offset:24576
  ds_read_b64_tr_b16 a[82:83], v52 offset:26624
  v_mfma_f32_16x16x32_bf16 v[32:35], a[64:67], a[20:23], v[32:35]
  ds_read_b64_tr_b16 a[84:85], v53 offset:24576
  ds_read_b64_tr_b16 a[86:87], v53 offset:26624
  v_mfma_f32_16x16x32_bf16 v[20:23], a[68:71], a[16:19], v[20:23]
  ds_read_b64_tr_b16 a[88:89], v54 offset:24576
  ds_read_b64_tr_b16 a[90:91], v54 offset:26624
  v_mfma_f32_16x16x32_bf16 v[36:39], a[68:71], a[20:23], v[36:39]
  ds_read_b64_tr_b16 a[92:93], v55 offset:24576
  ds_read_b64_tr_b16 a[94:95], v55 offset:26624
  v_mfma_f32_16x16x32_bf16 v[24:27], a[72:75], a[16:19], v[24:27]
  buffer_load_dwordx4 a[8:11], v3, s[16:19], s31 offen offset:2048
  v_mfma_f32_16x16x32_bf16 v[40:43], a[72:75], a[20:23], v[40:43]
  v_mfma_f32_16x16x32_bf16 v[28:31], a[76:79], a[16:19], v[28:31]
  buffer_load_dwordx4 a[12:15], v4, s[16:19], s31 offen offset:2048
  v_mfma_f32_16x16x32_bf16 v[44:47], a[76:79], a[20:23], v[44:47]
  s_waitcnt vmcnt(16) lgkmcnt(0)
  s_barrier
  v_mfma_f32_16x16x32_bf16 v[16:19], a[80:83], a[24:27], v[16:19]
  ds_read_b64_tr_b16 a[64:65], v52 offset:32768
  ds_read_b64_tr_b16 a[66:67], v52 offset:34816
  v_mfma_f32_16x16x32_bf16 v[32:35], a[80:83], a[28:31], v[32:35]
  ds_read_b64_tr_b16 a[68:69], v53 offset:32768
  ds_read_b64_tr_b16 a[70:71], v53 offset:34816
  v_mfma_f32_16x16x32_bf16 v[20:23], a[84:87], a[24:27], v[20:23]
  ds_read_b64_tr_b16 a[72:73], v54 offset:32768
  ds_read_b64_tr_b16 a[74:75], v54 offset:34816
  v_mfma_f32_16x16x32_bf16 v[36:39], a[84:87], a[28:31], v[36:39]
  ds_read_b64_tr_b16 a[76:77], v55 offset:32768
  ds_read_b64_tr_b16 a[78:79], v55 offset:34816
  v_mfma_f32_16x16x32_bf16 v[24:27], a[88:91], a[24:27], v[24:27]
  s_add_u32 s31, s30, 102400
  buffer_load_dwordx4 a[16:19], v3, s[16:19], s31 offen offset:0
  v_mfma_f32_16x16x32_bf16 v[40:43], a[88:91], a[28:31], v[40:43]
  v_mfma_f32_16x16x32_bf16 v[28:31], a[92:95], a[24:27], v[28:31]
  buffer_load_dwordx4 a[20:23], v4, s[16:19], s31 offen offset:0
  v_mfma_f32_16x16x32_bf16 v[44:47], a[92:95], a[28:31], v[44:47]
  s_waitcnt vmcnt(16) lgkmcnt(0)
  v_mfma_f32_16x16x32_bf16 v[16:19], a[64:67], a[32:35], v[16:19]
  ds_read_b64_tr_b16 a[80:81], v52 offset:40960
  ds_read_b64_tr_b16 a[82:83], v52 offset:43008
  v_mfma_f32_16x16x32_bf16 v[32:35], a[64:67], a[36:39], v[32:35]
  ds_read_b64_tr_b16 a[84:85], v53 offset:40960
  ds_read_b64_tr_b16 a[86:87], v53 offset:43008
  v_mfma_f32_16x16x32_bf16 v[20:23], a[68:71], a[32:35], v[20:23]
  ds_read_b64_tr_b16 a[88:89], v54 offset:40960
  ds_read_b64_tr_b16 a[90:91], v54 offset:43008
  v_mfma_f32_16x16x32_bf16 v[36:39], a[68:71], a[36:39], v[36:39]
  ds_read_b64_tr_b16 a[92:93], v55 offset:40960
  ds_read_b64_tr_b16 a[94:95], v55 offset:43008
  v_mfma_f32_16x16x32_bf16 v[24:27], a[72:75], a[32:35], v[24:27]
  buffer_load_dwordx4 a[24:27], v3, s[16:19], s31 offen offset:2048
  v_mfma_f32_16x16x32_bf16 v[40:43], a[72:75], a[36:39], v[40:43]
  v_mfma_f32_16x16x32_bf16 v[28:31], a[76:79], a[32:35], v[28:31]
  buffer_load_dwordx4 a[28:31], v4, s[16:19], s31 offen offset:2048
  v_mfma_f32_16x16x32_bf16 v[44:47], a[76:79], a[36:39], v[44:47]
  s_waitcnt vmcnt(16) lgkmcnt(0)
  v_mfma_f32_16x16x32_bf16 v[16:19], a[80:83], a[40:43], v[16:19]
  ds_read_b64_tr_b16 a[64:65], v52 offset:49152
  ds_read_b64_tr_b16 a[66:67], v52 offset:51200
  v_mfma_f32_16x16x32_bf16 v[32:35], a[80:83], a[44:47], v[32:35]
  ds_read_b64_tr_b16 a[68:69], v53 offset:49152
  ds_read_b64_tr_b16 a[70:71], v53 offset:51200
  v_mfma_f32_16x16x32_bf16 v[20:23], a[84:87], a[40:43], v[20:23]
  ds_read_b64_tr_b16 a[72:73], v54 offset:49152
  ds_read_b64_tr_b16 a[74:75], v54 offset:51200
  v_mfma_f32_16x16x32_bf16 v[36:39], a[84:87], a[44:47], v[36:39]
  ds_read_b64_tr_b16 a[76:77], v55 offset:49152
  ds_read_b64_tr_b16 a[78:79], v55 offset:51200
  v_mfma_f32_16x16x32_bf16 v[24:27], a[88:91], a[40:43], v[24:27]
  s_add_u32 s31, s30, 106496
  buffer_load_dwordx4 a[32:35], v3, s[16:19], s31 offen offset:0
  v_mfma_f32_16x16x32_bf16 v[40:43], a[88:91], a[44:47], v[40:43]
  v_mfma_f32_16x16x32_bf16 v[28:31], a[92:95], a[40:43], v[28:31]
  buffer_load_dwordx4 a[36:39], v4, s[16:19], s31 offen offset:0
  v_mfma_f32_16x16x32_bf16 v[44:47], a[92:95], a[44:47], v[44:47]
  s_waitcnt vmcnt(16) lgkmcnt(0)
  v_mfma_f32_16x16x32_bf16 v[16:19], a[64:67], a[48:51], v[16:19]
  ds_read_b64_tr_b16 a[80:81], v52 offset:57344
  ds_read_b64_tr_b16 a[82:83], v52 offset:59392
  v_mfma_f32_16x16x32_bf16 v[32:35], a[64:67], a[52:55], v[32:35]
  ds_read_b64_tr_b16 a[84:85], v53 offset:57344
  ds_read_b64_tr_b16 a[86:87], v53 offset:59392
  v_mfma_f32_16x16x32_bf16 v[20:23], a[68:71], a[48:51], v[20:23]
  ds_read_b64_tr_b16 a[88:89], v54 offset:57344
  ds_read_b64_tr_b16 a[90:91], v54 offset:59392
  v_mfma_f32_16x16x32_bf16 v[36:39], a[68:71], a[52:55], v[36:39]
  ds_read_b64_tr_b16 a[92:93], v55 offset:57344
  ds_read_b64_tr_b16 a[94:95], v55 offset:59392
  v_mfma_f32_16x16x32_bf16 v[24:27], a[72:75], a[48:51], v[24:27]
  buffer_load_dwordx4 a[40:43], v3, s[16:19], s31 offen offset:2048
  v_mfma_f32_16x16x32_bf16 v[40:43], a[72:75], a[52:55], v[40:43]
  v_mfma_f32_16x16x32_bf16 v[28:31], a[76:79], a[48:51], v[28:31]
  buffer_load_dwordx4 a[44:47], v4, s[16:19], s31 offen offset:2048
  v_mfma_f32_16x16x32_bf16 v[44:47], a[76:79], a[52:55], v[44:47]
  s_waitcnt vmcnt(12) lgkmcnt(0)
  s_barrier
  v_mfma_f32_16x16x32_bf16 v[16:19], a[80:83], a[56:59], v[16:19]
  ds_read_b64_tr_b16 a[64:65], v48 offset:0
  ds_read_b64_tr_b16 a[66:67], v48 offset:2048
  v_mfma_f32_16x16x32_bf16 v[32:35], a[80:83], a[60:63], v[32:35]
  ds_read_b64_tr_b16 a[68:69], v49 offset:0
  ds_read_b64_tr_b16 a[70:71], v49 offset:2048
  v_mfma_f32_16x16x32_bf16 v[20:23], a[84:87], a[56:59], v[20:23]
  ds_read_b64_tr_b16 a[72:73], v50 offset:0
  ds_read_b64_tr_b16 a[74:75], v50 offset:2048
  v_mfma_f32_16x16x32_bf16 v[36:39], a[84:87], a[60:63], v[36:39]
  ds_read_b64_tr_b16 a[76:77], v51 offset:0
  ds_read_b64_tr_b16 a[78:79], v51 offset:2048
  v_mfma_f32_16x16x32_bf16 v[24:27], a[88:91], a[56:59], v[24:27]
  s_add_u32 s31, s30, 110592
  buffer_load_dwordx4 a[48:51], v3, s[16:19], s31 offen offset:0
  v_mfma_f32_16x16x32_bf16 v[40:43], a[88:91], a[60:63], v[40:43]
  v_mfma_f32_16x16x32_bf16 v[28:31], a[92:95], a[56:59], v[28:31]
  buffer_load_dwordx4 a[52:55], v4, s[16:19], s31 offen offset:0
  v_mfma_f32_16x16x32_bf16 v[44:47], a[92:95], a[60:63], v[44:47]
  s_waitcnt vmcnt(12) lgkmcnt(0)
  v_mfma_f32_16x16x32_bf16 v[16:19], a[64:67], a[0:3], v[16:19]
  ds_read_b64_tr_b16 a[80:81], v48 offset:8192
  ds_read_b64_tr_b16 a[82:83], v48 offset:10240
  v_mfma_f32_16x16x32_bf16 v[32:35], a[64:67], a[4:7], v[32:35]
  ds_read_b64_tr_b16 a[84:85], v49 offset:8192
  ds_read_b64_tr_b16 a[86:87], v49 offset:10240
  v_mfma_f32_16x16x32_bf16 v[20:23], a[68:71], a[0:3], v[20:23]
  ds_read_b64_tr_b16 a[88:89], v50 offset:8192
  ds_read_b64_tr_b16 a[90:91], v50 offset:10240
  v_mfma_f32_16x16x32_bf16 v[36:39], a[68:71], a[4:7], v[36:39]
  ds_read_b64_tr_b16 a[92:93], v51 offset:8192
  ds_read_b64_tr_b16 a[94:95], v51 offset:10240
  v_mfma_f32_16x16x32_bf16 v[24:27], a[72:75], a[0:3], v[24:27]
  buffer_load_dwordx4 a[56:59], v3, s[16:19], s31 offen offset:2048
  v_mfma_f32_16x16x32_bf16 v[40:43], a[72:75], a[4:7], v[40:43]
  v_mfma_f32_16x16x32_bf16 v[28:31], a[76:79], a[0:3], v[28:31]
  buffer_load_dwordx4 a[60:63], v4, s[16:19], s31 offen offset:2048
  v_mfma_f32_16x16x32_bf16 v[44:47], a[76:79], a[4:7], v[44:47]
  s_waitcnt vmcnt(12) lgkmcnt(0)
  v_mfma_f32_16x16x32_bf16 v[16:19], a[80:83], a[8:11], v[16:19]
  ds_read_b64_tr_b16 a[64:65], v48 offset:16384
  ds_read_b64_tr_b16 a[66:67], v48 offset:18432
  v_mfma_f32_16x16x32_bf16 v[32:35], a[80:83], a[12:15], v[32:35]
  ds_read_b64_tr_b16 a[68:69], v49 offset:16384
  ds_read_b64_tr_b16 a[70:71], v49 offset:18432
  v_mfma_f32_16x16x32_bf16 v[20:23], a[84:87], a[8:11], v[20:23]
  ds_read_b64_tr_b16 a[72:73], v50 offset:16384
  ds_read_b64_tr_b16 a[74:75], v50 offset:18432
  v_mfma_f32_16x16x32_bf16 v[36:39], a[84:87], a[12:15], v[36:39]
  ds_read_b64_tr_b16 a[76:77], v51 offset:16384
  ds_read_b64_tr_b16 a[78:79], v51 offset:18432
  v_mfma_f32_16x16x32_bf16 v[24:27], a[88:91], a[8:11], v[24:27]
  v_mfma_f32_16x16x32_bf16 v[40:43], a[88:91], a[12:15], v[40:43]
  v_mfma_f32_16x16x32_bf16 v[28:31], a[92:95], a[8:11], v[28:31]
  v_mfma_f32_16x16x32_bf16 v[44:47], a[92:95], a[12:15], v[44:47]
  s_waitcnt vmcnt(10) lgkmcnt(0)
  v_mfma_f32_16x16x32_bf16 v[16:19], a[64:67], a[16:19], v[16:19]
  ds_read_b64_tr_b16 a[80:81], v48 offset:24576
  ds_read_b64_tr_b16 a[82:83], v48 offset:26624
  v_mfma_f32_16x16x32_bf16 v[32:35], a[64:67], a[20:23], v[32:35]
  ds_read_b64_tr_b16 a[84:85], v49 offset:24576
  ds_read_b64_tr_b16 a[86:87], v49 offset:26624
  v_mfma_f32_16x16x32_bf16 v[20:23], a[68:71], a[16:19], v[20:23]
  ds_read_b64_tr_b16 a[88:89], v50 offset:24576
  ds_read_b64_tr_b16 a[90:91], v50 offset:26624
  v_mfma_f32_16x16x32_bf16 v[36:39], a[68:71], a[20:23], v[36:39]
  ds_read_b64_tr_b16 a[92:93], v51 offset:24576
  ds_read_b64_tr_b16 a[94:95], v51 offset:26624
  v_mfma_f32_16x16x32_bf16 v[24:27], a[72:75], a[16:19], v[24:27]
  v_mfma_f32_16x16x32_bf16 v[40:43], a[72:75], a[20:23], v[40:43]
  v_mfma_f32_16x16x32_bf16 v[28:31], a[76:79], a[16:19], v[28:31]
  v_mfma_f32_16x16x32_bf16 v[44:47], a[76:79], a[20:23], v[44:47]
  s_waitcnt vmcnt(8) lgkmcnt(0)
  s_barrier
  v_mfma_f32_16x16x32_bf16 v[16:19], a[80:83], a[24:27], v[16:19]
  ds_read_b64_tr_b16 a[64:65], v48 offset:32768
  ds_read_b64_tr_b16 a[66:67], v48 offset:34816
  v_mfma_f32_16x16x32_bf16 v[32:35], a[80:83], a[28:31], v[32:35]
  ds_read_b64_tr_b16 a[68:69], v49 offset:32768
  ds_read_b64_tr_b16 a[70:71], v49 offset:34816
  v_mfma_f32_16x16x32_bf16 v[20:23], a[84:87], a[24:27], v[20:23]
  ds_read_b64_tr_b16 a[72:73], v50 offset:32768
  ds_read_b64_tr_b16 a[74:75], v50 offset:34816
  v_mfma_f32_16x16x32_bf16 v[36:39], a[84:87], a[28:31], v[36:39]
  ds_read_b64_tr_b16 a[76:77], v51 offset:32768
  ds_read_b64_tr_b16 a[78:79], v51 offset:34816
  v_mfma_f32_16x16x32_bf16 v[24:27], a[88:91], a[24:27], v[24:27]
  v_mfma_f32_16x16x32_bf16 v[40:43], a[88:91], a[28:31], v[40:43]
  v_mfma_f32_16x16x32_bf16 v[28:31], a[92:95], a[24:27], v[28:31]
  v_mfma_f32_16x16x32_bf16 v[44:47], a[92:95], a[28:31], v[44:47]
  s_waitcnt vmcnt(6) lgkmcnt(0)
  v_mfma_f32_16x16x32_bf16 v[16:19], a[64:67], a[32:35], v[16:19]
  ds_read_b64_tr_b16 a[80:81], v48 offset:40960
  ds_read_b64_tr_b16 a[82:83], v48 offset:43008
  v_mfma_f32_16x16x32_bf16 v[32:35], a[64:67], a[36:39], v[32:35]
  ds_read_b64_tr_b16 a[84:85], v49 offset:40960
  ds_read_b64_tr_b16 a[86:87], v49 offset:43008
  v_mfma_f32_16x16x32_bf16 v[20:23], a[68:71], a[32:35], v[20:23]
  ds_read_b64_tr_b16 a[88:89], v50 offset:40960
  ds_read_b64_tr_b16 a[90:91], v50 offset:43008
  v_mfma_f32_16x16x32_bf16 v[36:39], a[68:71], a[36:39], v[36:39]
  ds_read_b64_tr_b16 a[92:93], v51 offset:40960
  ds_read_b64_tr_b16 a[94:95], v51 offset:43008
  v_mfma_f32_16x16x32_bf16 v[24:27], a[72:75], a[32:35], v[24:27]
  v_mfma_f32_16x16x32_bf16 v[40:43], a[72:75], a[36:39], v[40:43]
  v_mfma_f32_16x16x32_bf16 v[28:31], a[76:79], a[32:35], v[28:31]
  v_mfma_f32_16x16x32_bf16 v[44:47], a[76:79], a[36:39], v[44:47]
  s_waitcnt vmcnt(4) lgkmcnt(0)
  v_mfma_f32_16x16x32_bf16 v[16:19], a[80:83], a[40:43], v[16:19]
  ds_read_b64_tr_b16 a[64:65], v48 offset:49152
  ds_read_b64_tr_b16 a[66:67], v48 offset:51200
  v_mfma_f32_16x16x32_bf16 v[32:35], a[80:83], a[44:47], v[32:35]
  ds_read_b64_tr_b16 a[68:69], v49 offset:49152
  ds_read_b64_tr_b16 a[70:71], v49 offset:51200
  v_mfma_f32_16x16x32_bf16 v[20:23], a[84:87], a[40:43], v[20:23]
  ds_read_b64_tr_b16 a[72:73], v50 offset:49152
  ds_read_b64_tr_b16 a[74:75], v50 offset:51200
  v_mfma_f32_16x16x32_bf16 v[36:39], a[84:87], a[44:47], v[36:39]
  ds_read_b64_tr_b16 a[76:77], v51 offset:49152
  ds_read_b64_tr_b16 a[78:79], v51 offset:51200
  v_mfma_f32_16x16x32_bf16 v[24:27], a[88:91], a[40:43], v[24:27]
  v_mfma_f32_16x16x32_bf16 v[40:43], a[88:91], a[44:47], v[40:43]
  v_mfma_f32_16x16x32_bf16 v[28:31], a[92:95], a[40:43], v[28:31]
  v_mfma_f32_16x16x32_bf16 v[44:47], a[92:95], a[44:47], v[44:47]
  s_waitcnt vmcnt(2) lgkmcnt(0)
  v_mfma_f32_16x16x32_bf16 v[16:19], a[64:67], a[48:51], v[16:19]
  ds_read_b64_tr_b16 a[80:81], v48 offset:57344
  ds_read_b64_tr_b16 a[82:83], v48 offset:59392
  v_mfma_f32_16x16x32_bf16 v[32:35], a[64:67], a[52:55], v[32:35]
  ds_read_b64_tr_b16 a[84:85], v49 offset:57344
  ds_read_b64_tr_b16 a[86:87], v49 offset:59392
  v_mfma_f32_16x16x32_bf16 v[20:23], a[68:71], a[48:51], v[20:23]
  ds_read_b64_tr_b16 a[88:89], v50 offset:57344
  ds_read_b64_tr_b16 a[90:91], v50 offset:59392
  v_mfma_f32_16x16x32_bf16 v[36:39], a[68:71], a[52:55], v[36:39]
  ds_read_b64_tr_b16 a[92:93], v51 offset:57344
  ds_read_b64_tr_b16 a[94:95], v51 offset:59392
  v_mfma_f32_16x16x32_bf16 v[24:27], a[72:75], a[48:51], v[24:27]
  v_mfma_f32_16x16x32_bf16 v[40:43], a[72:75], a[52:55], v[40:43]
  v_mfma_f32_16x16x32_bf16 v[28:31], a[76:79], a[48:51], v[28:31]
  v_mfma_f32_16x16x32_bf16 v[44:47], a[76:79], a[52:55], v[44:47]
  s_waitcnt vmcnt(0) lgkmcnt(0)
  v_mfma_f32_16x16x32_bf16 v[16:19], a[80:83], a[56:59], v[16:19]
  v_mfma_f32_16x16x32_bf16 v[32:35], a[80:83], a[60:63], v[32:35]
  v_mfma_f32_16x16x32_bf16 v[20:23], a[84:87], a[56:59], v[20:23]
  v_mfma_f32_16x16x32_bf16 v[36:39], a[84:87], a[60:63], v[36:39]
  v_mfma_f32_16x16x32_bf16 v[24:27], a[88:91], a[56:59], v[24:27]
  v_mfma_f32_16x16x32_bf16 v[40:43], a[88:91], a[60:63], v[40:43]
  v_mfma_f32_16x16x32_bf16 v[28:31], a[92:95], a[56:59], v[28:31]
  v_mfma_f32_16x16x32_bf16 v[44:47], a[92:95], a[60:63], v[44:47]
  s_waitcnt vmcnt(0) lgkmcnt(0)
  s_barrier
  s_lshl_b32 s40, s26, 12
  v_lshlrev_b32 v5, 4, v1
  v_add_u32 v6, s40, v5
  s_xor_b32 s41, s26, 4
  s_lshl_b32 s41, s41, 12
  v_add_u32 v7, s41, v5
  s_nop 7
  s_nop 7
  s_cmp_eq_u32 s28, 0
  s_cbranch_scc0 G2_EP1
  ds_write_b128 v6, v[32:35] offset:0
  ds_write_b128 v6, v[36:39] offset:1024
  ds_write_b128 v6, v[40:43] offset:2048
  ds_write_b128 v6, v[44:47] offset:3072
  s_waitcnt lgkmcnt(0)
  s_barrier
  ds_read_b128 v[32:35], v7 offset:0
  ds_read_b128 v[36:39], v7 offset:1024
  ds_read_b128 v[40:43], v7 offset:2048
  ds_read_b128 v[44:47], v7 offset:3072
  v_and_b32 v5, 15, v1
  v_lshrrev_b32 v6, 4, v1
  v_lshlrev_b32 v6, 3, v6
  v_lshl_add_u32 v5, v5, 11, v6
  s_lshl_b32 s40, s24, 7
  s_lshl_b32 s41, s27, 5
  s_add_u32 s40, s40, s41
  s_add_u32 s40, s40, 0
  s_lshl_b32 s40, s40, 11
  s_lshl_b32 s41, s25, 7
  s_add_u32 s40, s40, s41
  s_waitcnt lgkmcnt(0)
  v_pk_add_f32 v[16:17], v[16:17], v[32:33]
  v_pk_add_f32 v[18:19], v[18:19], v[34:35]
  v_pk_add_f32 v[20:21], v[20:21], v[36:37]
  v_pk_add_f32 v[22:23], v[22:23], v[38:39]
  v_pk_add_f32 v[24:25], v[24:25], v[40:41]
  v_pk_add_f32 v[26:27], v[26:27], v[42:43]
  v_pk_add_f32 v[28:29], v[28:29], v[44:45]
  v_pk_add_f32 v[30:31], v[30:31], v[46:47]
  v_cvt_pk_bf16_f32 v16, v16, v17
  v_cvt_pk_bf16_f32 v17, v18, v19
  v_cvt_pk_bf16_f32 v20, v20, v21
  v_cvt_pk_bf16_f32 v21, v22, v23
  v_cvt_pk_bf16_f32 v24, v24, v25
  v_cvt_pk_bf16_f32 v25, v26, v27
  v_cvt_pk_bf16_f32 v28, v28, v29
  v_cvt_pk_bf16_f32 v29, v30, v31
  buffer_store_dwordx2 v[16:17], v5, s[20:23], s40 offen offset:0
  buffer_store_dwordx2 v[20:21], v5, s[20:23], s40 offen offset:32
  buffer_store_dwordx2 v[24:25], v5, s[20:23], s40 offen offset:64
  buffer_store_dwordx2 v[28:29], v5, s[20:23], s40 offen offset:96
  s_branch G2_END
G2_EP1:
  ds_write_b128 v6, v[16:19] offset:0
  ds_write_b128 v6, v[20:23] offset:1024
  ds_write_b128 v6, v[24:27] offset:2048
  ds_write_b128 v6, v[28:31] offset:3072
  s_waitcnt lgkmcnt(0)
  s_barrier
  ds_read_b128 v[16:19], v7 offset:0
  ds_read_b128 v[20:23], v7 offset:1024
  ds_read_b128 v[24:27], v7 offset:2048
  ds_read_b128 v[28:31], v7 offset:3072
  v_and_b32 v5, 15, v1
  v_lshrrev_b32 v6, 4, v1
  v_lshlrev_b32 v6, 3, v6
  v_lshl_add_u32 v5, v5, 11, v6
  s_lshl_b32 s40, s24, 7
  s_lshl_b32 s41, s27, 5
  s_add_u32 s40, s40, s41
  s_add_u32 s40, s40, 16
  s_lshl_b32 s40, s40, 11
  s_lshl_b32 s41, s25, 7
  s_add_u32 s40, s40, s41
  s_waitcnt lgkmcnt(0)
  v_pk_add_f32 v[32:33], v[32:33], v[16:17]
  v_pk_add_f32 v[34:35], v[34:35], v[18:19]
  v_pk_add_f32 v[36:37], v[36:37], v[20:21]
  v_pk_add_f32 v[38:39], v[38:39], v[22:23]
  v_pk_add_f32 v[40:41], v[40:41], v[24:25]
  v_pk_add_f32 v[42:43], v[42:43], v[26:27]
  v_pk_add_f32 v[44:45], v[44:45], v[28:29]
  v_pk_add_f32 v[46:47], v[46:47], v[30:31]
  v_cvt_pk_bf16_f32 v32, v32, v33
  v_cvt_pk_bf16_f32 v33, v34, v35
  v_cvt_pk_bf16_f32 v36, v36, v37
  v_cvt_pk_bf16_f32 v37, v38, v39
  v_cvt_pk_bf16_f32 v40, v40, v41
  v_cvt_pk_bf16_f32 v41, v42, v43
  v_cvt_pk_bf16_f32 v44, v44, v45
  v_cvt_pk_bf16_f32 v45, v46, v47
  buffer_store_dwordx2 v[32:33], v5, s[20:23], s40 offen offset:0
  buffer_store_dwordx2 v[36:37], v5, s[20:23], s40 offen offset:32
  buffer_store_dwordx2 v[40:41], v5, s[20:23], s40 offen offset:64
  buffer_store_dwordx2 v[44:45], v5, s[20:23], s40 offen offset:96
  s_branch G2_END
G2_END:
G2_EXIT:
  s_endpgm
.section .rodata,"a"
.p2align 6
.amdhsa_kernel gemm1_kernel
  .amdhsa_next_free_vgpr 256
  .amdhsa_next_free_sgpr 96
  .amdhsa_accum_offset 160
  .amdhsa_group_segment_fixed_size 0
  .amdhsa_kernarg_size 56
  .amdhsa_user_sgpr_count 2
  .amdhsa_user_sgpr_kernarg_segment_ptr 1
  .amdhsa_system_sgpr_workgroup_id_x 1
.end_amdhsa_kernel
.p2align 6
.amdhsa_kernel gemm2_kernel
  .amdhsa_next_free_vgpr 160
  .amdhsa_next_free_sgpr 80
  .amdhsa_accum_offset 64
  .amdhsa_group_segment_fixed_size 0
  .amdhsa_kernarg_size 56
  .amdhsa_user_sgpr_count 2
  .amdhsa_user_sgpr_kernarg_segment_ptr 1
  .amdhsa_system_sgpr_workgroup_id_x 1
.end_amdhsa_kernel
```
